```python
import torch

def _softmax(x, axis=-1):
    return torch.softmax(x, dim=axis)
def _gelu(x):
    return torch.nn.functional.gelu(x, approximate="tanh")
def _silu(x):
    return torch.nn.functional.silu(x)
def _sigmoid(x):
    return torch.sigmoid(x)
def _layernorm(x, axis=-1, eps=1e-5):
    m = x.mean(dim=axis, keepdim=True)
    v = x.var(dim=axis, keepdim=True, unbiased=False)
    return (x - m) / torch.sqrt(v + eps)
def _scatter_add(tgt, idx, src, axis=0):
    return tgt.clone().index_add_(axis, idx, src)
def _segment_sum(src, seg, n):
    out = torch.zeros((n,) + src.shape[1:], dtype=src.dtype)
    return out.index_add_(0, seg, src)
def _pad(x, pw):
    flat = tuple(v for pair in reversed(pw) for v in pair)
    return torch.nn.functional.pad(x, flat)

kernel_name = 'concat_heads__gqa_block_cached__mha_block_cached__near_ridge'

def setup_inputs():

    _w = (lambda a: (lambda t: t.to(torch.bfloat16) if t.is_floating_point() else t)(torch.as_tensor(a)))
    def _A_setup():
        B, Sq, D = 8, 80, 512
        Hq, Hkv, Sk, Dh = 32, 8, 1024, 128
        assert Hq % Hkv == 0, (Hq, Hkv)
        return {
            "x": _w((lambda *s: torch.randn(*s, dtype=torch.bfloat16) * 0.8)(B, Sq, D)),
            "k_cache": _w((lambda *s: torch.randn(*s, dtype=torch.bfloat16) * 0.8)(B, Hkv, Sk, Dh)),
            "v_cache": _w((lambda *s: torch.randn(*s, dtype=torch.bfloat16) * 0.05)(B, Hkv, Sk, Dh)),
            "wq": _w((lambda *s: torch.randn(*s, dtype=torch.bfloat16) * 0.8)(D, Hq * Dh) * (D ** -0.5)),
            "wo": _w((lambda *s: torch.randn(*s, dtype=torch.bfloat16) * 0.05)(Hq * Dh, D) * ((Hq * Dh) ** -0.5)),
        }
    _A_in = _A_setup()

    def _B_setup():
        B, Sq, D = 8, 80, 512
        H, Sk, Dh = 32, 1024, 128
        return {
            "x": _w((lambda *s: torch.randn(*s, dtype=torch.bfloat16) * 0.8)(B, Sq, D)),
            "k_cache": _w((lambda *s: torch.randn(*s, dtype=torch.bfloat16) * 0.8)(B, H, Sk, Dh)),
            "v_cache": _w((lambda *s: torch.randn(*s, dtype=torch.bfloat16) * 0.05)(B, H, Sk, Dh)),
            "wq": _w((lambda *s: torch.randn(*s, dtype=torch.bfloat16) * 0.8)(D, H * Dh) * (D ** -0.5)),
            "wo": _w((lambda *s: torch.randn(*s, dtype=torch.bfloat16) * 0.05)(H * Dh, D) * ((H * Dh) ** -0.5)),
        }
    _B_in = _B_setup()

    return {
        "A_x": _A_in["x"],
        "A_k_cache": _A_in["k_cache"],
        "A_v_cache": _A_in["v_cache"],
        "A_wq": _A_in["wq"],
        "A_wo": _A_in["wo"],
        "B_x": _B_in["x"],
        "B_k_cache": _B_in["k_cache"],
        "B_v_cache": _B_in["v_cache"],
        "B_wq": _B_in["wq"],
        "B_wo": _B_in["wo"],
    }

def reference(A_x, A_k_cache, A_v_cache, A_wq, A_wo, B_x, B_k_cache, B_v_cache, B_wq, B_wo):
    def _A_ref(x, k_cache, v_cache, wq, wo):
        B, Sq, D = x.shape
        Hq, Dh = 32, 128
        Hkv = k_cache.shape[1]
        rep = Hq // Hkv
        q = (lambda x, *d: x.permute(*d))((x @ wq).reshape(B, Sq, Hq, Dh), 0, 2, 1, 3)
        k = (lambda x, n, axis: torch.repeat_interleave(x, n, dim=axis))(k_cache, rep, axis=1)
        v = (lambda x, n, axis: torch.repeat_interleave(x, n, dim=axis))(v_cache, rep, axis=1)
        scores = torch.einsum("bhqd,bhkd->bhqk", q, k) * (Dh ** -0.5)
        p = _softmax(scores, axis=-1)
        o = torch.einsum("bhqk,bhkd->bhqd", p, v)
        return (lambda x, *d: x.permute(*d))(o, 0, 2, 1, 3).reshape(B, Sq, Hq * Dh) @ wo

    def _B_ref(x, k_cache, v_cache, wq, wo):
        B, Sq, D = x.shape
        H, Dh = 32, 128
        q = (lambda x, *d: x.permute(*d))((x @ wq).reshape(B, Sq, H, Dh), 0, 2, 1, 3)
        scores = torch.einsum("bhqd,bhkd->bhqk", q, k_cache) * (Dh ** -0.5)
        p = _softmax(scores, axis=-1)
        o = torch.einsum("bhqk,bhkd->bhqd", p, v_cache)
        return (lambda x, *d: x.permute(*d))(o, 0, 2, 1, 3).reshape(B, Sq, H * Dh) @ wo

    a = _A_ref(A_x, A_k_cache, A_v_cache, A_wq, A_wo)
    b = _B_ref(B_x, B_k_cache, B_v_cache, B_wq, B_wo)
    return torch.concatenate([a, b], axis=-1)
```

```asm
; @launch grid=(256,1,1) block=(256,1,1) lds=163840
.amdgcn_target "amdgcn-amd-amdhsa--gfx950"
.text
.globl concat_heads__gqa_block_cached__mha_block_cached__near_ridge_kernel
.p2align 8
.type concat_heads__gqa_block_cached__mha_block_cached__near_ridge_kernel,@function
concat_heads__gqa_block_cached__mha_block_cached__near_ridge_kernel:
  s_cmp_ge_u32 s2, 256
  s_cbranch_scc1 L_end
  s_load_dwordx16 s[4:19], s[0:1], 0
  s_load_dwordx8 s[20:27], s[0:1], 64
  s_load_dwordx2 s[28:29], s[0:1], 96
  v_lshrrev_b32 v1, 6, v0
  v_and_b32 v0, 63, v0
  v_readfirstlane_b32 s64, v1
  s_and_b32 s74, s2, 7
  s_lshr_b32 s75, s2, 3
  s_and_b32 s66, s75, 1
  s_lshr_b32 s67, s75, 2
  s_bfe_u32 s75, s75, 0x10001
  s_lshl_b32 s31, s74, 1
  s_add_u32 s31, s31, s75
  s_lshl_b32 s68, s31, 1
  s_lshl_b32 s3, s75, 2
  s_add_u32 s3, s3, s67
  s_and_b32 s65, s64, 1
  s_lshl_b32 s69, s64, 15
  s_mov_b32 s30, s69
  s_xor_b32 s78, s69, 32768
  s_lshl_b32 s70, s64, 13
  s_add_u32 s70, s70, 131072
  s_xor_b32 s79, s70, 8192
  s_lshl_b32 s75, s67, 5
  s_add_u32 s75, s75, s68
  s_lshr_b32 s76, s64, 1
  s_add_u32 s75, s75, s76
  s_lshl_b32 s76, s67, 3
  s_add_u32 s76, s76, s74
  s_cmp_eq_u32 s66, 1
  s_cselect_b32 s75, s76, s75
  s_lshl_b32 s75, s75, 18
  s_lshl_b32 s76, s65, 17
  s_add_u32 s75, s75, s76
  s_mul_i32 s76, s67, 81920
  s_cmp_lt_u32 s64, 2
  s_cselect_b32 s100, 8, 64
  s_add_u32 s100, s100, s64
  v_lshrrev_b32 v228, 4, v0
  v_and_b32 v229, 15, v0
  v_lshlrev_b32 v7, 4, v0
  v_lshrrev_b32 v230, 5, v0
  v_and_b32 v231, 31, v0
  v_add_u32 v232, 0, v230
  v_lshlrev_b32 v232, 2, v232
  v_xor_b32 v232, v232, v231
  v_lshlrev_b32 v232, 4, v232
  v_lshl_add_u32 v120, v230, 13, v232
  v_add_u32 v232, 2, v230
  v_lshlrev_b32 v232, 2, v232
  v_xor_b32 v232, v232, v231
  v_lshlrev_b32 v232, 4, v232
  v_lshl_add_u32 v121, v230, 13, v232
  s_lshl_b32 s77, s65, 2
  v_add_u32 v232, s77, v228
  v_and_b32 v233, 7, v0
  v_xor_b32 v232, v232, v233
  v_lshlrev_b32 v232, 4, v232
  v_lshrrev_b32 v233, 3, v0
  v_lshl_add_u32 v122, v233, 10, v232
  v_add_u32 v230, 0, v228
  v_xor_b32 v230, v230, v229
  v_lshlrev_b32 v230, 4, v230
  v_lshl_add_u32 v1, v228, 8, v230
  v_add_u32 v230, 4, v228
  v_xor_b32 v230, v230, v229
  v_lshlrev_b32 v230, 4, v230
  v_lshl_add_u32 v2, v228, 8, v230
  v_add_u32 v230, 8, v228
  v_xor_b32 v230, v230, v229
  v_lshlrev_b32 v230, 4, v230
  v_lshl_add_u32 v3, v228, 8, v230
  v_add_u32 v230, 12, v228
  v_xor_b32 v230, v230, v229
  v_lshlrev_b32 v230, 4, v230
  v_lshl_add_u32 v4, v228, 8, v230
  v_add_u32 v230, 0, v228
  v_lshlrev_b32 v230, 1, v230
  v_xor_b32 v230, v230, v229
  v_lshlrev_b32 v230, 4, v230
  v_lshl_add_u32 v5, v228, 8, v230
  v_add_u32 v230, 4, v228
  v_lshlrev_b32 v230, 1, v230
  v_xor_b32 v230, v230, v229
  v_lshlrev_b32 v230, 4, v230
  v_lshl_add_u32 v6, v228, 8, v230
  s_waitcnt lgkmcnt(0)
  s_cmp_eq_u32 s66, 1
  s_cselect_b64 s[32:33], s[4:5], s[14:15]
  s_cselect_b64 s[36:37], s[10:11], s[20:21]
  s_cselect_b64 s[40:41], s[6:7], s[16:17]
  s_cselect_b64 s[44:45], s[8:9], s[18:19]
  s_cselect_b64 s[48:49], s[12:13], s[22:23]
  s_add_u32 s32, s32, s76
  s_addc_u32 s33, s33, 0
  s_add_u32 s40, s40, s75
  s_addc_u32 s41, s41, 0
  s_add_u32 s44, s44, s75
  s_addc_u32 s45, s45, 0
  s_mov_b32 s34, 81920
  s_mov_b32 s38, 4194304
  s_mov_b32 s42, 131072
  s_mov_b32 s46, 131072
  s_mov_b32 s50, 4194304
  s_mov_b32 s52, s28
  s_mov_b32 s53, s29
  s_mov_b32 s54, 268435456
  s_mov_b32 s56, s24
  s_mov_b32 s57, s25
  s_mov_b32 s58, 1310720
  s_mov_b32 s60, s26
  s_mov_b32 s61, s27
  s_mov_b32 s62, 256
  s_mov_b32 s35, 0x20000
  s_mov_b32 s39, 0x20000
  s_mov_b32 s43, 0x20000
  s_mov_b32 s47, 0x20000
  s_mov_b32 s51, 0x20000
  s_mov_b32 s55, 0x20000
  s_mov_b32 s59, 0x20000
  s_mov_b32 s63, 0x20000
  s_lshl_b32 s77, s67, 5
  s_add_u32 s77, s77, s68
  s_lshl_b32 s77, s77, 18
  s_add_u32 s4, s16, s77
  s_addc_u32 s5, s17, 0
  s_add_u32 s8, s18, s77
  s_addc_u32 s9, s19, 0
  s_mov_b32 s6, 524288
  s_mov_b32 s10, 524288
  s_mov_b32 s7, 0x20000
  s_mov_b32 s11, 0x20000
  s_mov_b32 s24, s22
  s_mov_b32 s25, s23
  s_mov_b32 s26, 4194304
  s_mov_b32 s27, 0x20000
  s_lshr_b32 s12, s64, 1
  s_lshl_b32 s12, s12, 12
  s_lshl_b32 s16, s65, 15
  s_add_u32 s17, s16, 0x10000
  s_add_u32 s13, s16, s12
  s_add_u32 s14, s17, s12
  s_lshl_b32 s15, s64, 17
  s_add_u32 s15, s15, 98304
  s_cmp_eq_u32 s66, 1
  s_cselect_b32 s16, s16, s69
  s_cselect_b32 s17, s17, s69
  s_lshl_b32 s74, s64, 17
  s_lshl_b32 s75, s68, 8
  s_add_u32 s74, s74, s75
  s_lshl_b32 s76, s64, 13
  s_add_u32 s75, s3, 0
  s_and_b32 s75, s75, 7
  s_lshl_b32 s72, s75, 19
  s_add_u32 s72, s72, s74
  s_add_u32 m0, s69, 16384
  s_add_u32 s77, s72, 0
  buffer_load_dwordx4 v120, s[36:39], s77 offen lds
  s_add_u32 m0, s69, 17408
  s_add_u32 s77, s72, 16384
  buffer_load_dwordx4 v121, s[36:39], s77 offen lds
  s_add_u32 m0, s69, 18432
  s_add_u32 s77, s72, 32768
  buffer_load_dwordx4 v120, s[36:39], s77 offen lds
  s_add_u32 m0, s69, 19456
  s_add_u32 s77, s72, 49152
  buffer_load_dwordx4 v121, s[36:39], s77 offen lds
  s_add_u32 m0, s69, 20480
  s_add_u32 s77, s72, 65536
  buffer_load_dwordx4 v120, s[36:39], s77 offen lds
  s_add_u32 m0, s69, 21504
  s_add_u32 s77, s72, 81920
  buffer_load_dwordx4 v121, s[36:39], s77 offen lds
  s_add_u32 m0, s69, 22528
  s_add_u32 s77, s72, 98304
  buffer_load_dwordx4 v120, s[36:39], s77 offen lds
  s_add_u32 m0, s69, 23552
  s_add_u32 s77, s72, 114688
  buffer_load_dwordx4 v121, s[36:39], s77 offen lds
  s_lshl_b32 s75, s75, 7
  s_lshl_b32 s72, s64, 10
  s_add_u32 m0, s72, 131072
  s_add_u32 s77, s76, 0
  s_add_u32 s77, s77, s75
  buffer_load_dwordx4 v122, s[32:35], s77 offen lds
  s_lshl_b32 s72, s64, 10
  s_add_u32 m0, s72, 135168
  s_add_u32 s77, s76, 32768
  s_add_u32 s77, s77, s75
  buffer_load_dwordx4 v122, s[32:35], s77 offen lds
  s_lshl_b32 s72, s100, 10
  s_add_u32 m0, s72, 131072
  s_lshl_b32 s77, s100, 13
  s_add_u32 s77, s77, s75
  buffer_load_dwordx4 v122, s[32:35], s77 offen lds
  s_add_u32 s75, s3, 1
  s_and_b32 s75, s75, 7
  s_lshl_b32 s72, s75, 19
  s_add_u32 s72, s72, s74
  s_add_u32 m0, s69, 24576
  s_add_u32 s77, s72, 0
  buffer_load_dwordx4 v120, s[36:39], s77 offen lds
  s_add_u32 m0, s69, 25600
  s_add_u32 s77, s72, 16384
  buffer_load_dwordx4 v121, s[36:39], s77 offen lds
  s_add_u32 m0, s69, 26624
  s_add_u32 s77, s72, 32768
  buffer_load_dwordx4 v120, s[36:39], s77 offen lds
  s_add_u32 m0, s69, 27648
  s_add_u32 s77, s72, 49152
  buffer_load_dwordx4 v121, s[36:39], s77 offen lds
  s_add_u32 m0, s69, 28672
  s_add_u32 s77, s72, 65536
  buffer_load_dwordx4 v120, s[36:39], s77 offen lds
  s_add_u32 m0, s69, 29696
  s_add_u32 s77, s72, 81920
  buffer_load_dwordx4 v121, s[36:39], s77 offen lds
  s_add_u32 m0, s69, 30720
  s_add_u32 s77, s72, 98304
  buffer_load_dwordx4 v120, s[36:39], s77 offen lds
  s_add_u32 m0, s69, 31744
  s_add_u32 s77, s72, 114688
  buffer_load_dwordx4 v121, s[36:39], s77 offen lds
  s_lshl_b32 s75, s75, 7
  s_lshl_b32 s72, s64, 10
  s_add_u32 m0, s72, 141312
  s_add_u32 s77, s76, 0
  s_add_u32 s77, s77, s75
  buffer_load_dwordx4 v122, s[32:35], s77 offen lds
  s_lshl_b32 s72, s64, 10
  s_add_u32 m0, s72, 145408
  s_add_u32 s77, s76, 32768
  s_add_u32 s77, s77, s75
  buffer_load_dwordx4 v122, s[32:35], s77 offen lds
  s_lshl_b32 s72, s100, 10
  s_add_u32 m0, s72, 141312
  s_lshl_b32 s77, s100, 13
  s_add_u32 s77, s77, s75
  buffer_load_dwordx4 v122, s[32:35], s77 offen lds
  s_add_u32 s75, s3, 2
  s_and_b32 s75, s75, 7
  s_lshl_b32 s72, s75, 19
  s_add_u32 s72, s72, s74
  s_add_u32 m0, s69, 8192
  s_add_u32 s77, s72, 0
  buffer_load_dwordx4 v120, s[36:39], s77 offen lds
  s_add_u32 m0, s69, 9216
  s_add_u32 s77, s72, 16384
  buffer_load_dwordx4 v121, s[36:39], s77 offen lds
  s_add_u32 m0, s69, 10240
  s_add_u32 s77, s72, 32768
  buffer_load_dwordx4 v120, s[36:39], s77 offen lds
  s_add_u32 m0, s69, 11264
  s_add_u32 s77, s72, 49152
  buffer_load_dwordx4 v121, s[36:39], s77 offen lds
  s_add_u32 m0, s69, 12288
  s_add_u32 s77, s72, 65536
  buffer_load_dwordx4 v120, s[36:39], s77 offen lds
  s_add_u32 m0, s69, 13312
  s_add_u32 s77, s72, 81920
  buffer_load_dwordx4 v121, s[36:39], s77 offen lds
  s_add_u32 m0, s69, 14336
  s_add_u32 s77, s72, 98304
  buffer_load_dwordx4 v120, s[36:39], s77 offen lds
  s_add_u32 m0, s69, 15360
  s_add_u32 s77, s72, 114688
  buffer_load_dwordx4 v121, s[36:39], s77 offen lds
  s_lshl_b32 s75, s75, 7
  s_lshl_b32 s72, s64, 10
  s_add_u32 m0, s72, 151552
  s_add_u32 s77, s76, 0
  s_add_u32 s77, s77, s75
  buffer_load_dwordx4 v122, s[32:35], s77 offen lds
  s_lshl_b32 s72, s64, 10
  s_add_u32 m0, s72, 155648
  s_add_u32 s77, s76, 32768
  s_add_u32 s77, s77, s75
  buffer_load_dwordx4 v122, s[32:35], s77 offen lds
  s_lshl_b32 s72, s100, 10
  s_add_u32 m0, s72, 151552
  s_lshl_b32 s77, s100, 13
  s_add_u32 s77, s77, s75
  buffer_load_dwordx4 v122, s[32:35], s77 offen lds
  s_cmp_eq_u32 s66, 1
  s_cbranch_scc1 L_ry0
  s_add_u32 m0, s30, 0
  s_mov_b32 s77, 0
  buffer_load_dwordx4 v1, s[40:43], s77 offen offset:0  lds
  buffer_load_dwordx4 v2, s[40:43], s77 offen offset:1024  lds
  buffer_load_dwordx4 v3, s[40:43], s77 offen offset:2048  lds
  buffer_load_dwordx4 v4, s[40:43], s77 offen offset:3072  lds
  s_add_u32 m0, s30, 4096
  s_mov_b32 s77, 4096
  buffer_load_dwordx4 v1, s[40:43], s77 offen offset:0  lds
  buffer_load_dwordx4 v2, s[40:43], s77 offen offset:1024  lds
  buffer_load_dwordx4 v3, s[40:43], s77 offen offset:2048  lds
  buffer_load_dwordx4 v4, s[40:43], s77 offen offset:3072  lds
  s_branch L_re0
L_ry0:
  s_add_u32 m0, s13, 0
  s_add_u32 s77, s12, 0
  buffer_load_dwordx4 v1, s[40:43], s77 offen offset:0  lds
  buffer_load_dwordx4 v2, s[40:43], s77 offen offset:1024  lds
  buffer_load_dwordx4 v3, s[40:43], s77 offen offset:2048  lds
  buffer_load_dwordx4 v4, s[40:43], s77 offen offset:3072  lds
  s_add_u32 m0, s14, 0
  s_add_u32 s77, s12, 0
  buffer_load_dwordx4 v5, s[44:47], s77 offen offset:0  lds
  buffer_load_dwordx4 v6, s[44:47], s77 offen offset:1024  lds
  buffer_load_dwordx4 v5, s[44:47], s77 offen offset:2048  lds
  buffer_load_dwordx4 v6, s[44:47], s77 offen offset:3072  lds
L_re0:
  s_xor_b32 s29, s66, 1
  s_lshl_b32 s29, s29, 3
  s_add_u32 s29, s29, s67
  s_lshl_b32 s29, s29, 2
  s_add_u32 s29, s29, s64
  s_lshl_b32 s29, s29, 8
  s_lshl_b32 s77, s31, 2
  s_add_u32 s29, s29, s77
  s_add_u32 s29, s29, 33554432
  v_and_b32 v230, 3, v0
  v_lshlrev_b32 v37, 6, v230
  buffer_load_dword v36, v37, s[52:55], s29 offen sc1
  v_lshlrev_b32 v230, 2, v230
  s_lshl_b32 s77, s64, 4
  v_add_u32 v38, s77, v230
  s_lshl_b32 s77, s67, 4
  s_add_u32 s77, s77, s31
  s_lshl_b32 s77, s77, 6
  s_add_u32 s77, s77, 33554432
  buffer_load_dword v244, v38, s[52:55], s77 offen sc1
  s_add_u32 s77, s77, 8192
  buffer_load_dword v245, v38, s[52:55], s77 offen sc1
  s_lshl_b32 s18, s67, 4
  s_add_u32 s18, s18, s31
  s_lshl_b32 s18, s18, 6
  s_add_u32 s18, s18, 33619968
  v_mov_b32 v247, 0
  buffer_load_dword v246, v247, s[52:55], s18 offen sc1
  v_add_u32 v230, 0, v228
  v_lshlrev_b32 v230, 1, v230
  v_xor_b32 v230, v230, v229
  v_lshlrev_b32 v230, 4, v230
  v_lshl_add_u32 v24, v228, 10, v230
  v_add_u32 v230, 4, v228
  v_lshlrev_b32 v230, 1, v230
  v_xor_b32 v230, v230, v229
  v_lshlrev_b32 v230, 4, v230
  v_lshl_add_u32 v25, v228, 10, v230
  v_add_u32 v25, 3072, v25
  v_add_u32 v230, 0, v228
  v_lshlrev_b32 v230, 1, v230
  v_xor_b32 v230, v230, v229
  v_lshlrev_b32 v230, 4, v230
  v_lshl_add_u32 v26, v228, 10, v230
  v_add_u32 v26, 6144, v26
  v_add_u32 v230, 4, v228
  v_lshlrev_b32 v230, 1, v230
  v_xor_b32 v230, v230, v229
  v_lshlrev_b32 v230, 4, v230
  v_lshl_add_u32 v27, v228, 10, v230
  v_add_u32 v27, 9216, v27
  v_xor_b32 v230, v228, v229
  s_lshl_b32 s77, s65, 3
  v_xor_b32 v230, s77, v230
  v_lshlrev_b32 v231, 8, v229
  v_add_u32 v231, s16, v231
  v_xor_b32 v232, 0, v230
  v_lshl_add_u32 v8, v232, 4, v231
  v_xor_b32 v232, 4, v230
  v_lshl_add_u32 v9, v232, 4, v231
  v_xor_b32 v232, 8, v230
  v_lshl_add_u32 v10, v232, 4, v231
  v_xor_b32 v232, 12, v230
  v_lshl_add_u32 v11, v232, 4, v231
  v_lshrrev_b32 v230, 2, v0
  v_lshlrev_b32 v231, 8, v230
  v_add_u32 v231, s69, v231
  v_bfe_u32 v232, v0, 1, 1
  v_lshl_add_u32 v231, v232, 4, v231
  v_and_b32 v232, 1, v0
  v_lshl_add_u32 v231, v232, 3, v231
  v_and_b32 v230, 7, v230
  v_lshlrev_b32 v230, 1, v230
  v_xor_b32 v232, 0, v230
  v_lshl_add_u32 v28, v232, 4, v231
  v_xor_b32 v232, 2, v230
  v_lshl_add_u32 v29, v232, 4, v231
  v_xor_b32 v232, 4, v230
  v_lshl_add_u32 v30, v232, 4, v231
  v_xor_b32 v232, 6, v230
  v_lshl_add_u32 v31, v232, 4, v231
  v_xor_b32 v232, 8, v230
  v_lshl_add_u32 v32, v232, 4, v231
  v_xor_b32 v232, 10, v230
  v_lshl_add_u32 v33, v232, 4, v231
  v_xor_b32 v232, 12, v230
  v_lshl_add_u32 v34, v232, 4, v231
  v_xor_b32 v232, 14, v230
  v_lshl_add_u32 v35, v232, 4, v231
  v_xor_b32 v230, s77, v230
  s_sub_u32 s72, s17, s69
  v_add_u32 v231, s72, v231
  v_xor_b32 v232, 0, v230
  v_lshl_add_u32 v12, v232, 4, v231
  v_xor_b32 v232, 2, v230
  v_lshl_add_u32 v13, v232, 4, v231
  v_xor_b32 v232, 4, v230
  v_lshl_add_u32 v14, v232, 4, v231
  v_xor_b32 v232, 6, v230
  v_lshl_add_u32 v15, v232, 4, v231
  v_xor_b32 v232, 8, v230
  v_lshl_add_u32 v16, v232, 4, v231
  v_xor_b32 v232, 10, v230
  v_lshl_add_u32 v17, v232, 4, v231
  v_xor_b32 v232, 12, v230
  v_lshl_add_u32 v18, v232, 4, v231
  v_xor_b32 v232, 14, v230
  v_lshl_add_u32 v19, v232, 4, v231
  v_lshrrev_b32 v230, 1, v229
  v_xor_b32 v230, v230, v228
  v_lshlrev_b32 v231, 7, v229
  v_add_u32 v231, 131072, v231
  v_lshl_add_u32 v123, v230, 4, v231
  v_xor_b32 v230, 4, v230
  v_lshl_add_u32 v124, v230, 4, v231
  v_bfe_u32 v230, v0, 2, 2
  v_bfe_u32 v231, v0, 4, 1
  v_lshl_add_u32 v231, v231, 3, v230
  v_lshlrev_b32 v231, 9, v231
  v_lshrrev_b32 v232, 5, v0
  v_lshl_add_u32 v231, v232, 15, v231
  v_and_b32 v232, 3, v0
  s_lshl_b32 s77, s64, 3
  v_add_u32 v232, s77, v232
  v_lshlrev_b32 v230, 2, v230
  v_xor_b32 v232, v232, v230
  v_lshl_add_u32 v125, v232, 4, v231
  v_xor_b32 v232, 4, v232
  v_lshl_add_u32 v126, v232, 4, v231
  v_add_u32 v127, 0x10000, v125
  v_add_u32 v128, 0x10000, v126
  v_mov_b32 v20, 0x3f803f80
  v_mov_b32 v21, 0x3f803f80
  v_mov_b32 v22, 0x3f803f80
  v_mov_b32 v23, 0x3f803f80
  v_mov_b32 v208, 0
  v_mov_b32 v209, 0
  v_mov_b32 v210, 0
  v_mov_b32 v211, 0
  v_mov_b32 v212, 0
  v_mov_b32 v213, 0
  v_mov_b32 v214, 0
  v_mov_b32 v215, 0
  v_mov_b32 v216, 0
  v_mov_b32 v217, 0
  v_mov_b32 v218, 0
  v_mov_b32 v219, 0
  v_mov_b32 v220, 0
  v_mov_b32 v221, 0
  v_mov_b32 v222, 0
  v_mov_b32 v223, 0
  v_mov_b32 v224, 0
  v_mov_b32 v225, 0
  v_mov_b32 v226, 0
  v_mov_b32 v227, 0
  v_mov_b32 v176, 0
  v_mov_b32 v177, 0
  v_mov_b32 v178, 0
  v_mov_b32 v179, 0
  v_mov_b32 v180, 0
  v_mov_b32 v181, 0
  v_mov_b32 v182, 0
  v_mov_b32 v183, 0
  v_mov_b32 v184, 0
  v_mov_b32 v185, 0
  v_mov_b32 v186, 0
  v_mov_b32 v187, 0
  v_mov_b32 v188, 0
  v_mov_b32 v189, 0
  v_mov_b32 v190, 0
  v_mov_b32 v191, 0
  v_mov_b32 v192, 0
  v_mov_b32 v193, 0
  v_mov_b32 v194, 0
  v_mov_b32 v195, 0
  v_mov_b32 v196, 0
  v_mov_b32 v197, 0
  v_mov_b32 v198, 0
  v_mov_b32 v199, 0
  v_mov_b32 v200, 0
  v_mov_b32 v201, 0
  v_mov_b32 v202, 0
  v_mov_b32 v203, 0
  v_mov_b32 v204, 0
  v_mov_b32 v205, 0
  v_mov_b32 v206, 0
  v_mov_b32 v207, 0
  v_mov_b32 v136, 0
  v_mov_b32 v137, 0
  v_mov_b32 v138, 0
  v_mov_b32 v139, 0
  v_mov_b32 v140, 0
  v_mov_b32 v141, 0
  v_mov_b32 v142, 0
  v_mov_b32 v143, 0
  v_accvgpr_write_b32 a144, 0
  v_accvgpr_write_b32 a145, 0
  v_accvgpr_write_b32 a146, 0
  v_accvgpr_write_b32 a147, 0
  v_accvgpr_write_b32 a148, 0
  v_accvgpr_write_b32 a149, 0
  v_accvgpr_write_b32 a150, 0
  v_accvgpr_write_b32 a151, 0
  v_accvgpr_write_b32 a152, 0
  v_accvgpr_write_b32 a153, 0
  v_accvgpr_write_b32 a154, 0
  v_accvgpr_write_b32 a155, 0
  v_accvgpr_write_b32 a156, 0
  v_accvgpr_write_b32 a157, 0
  v_accvgpr_write_b32 a158, 0
  v_accvgpr_write_b32 a159, 0
  v_accvgpr_write_b32 a160, 0
  v_accvgpr_write_b32 a161, 0
  v_accvgpr_write_b32 a162, 0
  v_accvgpr_write_b32 a163, 0
  v_accvgpr_write_b32 a164, 0
  v_accvgpr_write_b32 a165, 0
  v_accvgpr_write_b32 a166, 0
  v_accvgpr_write_b32 a167, 0
  v_accvgpr_write_b32 a168, 0
  v_accvgpr_write_b32 a169, 0
  v_accvgpr_write_b32 a170, 0
  v_accvgpr_write_b32 a171, 0
  v_accvgpr_write_b32 a172, 0
  v_accvgpr_write_b32 a173, 0
  v_accvgpr_write_b32 a174, 0
  v_accvgpr_write_b32 a175, 0
  v_accvgpr_write_b32 a176, 0
  v_accvgpr_write_b32 a177, 0
  v_accvgpr_write_b32 a178, 0
  v_accvgpr_write_b32 a179, 0
  s_mov_b32 s82, 0x3e0293ee
  s_mov_b32 s83, 0x3e0293ee
  s_mov_b32 s80, 0xff800000
  s_mov_b32 s81, 0xff800000
  s_lshl_b32 s101, s68, 17
  s_lshl_b32 s77, s64, 8
  s_add_u32 s101, s101, s77
  s_waitcnt vmcnt(34)
  s_barrier
  ds_read_b64_tr_b16 a[80:81], v125 offset:16384
  ds_read_b64_tr_b16 a[82:83], v125 offset:18432
  ds_read_b64_tr_b16 a[84:85], v125 offset:16392
  ds_read_b64_tr_b16 a[86:87], v125 offset:18440
  ds_read_b64_tr_b16 a[88:89], v126 offset:16384
  ds_read_b64_tr_b16 a[90:91], v126 offset:18432
  ds_read_b64_tr_b16 a[92:93], v126 offset:16392
  ds_read_b64_tr_b16 a[94:95], v126 offset:18440
  ds_read_b128 a[0:3], v123 offset:0
  ds_read_b128 a[4:7], v123 offset:2048
  ds_read_b128 a[8:11], v123 offset:4096
  ds_read_b128 a[12:15], v123 offset:6144
  ds_read_b128 a[16:19], v123 offset:8192
  ds_read_b64_tr_b16 a[96:97], v127 offset:16384
  ds_read_b64_tr_b16 a[98:99], v127 offset:18432
  ds_read_b64_tr_b16 a[100:101], v127 offset:16392
  ds_read_b64_tr_b16 a[102:103], v127 offset:18440
  ds_read_b64_tr_b16 a[104:105], v128 offset:16384
  ds_read_b64_tr_b16 a[106:107], v128 offset:18432
  ds_read_b64_tr_b16 a[108:109], v128 offset:16392
  ds_read_b64_tr_b16 a[110:111], v128 offset:18440
  ds_read_b128 a[20:23], v124 offset:0
  ds_read_b128 a[24:27], v124 offset:2048
  ds_read_b128 a[28:31], v124 offset:4096
  ds_read_b128 a[32:35], v124 offset:6144
  ds_read_b128 a[36:39], v124 offset:8192
  s_waitcnt lgkmcnt(0)
  s_barrier
  s_add_u32 s75, s3, 3
  s_and_b32 s75, s75, 7
  s_lshl_b32 s72, s75, 19
  s_add_u32 s72, s72, s74
  s_add_u32 m0, s69, 16384
  s_add_u32 s77, s72, 0
  buffer_load_dwordx4 v120, s[36:39], s77 offen lds
  s_add_u32 m0, s69, 17408
  s_add_u32 s77, s72, 16384
  buffer_load_dwordx4 v121, s[36:39], s77 offen lds
  s_add_u32 m0, s69, 18432
  s_add_u32 s77, s72, 32768
  buffer_load_dwordx4 v120, s[36:39], s77 offen lds
  s_add_u32 m0, s69, 19456
  s_add_u32 s77, s72, 49152
  buffer_load_dwordx4 v121, s[36:39], s77 offen lds
  s_add_u32 m0, s69, 20480
  s_add_u32 s77, s72, 65536
  buffer_load_dwordx4 v120, s[36:39], s77 offen lds
  s_add_u32 m0, s69, 21504
  s_add_u32 s77, s72, 81920
  buffer_load_dwordx4 v121, s[36:39], s77 offen lds
  s_add_u32 m0, s69, 22528
  s_add_u32 s77, s72, 98304
  buffer_load_dwordx4 v120, s[36:39], s77 offen lds
  s_add_u32 m0, s69, 23552
  s_add_u32 s77, s72, 114688
  buffer_load_dwordx4 v121, s[36:39], s77 offen lds
  s_lshl_b32 s75, s75, 7
  s_lshl_b32 s72, s64, 10
  s_add_u32 m0, s72, 131072
  s_add_u32 s77, s76, 0
  s_add_u32 s77, s77, s75
  buffer_load_dwordx4 v122, s[32:35], s77 offen lds
  s_lshl_b32 s72, s64, 10
  s_add_u32 m0, s72, 135168
  s_add_u32 s77, s76, 32768
  s_add_u32 s77, s77, s75
  buffer_load_dwordx4 v122, s[32:35], s77 offen lds
  s_lshl_b32 s72, s100, 10
  s_add_u32 m0, s72, 131072
  s_lshl_b32 s77, s100, 13
  s_add_u32 s77, s77, s75
  buffer_load_dwordx4 v122, s[32:35], s77 offen lds
  s_waitcnt vmcnt(34)
  s_barrier
  v_mfma_f32_16x16x32_bf16 v[40:43], a[80:83], a[0:3], 0
  ds_read_b64_tr_b16 a[112:113], v125 offset:24576
  ds_read_b64_tr_b16 a[114:115], v125 offset:26624
  v_mfma_f32_16x16x32_bf16 v[60:63], a[84:87], a[0:3], 0
  ds_read_b64_tr_b16 a[116:117], v125 offset:24584
  v_mfma_f32_16x16x32_bf16 v[80:83], a[88:91], a[0:3], 0
  ds_read_b64_tr_b16 a[118:119], v125 offset:26632
  v_mfma_f32_16x16x32_bf16 v[100:103], a[92:95], a[0:3], 0
  ds_read_b64_tr_b16 a[120:121], v126 offset:24576
  ds_read_b64_tr_b16 a[122:123], v126 offset:26624
  v_mfma_f32_16x16x32_bf16 v[44:47], a[80:83], a[4:7], 0
  ds_read_b64_tr_b16 a[124:125], v126 offset:24584
  v_mfma_f32_16x16x32_bf16 v[64:67], a[84:87], a[4:7], 0
  ds_read_b64_tr_b16 a[126:127], v126 offset:26632
  v_mfma_f32_16x16x32_bf16 v[84:87], a[88:91], a[4:7], 0
  ds_read_b128 a[40:43], v123 offset:10240
  ds_read_b128 a[44:47], v123 offset:12288
  v_mfma_f32_16x16x32_bf16 v[104:107], a[92:95], a[4:7], 0
  ds_read_b128 a[48:51], v123 offset:14336
  v_mfma_f32_16x16x32_bf16 v[48:51], a[80:83], a[8:11], 0
  ds_read_b128 a[52:55], v123 offset:16384
  v_mfma_f32_16x16x32_bf16 v[68:71], a[84:87], a[8:11], 0
  ds_read_b128 a[56:59], v123 offset:18432
  v_mfma_f32_16x16x32_bf16 v[88:91], a[88:91], a[8:11], 0
  ds_read_b64_tr_b16 a[128:129], v127 offset:24576
  ds_read_b64_tr_b16 a[130:131], v127 offset:26624
  v_mfma_f32_16x16x32_bf16 v[108:111], a[92:95], a[8:11], 0
  ds_read_b64_tr_b16 a[132:133], v127 offset:24584
  v_mfma_f32_16x16x32_bf16 v[52:55], a[80:83], a[12:15], 0
  ds_read_b64_tr_b16 a[134:135], v127 offset:26632
  v_mfma_f32_16x16x32_bf16 v[72:75], a[84:87], a[12:15], 0
  ds_read_b64_tr_b16 a[136:137], v128 offset:24576
  ds_read_b64_tr_b16 a[138:139], v128 offset:26624
  v_mfma_f32_16x16x32_bf16 v[92:95], a[88:91], a[12:15], 0
  ds_read_b64_tr_b16 a[140:141], v128 offset:24584
  v_mfma_f32_16x16x32_bf16 v[112:115], a[92:95], a[12:15], 0
  ds_read_b64_tr_b16 a[142:143], v128 offset:26632
  v_mfma_f32_16x16x32_bf16 v[56:59], a[80:83], a[16:19], 0
  ds_read_b128 a[60:63], v124 offset:10240
  ds_read_b128 a[64:67], v124 offset:12288
  v_mfma_f32_16x16x32_bf16 v[76:79], a[84:87], a[16:19], 0
  ds_read_b128 a[68:71], v124 offset:14336
  v_mfma_f32_16x16x32_bf16 v[96:99], a[88:91], a[16:19], 0
  ds_read_b128 a[72:75], v124 offset:16384
  v_mfma_f32_16x16x32_bf16 v[116:119], a[92:95], a[16:19], 0
  ds_read_b128 a[76:79], v124 offset:18432
  s_waitcnt lgkmcnt(0)
  s_barrier
  v_mfma_f32_16x16x32_bf16 v[40:43], a[96:99], a[20:23], v[40:43]
  s_add_u32 s75, s3, 4
  s_and_b32 s75, s75, 7
  s_lshl_b32 s72, s75, 19
  v_mfma_f32_16x16x32_bf16 v[60:63], a[100:103], a[20:23], v[60:63]
  s_add_u32 s72, s72, s74
  s_add_u32 m0, s69, 24576
  v_mfma_f32_16x16x32_bf16 v[80:83], a[104:107], a[20:23], v[80:83]
  s_add_u32 s77, s72, 0
  buffer_load_dwordx4 v120, s[36:39], s77 offen lds
  v_mfma_f32_16x16x32_bf16 v[100:103], a[108:111], a[20:23], v[100:103]
  s_add_u32 m0, s69, 25600
  s_add_u32 s77, s72, 16384
  v_mfma_f32_16x16x32_bf16 v[44:47], a[96:99], a[24:27], v[44:47]
  buffer_load_dwordx4 v121, s[36:39], s77 offen lds
  s_add_u32 m0, s69, 26624
  v_mfma_f32_16x16x32_bf16 v[64:67], a[100:103], a[24:27], v[64:67]
  s_add_u32 s77, s72, 32768
  buffer_load_dwordx4 v120, s[36:39], s77 offen lds
  s_add_u32 m0, s69, 27648
  v_mfma_f32_16x16x32_bf16 v[84:87], a[104:107], a[24:27], v[84:87]
  s_add_u32 s77, s72, 49152
  buffer_load_dwordx4 v121, s[36:39], s77 offen lds
  v_mfma_f32_16x16x32_bf16 v[104:107], a[108:111], a[24:27], v[104:107]
  s_add_u32 m0, s69, 28672
  s_add_u32 s77, s72, 65536
  v_mfma_f32_16x16x32_bf16 v[48:51], a[96:99], a[28:31], v[48:51]
  buffer_load_dwordx4 v120, s[36:39], s77 offen lds
  s_add_u32 m0, s69, 29696
  v_mfma_f32_16x16x32_bf16 v[68:71], a[100:103], a[28:31], v[68:71]
  s_add_u32 s77, s72, 81920
  buffer_load_dwordx4 v121, s[36:39], s77 offen lds
  v_mfma_f32_16x16x32_bf16 v[88:91], a[104:107], a[28:31], v[88:91]
  s_add_u32 m0, s69, 30720
  s_add_u32 s77, s72, 98304
  buffer_load_dwordx4 v120, s[36:39], s77 offen lds
  v_mfma_f32_16x16x32_bf16 v[108:111], a[108:111], a[28:31], v[108:111]
  s_add_u32 m0, s69, 31744
  s_add_u32 s77, s72, 114688
  v_mfma_f32_16x16x32_bf16 v[52:55], a[96:99], a[32:35], v[52:55]
  buffer_load_dwordx4 v121, s[36:39], s77 offen lds
  s_lshl_b32 s75, s75, 7
  v_mfma_f32_16x16x32_bf16 v[72:75], a[100:103], a[32:35], v[72:75]
  s_lshl_b32 s72, s64, 10
  s_add_u32 m0, s72, 141312
  v_mfma_f32_16x16x32_bf16 v[92:95], a[104:107], a[32:35], v[92:95]
  s_add_u32 s77, s76, 0
  s_add_u32 s77, s77, s75
  v_mfma_f32_16x16x32_bf16 v[112:115], a[108:111], a[32:35], v[112:115]
  buffer_load_dwordx4 v122, s[32:35], s77 offen lds
  s_lshl_b32 s72, s64, 10
  s_add_u32 m0, s72, 145408
  v_mfma_f32_16x16x32_bf16 v[56:59], a[96:99], a[36:39], v[56:59]
  s_add_u32 s77, s76, 32768
  s_add_u32 s77, s77, s75
  v_mfma_f32_16x16x32_bf16 v[76:79], a[100:103], a[36:39], v[76:79]
  buffer_load_dwordx4 v122, s[32:35], s77 offen lds
  s_lshl_b32 s72, s100, 10
  v_mfma_f32_16x16x32_bf16 v[96:99], a[104:107], a[36:39], v[96:99]
  s_add_u32 m0, s72, 141312
  s_lshl_b32 s77, s100, 13
  v_mfma_f32_16x16x32_bf16 v[116:119], a[108:111], a[36:39], v[116:119]
  s_add_u32 s77, s77, s75
  buffer_load_dwordx4 v122, s[32:35], s77 offen lds
  s_waitcnt vmcnt(34)
  s_waitcnt vmcnt(26)
  s_barrier
  v_mfma_f32_16x16x32_bf16 v[40:43], a[112:115], a[40:43], v[40:43]
  ds_read_b64_tr_b16 a[80:81], v125 offset:8192
  ds_read_b64_tr_b16 a[82:83], v125 offset:10240
  v_mfma_f32_16x16x32_bf16 v[60:63], a[116:119], a[40:43], v[60:63]
  ds_read_b64_tr_b16 a[84:85], v125 offset:8200
  ds_read_b64_tr_b16 a[86:87], v125 offset:10248
  v_mfma_f32_16x16x32_bf16 v[80:83], a[120:123], a[40:43], v[80:83]
  ds_read_b64_tr_b16 a[88:89], v126 offset:8192
  ds_read_b64_tr_b16 a[90:91], v126 offset:10240
  v_mfma_f32_16x16x32_bf16 v[100:103], a[124:127], a[40:43], v[100:103]
  ds_read_b64_tr_b16 a[92:93], v126 offset:8200
  v_mfma_f32_16x16x32_bf16 v[44:47], a[112:115], a[44:47], v[44:47]
  ds_read_b64_tr_b16 a[94:95], v126 offset:10248
  ds_read_b128 a[0:3], v123 offset:20480
  v_mfma_f32_16x16x32_bf16 v[64:67], a[116:119], a[44:47], v[64:67]
  ds_read_b128 a[4:7], v123 offset:22528
  ds_read_b128 a[8:11], v123 offset:24576
  v_mfma_f32_16x16x32_bf16 v[84:87], a[120:123], a[44:47], v[84:87]
  ds_read_b128 a[12:15], v123 offset:26624
  v_mfma_f32_16x16x32_bf16 v[104:107], a[124:127], a[44:47], v[104:107]
  ds_read_b128 a[16:19], v123 offset:28672
  ds_read_b64_tr_b16 a[96:97], v127 offset:8192
  v_mfma_f32_16x16x32_bf16 v[48:51], a[112:115], a[48:51], v[48:51]
  ds_read_b64_tr_b16 a[98:99], v127 offset:10240
  ds_read_b64_tr_b16 a[100:101], v127 offset:8200
  v_mfma_f32_16x16x32_bf16 v[68:71], a[116:119], a[48:51], v[68:71]
  ds_read_b64_tr_b16 a[102:103], v127 offset:10248
  v_mfma_f32_16x16x32_bf16 v[88:91], a[120:123], a[48:51], v[88:91]
  ds_read_b64_tr_b16 a[104:105], v128 offset:8192
  ds_read_b64_tr_b16 a[106:107], v128 offset:10240
  v_mfma_f32_16x16x32_bf16 v[108:111], a[124:127], a[48:51], v[108:111]
  ds_read_b64_tr_b16 a[108:109], v128 offset:8200
  ds_read_b64_tr_b16 a[110:111], v128 offset:10248
  v_mfma_f32_16x16x32_bf16 v[52:55], a[112:115], a[52:55], v[52:55]
  ds_read_b128 a[20:23], v124 offset:20480
  ds_read_b128 a[24:27], v124 offset:22528
  v_mfma_f32_16x16x32_bf16 v[72:75], a[116:119], a[52:55], v[72:75]
  ds_read_b128 a[28:31], v124 offset:24576
  v_mfma_f32_16x16x32_bf16 v[92:95], a[120:123], a[52:55], v[92:95]
  ds_read_b128 a[32:35], v124 offset:26624
  ds_read_b128 a[36:39], v124 offset:28672
  v_mfma_f32_16x16x32_bf16 v[112:115], a[124:127], a[52:55], v[112:115]
  ds_read_b128 a[180:183], v8 offset:0
  ds_read_b128 a[184:187], v9 offset:0
  v_mfma_f32_16x16x32_bf16 v[56:59], a[112:115], a[56:59], v[56:59]
  ds_read_b128 a[188:191], v10 offset:0
  v_mfma_f32_16x16x32_bf16 v[76:79], a[116:119], a[56:59], v[76:79]
  ds_read_b128 a[192:195], v11 offset:0
  ds_read_b128 a[196:199], v8 offset:4096
  v_mfma_f32_16x16x32_bf16 v[96:99], a[120:123], a[56:59], v[96:99]
  ds_read_b128 a[200:203], v9 offset:4096
  ds_read_b128 a[204:207], v10 offset:4096
  v_mfma_f32_16x16x32_bf16 v[116:119], a[124:127], a[56:59], v[116:119]
  ds_read_b128 a[208:211], v11 offset:4096
  s_waitcnt lgkmcnt(0)
  s_barrier
  s_cmp_eq_u32 s66, 1
  s_cbranch_scc1 L_ry1
  s_add_u32 m0, s30, 0
  s_mov_b32 s77, 0
  buffer_load_dwordx4 v5, s[44:47], s77 offen offset:0  lds
  buffer_load_dwordx4 v6, s[44:47], s77 offen offset:1024  lds
  buffer_load_dwordx4 v5, s[44:47], s77 offen offset:2048  lds
  buffer_load_dwordx4 v6, s[44:47], s77 offen offset:3072  lds
  s_add_u32 m0, s30, 4096
  s_mov_b32 s77, 4096
  buffer_load_dwordx4 v5, s[44:47], s77 offen offset:0  lds
  buffer_load_dwordx4 v6, s[44:47], s77 offen offset:1024  lds
  buffer_load_dwordx4 v5, s[44:47], s77 offen offset:2048  lds
  buffer_load_dwordx4 v6, s[44:47], s77 offen offset:3072  lds
  s_branch L_re1
L_ry1:
  s_lshl_b32 s72, s67, 12
  s_add_u32 s72, s72, s101
  s_add_u32 s77, s72, 0
  buffer_load_dwordx4 v[248:251], v24, s[48:51], s77 offen
  s_add_u32 s77, s72, 32768
  buffer_load_dwordx4 v[248:251], v24, s[48:51], s77 offen
  s_add_u32 s77, s72, 65536
  buffer_load_dwordx4 v[248:251], v24, s[48:51], s77 offen
  s_add_u32 s77, s72, 98304
  buffer_load_dwordx4 v[248:251], v24, s[48:51], s77 offen
  s_add_u32 s77, s72, 131072
  buffer_load_dwordx4 v[248:251], v24, s[48:51], s77 offen
  s_add_u32 s77, s72, 163840
  buffer_load_dwordx4 v[248:251], v24, s[48:51], s77 offen
  s_add_u32 s77, s72, 196608
  buffer_load_dwordx4 v[248:251], v24, s[48:51], s77 offen
  s_add_u32 s77, s72, 229376
  buffer_load_dwordx4 v[248:251], v24, s[48:51], s77 offen
L_re1:
  v_mfma_f32_16x16x32_bf16 v[40:43], a[128:131], a[60:63], v[40:43]
  s_add_u32 s75, s3, 5
  s_and_b32 s75, s75, 7
  s_lshl_b32 s72, s75, 19
  v_mfma_f32_16x16x32_bf16 v[60:63], a[132:135], a[60:63], v[60:63]
  s_add_u32 s72, s72, s74
  s_add_u32 m0, s69, 8192
  v_mfma_f32_16x16x32_bf16 v[80:83], a[136:139], a[60:63], v[80:83]
  s_add_u32 s77, s72, 0
  buffer_load_dwordx4 v120, s[36:39], s77 offen lds
  v_mfma_f32_16x16x32_bf16 v[100:103], a[140:143], a[60:63], v[100:103]
  s_add_u32 m0, s69, 9216
  s_add_u32 s77, s72, 16384
  v_mfma_f32_16x16x32_bf16 v[44:47], a[128:131], a[64:67], v[44:47]
  buffer_load_dwordx4 v121, s[36:39], s77 offen lds
  s_add_u32 m0, s69, 10240
  v_mfma_f32_16x16x32_bf16 v[64:67], a[132:135], a[64:67], v[64:67]
  s_add_u32 s77, s72, 32768
  buffer_load_dwordx4 v120, s[36:39], s77 offen lds
  s_add_u32 m0, s69, 11264
  v_mfma_f32_16x16x32_bf16 v[84:87], a[136:139], a[64:67], v[84:87]
  s_add_u32 s77, s72, 49152
  buffer_load_dwordx4 v121, s[36:39], s77 offen lds
  v_mfma_f32_16x16x32_bf16 v[104:107], a[140:143], a[64:67], v[104:107]
  s_add_u32 m0, s69, 12288
  s_add_u32 s77, s72, 65536
  v_mfma_f32_16x16x32_bf16 v[48:51], a[128:131], a[68:71], v[48:51]
  buffer_load_dwordx4 v120, s[36:39], s77 offen lds
  s_add_u32 m0, s69, 13312
  v_mfma_f32_16x16x32_bf16 v[68:71], a[132:135], a[68:71], v[68:71]
  s_add_u32 s77, s72, 81920
  buffer_load_dwordx4 v121, s[36:39], s77 offen lds
  v_mfma_f32_16x16x32_bf16 v[88:91], a[136:139], a[68:71], v[88:91]
  s_add_u32 m0, s69, 14336
  s_add_u32 s77, s72, 98304
  buffer_load_dwordx4 v120, s[36:39], s77 offen lds
  v_mfma_f32_16x16x32_bf16 v[108:111], a[140:143], a[68:71], v[108:111]
  s_add_u32 m0, s69, 15360
  s_add_u32 s77, s72, 114688
  v_mfma_f32_16x16x32_bf16 v[52:55], a[128:131], a[72:75], v[52:55]
  buffer_load_dwordx4 v121, s[36:39], s77 offen lds
  s_lshl_b32 s75, s75, 7
  v_mfma_f32_16x16x32_bf16 v[72:75], a[132:135], a[72:75], v[72:75]
  s_lshl_b32 s72, s64, 10
  s_add_u32 m0, s72, 151552
  v_mfma_f32_16x16x32_bf16 v[92:95], a[136:139], a[72:75], v[92:95]
  s_add_u32 s77, s76, 0
  s_add_u32 s77, s77, s75
  v_mfma_f32_16x16x32_bf16 v[112:115], a[140:143], a[72:75], v[112:115]
  buffer_load_dwordx4 v122, s[32:35], s77 offen lds
  s_lshl_b32 s72, s64, 10
  s_add_u32 m0, s72, 155648
  v_mfma_f32_16x16x32_bf16 v[56:59], a[128:131], a[76:79], v[56:59]
  s_add_u32 s77, s76, 32768
  s_add_u32 s77, s77, s75
  v_mfma_f32_16x16x32_bf16 v[76:79], a[132:135], a[76:79], v[76:79]
  buffer_load_dwordx4 v122, s[32:35], s77 offen lds
  s_lshl_b32 s72, s100, 10
  v_mfma_f32_16x16x32_bf16 v[96:99], a[136:139], a[76:79], v[96:99]
  s_add_u32 m0, s72, 151552
  s_lshl_b32 s77, s100, 13
  v_mfma_f32_16x16x32_bf16 v[116:119], a[140:143], a[76:79], v[116:119]
  s_add_u32 s77, s77, s75
  buffer_load_dwordx4 v122, s[32:35], s77 offen lds
  s_waitcnt vmcnt(30)
  s_barrier
  v_mfma_f32_16x16x32_bf16 v[40:43], a[80:83], a[0:3], v[40:43]
  ds_read_b64_tr_b16 a[112:113], v125 offset:16384
  ds_read_b64_tr_b16 a[114:115], v125 offset:18432
  v_mfma_f32_16x16x32_bf16 v[60:63], a[84:87], a[0:3], v[60:63]
  ds_read_b64_tr_b16 a[116:117], v125 offset:16392
  v_mfma_f32_16x16x32_bf16 v[80:83], a[88:91], a[0:3], v[80:83]
  ds_read_b64_tr_b16 a[118:119], v125 offset:18440
  v_mfma_f32_16x16x32_bf16 v[100:103], a[92:95], a[0:3], v[100:103]
  ds_read_b64_tr_b16 a[120:121], v126 offset:16384
  ds_read_b64_tr_b16 a[122:123], v126 offset:18432
  v_mfma_f32_16x16x32_bf16 v[44:47], a[80:83], a[4:7], v[44:47]
  ds_read_b64_tr_b16 a[124:125], v126 offset:16392
  v_mfma_f32_16x16x32_bf16 v[64:67], a[84:87], a[4:7], v[64:67]
  ds_read_b64_tr_b16 a[126:127], v126 offset:18440
  v_mfma_f32_16x16x32_bf16 v[84:87], a[88:91], a[4:7], v[84:87]
  ds_read_b128 a[40:43], v123 offset:0
  ds_read_b128 a[44:47], v123 offset:2048
  v_mfma_f32_16x16x32_bf16 v[104:107], a[92:95], a[4:7], v[104:107]
  ds_read_b128 a[48:51], v123 offset:4096
  v_mfma_f32_16x16x32_bf16 v[48:51], a[80:83], a[8:11], v[48:51]
  ds_read_b128 a[52:55], v123 offset:6144
  v_mfma_f32_16x16x32_bf16 v[68:71], a[84:87], a[8:11], v[68:71]
  ds_read_b128 a[56:59], v123 offset:8192
  v_mfma_f32_16x16x32_bf16 v[88:91], a[88:91], a[8:11], v[88:91]
  ds_read_b64_tr_b16 a[128:129], v127 offset:16384
  ds_read_b64_tr_b16 a[130:131], v127 offset:18432
  v_mfma_f32_16x16x32_bf16 v[108:111], a[92:95], a[8:11], v[108:111]
  ds_read_b64_tr_b16 a[132:133], v127 offset:16392
  v_mfma_f32_16x16x32_bf16 v[52:55], a[80:83], a[12:15], v[52:55]
  ds_read_b64_tr_b16 a[134:135], v127 offset:18440
  v_mfma_f32_16x16x32_bf16 v[72:75], a[84:87], a[12:15], v[72:75]
  ds_read_b64_tr_b16 a[136:137], v128 offset:16384
  ds_read_b64_tr_b16 a[138:139], v128 offset:18432
  v_mfma_f32_16x16x32_bf16 v[92:95], a[88:91], a[12:15], v[92:95]
  ds_read_b64_tr_b16 a[140:141], v128 offset:16392
  v_mfma_f32_16x16x32_bf16 v[112:115], a[92:95], a[12:15], v[112:115]
  ds_read_b64_tr_b16 a[142:143], v128 offset:18440
  v_mfma_f32_16x16x32_bf16 v[56:59], a[80:83], a[16:19], v[56:59]
  ds_read_b128 a[60:63], v124 offset:0
  ds_read_b128 a[64:67], v124 offset:2048
  v_mfma_f32_16x16x32_bf16 v[76:79], a[84:87], a[16:19], v[76:79]
  ds_read_b128 a[68:71], v124 offset:4096
  v_mfma_f32_16x16x32_bf16 v[96:99], a[88:91], a[16:19], v[96:99]
  ds_read_b128 a[72:75], v124 offset:6144
  v_mfma_f32_16x16x32_bf16 v[116:119], a[92:95], a[16:19], v[116:119]
  ds_read_b128 a[76:79], v124 offset:8192
  s_waitcnt lgkmcnt(0)
  s_barrier
  v_mfma_f32_16x16x32_bf16 v[40:43], a[96:99], a[20:23], v[40:43]
  s_add_u32 s75, s3, 6
  s_and_b32 s75, s75, 7
  s_lshl_b32 s72, s75, 19
  v_mfma_f32_16x16x32_bf16 v[60:63], a[100:103], a[20:23], v[60:63]
  s_add_u32 s72, s72, s74
  s_add_u32 m0, s69, 16384
  v_mfma_f32_16x16x32_bf16 v[80:83], a[104:107], a[20:23], v[80:83]
  s_add_u32 s77, s72, 0
  buffer_load_dwordx4 v120, s[36:39], s77 offen lds
  v_mfma_f32_16x16x32_bf16 v[100:103], a[108:111], a[20:23], v[100:103]
  s_add_u32 m0, s69, 17408
  s_add_u32 s77, s72, 16384
  v_mfma_f32_16x16x32_bf16 v[44:47], a[96:99], a[24:27], v[44:47]
  buffer_load_dwordx4 v121, s[36:39], s77 offen lds
  s_add_u32 m0, s69, 18432
  v_mfma_f32_16x16x32_bf16 v[64:67], a[100:103], a[24:27], v[64:67]
  s_add_u32 s77, s72, 32768
  buffer_load_dwordx4 v120, s[36:39], s77 offen lds
  s_add_u32 m0, s69, 19456
  v_mfma_f32_16x16x32_bf16 v[84:87], a[104:107], a[24:27], v[84:87]
  s_add_u32 s77, s72, 49152
  buffer_load_dwordx4 v121, s[36:39], s77 offen lds
  v_mfma_f32_16x16x32_bf16 v[104:107], a[108:111], a[24:27], v[104:107]
  s_add_u32 m0, s69, 20480
  s_add_u32 s77, s72, 65536
  v_mfma_f32_16x16x32_bf16 v[48:51], a[96:99], a[28:31], v[48:51]
  buffer_load_dwordx4 v120, s[36:39], s77 offen lds
  s_add_u32 m0, s69, 21504
  v_mfma_f32_16x16x32_bf16 v[68:71], a[100:103], a[28:31], v[68:71]
  s_add_u32 s77, s72, 81920
  buffer_load_dwordx4 v121, s[36:39], s77 offen lds
  v_mfma_f32_16x16x32_bf16 v[88:91], a[104:107], a[28:31], v[88:91]
  s_add_u32 m0, s69, 22528
  s_add_u32 s77, s72, 98304
  buffer_load_dwordx4 v120, s[36:39], s77 offen lds
  v_mfma_f32_16x16x32_bf16 v[108:111], a[108:111], a[28:31], v[108:111]
  s_add_u32 m0, s69, 23552
  s_add_u32 s77, s72, 114688
  v_mfma_f32_16x16x32_bf16 v[52:55], a[96:99], a[32:35], v[52:55]
  buffer_load_dwordx4 v121, s[36:39], s77 offen lds
  s_lshl_b32 s75, s75, 7
  v_mfma_f32_16x16x32_bf16 v[72:75], a[100:103], a[32:35], v[72:75]
  s_lshl_b32 s72, s64, 10
  s_add_u32 m0, s72, 131072
  v_mfma_f32_16x16x32_bf16 v[92:95], a[104:107], a[32:35], v[92:95]
  s_add_u32 s77, s76, 0
  s_add_u32 s77, s77, s75
  v_mfma_f32_16x16x32_bf16 v[112:115], a[108:111], a[32:35], v[112:115]
  buffer_load_dwordx4 v122, s[32:35], s77 offen lds
  s_lshl_b32 s72, s64, 10
  s_add_u32 m0, s72, 135168
  v_mfma_f32_16x16x32_bf16 v[56:59], a[96:99], a[36:39], v[56:59]
  s_add_u32 s77, s76, 32768
  s_add_u32 s77, s77, s75
  v_mfma_f32_16x16x32_bf16 v[76:79], a[100:103], a[36:39], v[76:79]
  buffer_load_dwordx4 v122, s[32:35], s77 offen lds
  s_lshl_b32 s72, s100, 10
  v_mfma_f32_16x16x32_bf16 v[96:99], a[104:107], a[36:39], v[96:99]
  s_add_u32 m0, s72, 131072
  s_lshl_b32 s77, s100, 13
  v_mfma_f32_16x16x32_bf16 v[116:119], a[108:111], a[36:39], v[116:119]
  s_add_u32 s77, s77, s75
  buffer_load_dwordx4 v122, s[32:35], s77 offen lds
  s_waitcnt vmcnt(30)
  s_barrier
  v_mfma_f32_16x16x32_bf16 v[40:43], a[112:115], a[40:43], v[40:43]
  ds_read_b64_tr_b16 a[80:81], v125 offset:24576
  ds_read_b64_tr_b16 a[82:83], v125 offset:26624
  v_mfma_f32_16x16x32_bf16 v[60:63], a[116:119], a[40:43], v[60:63]
  ds_read_b64_tr_b16 a[84:85], v125 offset:24584
  v_mfma_f32_16x16x32_bf16 v[80:83], a[120:123], a[40:43], v[80:83]
  ds_read_b64_tr_b16 a[86:87], v125 offset:26632
  v_mfma_f32_16x16x32_bf16 v[100:103], a[124:127], a[40:43], v[100:103]
  ds_read_b64_tr_b16 a[88:89], v126 offset:24576
  ds_read_b64_tr_b16 a[90:91], v126 offset:26624
  v_mfma_f32_16x16x32_bf16 v[44:47], a[112:115], a[44:47], v[44:47]
  ds_read_b64_tr_b16 a[92:93], v126 offset:24584
  v_mfma_f32_16x16x32_bf16 v[64:67], a[116:119], a[44:47], v[64:67]
  ds_read_b64_tr_b16 a[94:95], v126 offset:26632
  v_mfma_f32_16x16x32_bf16 v[84:87], a[120:123], a[44:47], v[84:87]
  ds_read_b128 a[0:3], v123 offset:10240
  ds_read_b128 a[4:7], v123 offset:12288
  v_mfma_f32_16x16x32_bf16 v[104:107], a[124:127], a[44:47], v[104:107]
  ds_read_b128 a[8:11], v123 offset:14336
  v_mfma_f32_16x16x32_bf16 v[48:51], a[112:115], a[48:51], v[48:51]
  ds_read_b128 a[12:15], v123 offset:16384
  v_mfma_f32_16x16x32_bf16 v[68:71], a[116:119], a[48:51], v[68:71]
  ds_read_b128 a[16:19], v123 offset:18432
  v_mfma_f32_16x16x32_bf16 v[88:91], a[120:123], a[48:51], v[88:91]
  ds_read_b64_tr_b16 a[96:97], v127 offset:24576
  ds_read_b64_tr_b16 a[98:99], v127 offset:26624
  v_mfma_f32_16x16x32_bf16 v[108:111], a[124:127], a[48:51], v[108:111]
  ds_read_b64_tr_b16 a[100:101], v127 offset:24584
  v_mfma_f32_16x16x32_bf16 v[52:55], a[112:115], a[52:55], v[52:55]
  ds_read_b64_tr_b16 a[102:103], v127 offset:26632
  v_mfma_f32_16x16x32_bf16 v[72:75], a[116:119], a[52:55], v[72:75]
  ds_read_b64_tr_b16 a[104:105], v128 offset:24576
  ds_read_b64_tr_b16 a[106:107], v128 offset:26624
  v_mfma_f32_16x16x32_bf16 v[92:95], a[120:123], a[52:55], v[92:95]
  ds_read_b64_tr_b16 a[108:109], v128 offset:24584
  v_mfma_f32_16x16x32_bf16 v[112:115], a[124:127], a[52:55], v[112:115]
  ds_read_b64_tr_b16 a[110:111], v128 offset:26632
  v_mfma_f32_16x16x32_bf16 v[56:59], a[112:115], a[56:59], v[56:59]
  ds_read_b128 a[20:23], v124 offset:10240
  ds_read_b128 a[24:27], v124 offset:12288
  v_mfma_f32_16x16x32_bf16 v[76:79], a[116:119], a[56:59], v[76:79]
  ds_read_b128 a[28:31], v124 offset:14336
  v_mfma_f32_16x16x32_bf16 v[96:99], a[120:123], a[56:59], v[96:99]
  ds_read_b128 a[32:35], v124 offset:16384
  v_mfma_f32_16x16x32_bf16 v[116:119], a[124:127], a[56:59], v[116:119]
  ds_read_b128 a[36:39], v124 offset:18432
  s_waitcnt lgkmcnt(0)
  s_barrier
  v_mfma_f32_16x16x32_bf16 v[40:43], a[128:131], a[60:63], v[40:43]
  s_add_u32 s75, s3, 7
  s_and_b32 s75, s75, 7
  s_lshl_b32 s72, s75, 19
  v_mfma_f32_16x16x32_bf16 v[60:63], a[132:135], a[60:63], v[60:63]
  s_add_u32 s72, s72, s74
  s_add_u32 m0, s69, 24576
  v_mfma_f32_16x16x32_bf16 v[80:83], a[136:139], a[60:63], v[80:83]
  s_add_u32 s77, s72, 0
  buffer_load_dwordx4 v120, s[36:39], s77 offen lds
  v_mfma_f32_16x16x32_bf16 v[100:103], a[140:143], a[60:63], v[100:103]
  s_add_u32 m0, s69, 25600
  s_add_u32 s77, s72, 16384
  v_mfma_f32_16x16x32_bf16 v[44:47], a[128:131], a[64:67], v[44:47]
  buffer_load_dwordx4 v121, s[36:39], s77 offen lds
  s_add_u32 m0, s69, 26624
  v_mfma_f32_16x16x32_bf16 v[64:67], a[132:135], a[64:67], v[64:67]
  s_add_u32 s77, s72, 32768
  buffer_load_dwordx4 v120, s[36:39], s77 offen lds
  s_add_u32 m0, s69, 27648
  v_mfma_f32_16x16x32_bf16 v[84:87], a[136:139], a[64:67], v[84:87]
  s_add_u32 s77, s72, 49152
  buffer_load_dwordx4 v121, s[36:39], s77 offen lds
  v_mfma_f32_16x16x32_bf16 v[104:107], a[140:143], a[64:67], v[104:107]
  s_add_u32 m0, s69, 28672
  s_add_u32 s77, s72, 65536
  v_mfma_f32_16x16x32_bf16 v[48:51], a[128:131], a[68:71], v[48:51]
  buffer_load_dwordx4 v120, s[36:39], s77 offen lds
  s_add_u32 m0, s69, 29696
  v_mfma_f32_16x16x32_bf16 v[68:71], a[132:135], a[68:71], v[68:71]
  s_add_u32 s77, s72, 81920
  buffer_load_dwordx4 v121, s[36:39], s77 offen lds
  v_mfma_f32_16x16x32_bf16 v[88:91], a[136:139], a[68:71], v[88:91]
  s_add_u32 m0, s69, 30720
  s_add_u32 s77, s72, 98304
  buffer_load_dwordx4 v120, s[36:39], s77 offen lds
  v_mfma_f32_16x16x32_bf16 v[108:111], a[140:143], a[68:71], v[108:111]
  s_add_u32 m0, s69, 31744
  s_add_u32 s77, s72, 114688
  v_mfma_f32_16x16x32_bf16 v[52:55], a[128:131], a[72:75], v[52:55]
  buffer_load_dwordx4 v121, s[36:39], s77 offen lds
  s_lshl_b32 s75, s75, 7
  v_mfma_f32_16x16x32_bf16 v[72:75], a[132:135], a[72:75], v[72:75]
  s_lshl_b32 s72, s64, 10
  s_add_u32 m0, s72, 141312
  v_mfma_f32_16x16x32_bf16 v[92:95], a[136:139], a[72:75], v[92:95]
  s_add_u32 s77, s76, 0
  s_add_u32 s77, s77, s75
  v_mfma_f32_16x16x32_bf16 v[112:115], a[140:143], a[72:75], v[112:115]
  buffer_load_dwordx4 v122, s[32:35], s77 offen lds
  s_lshl_b32 s72, s64, 10
  s_add_u32 m0, s72, 145408
  v_mfma_f32_16x16x32_bf16 v[56:59], a[128:131], a[76:79], v[56:59]
  s_add_u32 s77, s76, 32768
  s_add_u32 s77, s77, s75
  v_mfma_f32_16x16x32_bf16 v[76:79], a[132:135], a[76:79], v[76:79]
  buffer_load_dwordx4 v122, s[32:35], s77 offen lds
  s_lshl_b32 s72, s100, 10
  v_mfma_f32_16x16x32_bf16 v[96:99], a[136:139], a[76:79], v[96:99]
  s_add_u32 m0, s72, 141312
  s_lshl_b32 s77, s100, 13
  v_mfma_f32_16x16x32_bf16 v[116:119], a[140:143], a[76:79], v[116:119]
  s_add_u32 s77, s77, s75
  buffer_load_dwordx4 v122, s[32:35], s77 offen lds
  s_waitcnt vmcnt(22)
  s_barrier
  v_mfma_f32_16x16x32_bf16 v[40:43], a[80:83], a[0:3], v[40:43]
  ds_read_b64_tr_b16 a[112:113], v125 offset:8192
  ds_read_b64_tr_b16 a[114:115], v125 offset:10240
  ds_read_b64_tr_b16 a[116:117], v125 offset:8200
  v_mfma_f32_16x16x32_bf16 v[60:63], a[84:87], a[0:3], v[60:63]
  ds_read_b64_tr_b16 a[118:119], v125 offset:10248
  ds_read_b64_tr_b16 a[120:121], v126 offset:8192
  v_mfma_f32_16x16x32_bf16 v[80:83], a[88:91], a[0:3], v[80:83]
  ds_read_b64_tr_b16 a[122:123], v126 offset:10240
  ds_read_b64_tr_b16 a[124:125], v126 offset:8200
  v_mfma_f32_16x16x32_bf16 v[100:103], a[92:95], a[0:3], v[100:103]
  ds_read_b64_tr_b16 a[126:127], v126 offset:10248
  ds_read_b128 a[40:43], v123 offset:20480
  v_mfma_f32_16x16x32_bf16 v[44:47], a[80:83], a[4:7], v[44:47]
  ds_read_b128 a[44:47], v123 offset:22528
  ds_read_b128 a[48:51], v123 offset:24576
  v_mfma_f32_16x16x32_bf16 v[64:67], a[84:87], a[4:7], v[64:67]
  ds_read_b128 a[52:55], v123 offset:26624
  ds_read_b128 a[56:59], v123 offset:28672
  v_mfma_f32_16x16x32_bf16 v[84:87], a[88:91], a[4:7], v[84:87]
  ds_read_b64_tr_b16 a[128:129], v127 offset:8192
  ds_read_b64_tr_b16 a[130:131], v127 offset:10240
  v_mfma_f32_16x16x32_bf16 v[104:107], a[92:95], a[4:7], v[104:107]
  ds_read_b64_tr_b16 a[132:133], v127 offset:8200
  ds_read_b64_tr_b16 a[134:135], v127 offset:10248
  v_mfma_f32_16x16x32_bf16 v[48:51], a[80:83], a[8:11], v[48:51]
  ds_read_b64_tr_b16 a[136:137], v128 offset:8192
  ds_read_b64_tr_b16 a[138:139], v128 offset:10240
  v_mfma_f32_16x16x32_bf16 v[68:71], a[84:87], a[8:11], v[68:71]
  ds_read_b64_tr_b16 a[140:141], v128 offset:8200
  ds_read_b64_tr_b16 a[142:143], v128 offset:10248
  v_mfma_f32_16x16x32_bf16 v[88:91], a[88:91], a[8:11], v[88:91]
  ds_read_b128 a[60:63], v124 offset:20480
  ds_read_b128 a[64:67], v124 offset:22528
  ds_read_b128 a[68:71], v124 offset:24576
  v_mfma_f32_16x16x32_bf16 v[108:111], a[92:95], a[8:11], v[108:111]
  ds_read_b128 a[72:75], v124 offset:26624
  ds_read_b128 a[76:79], v124 offset:28672
  v_mfma_f32_16x16x32_bf16 v[52:55], a[80:83], a[12:15], v[52:55]
  ds_read_b64_tr_b16 v[144:145], v12 offset:0
  ds_read_b64_tr_b16 v[146:147], v12 offset:4096
  v_mfma_f32_16x16x32_bf16 v[72:75], a[84:87], a[12:15], v[72:75]
  ds_read_b64_tr_b16 v[148:149], v13 offset:0
  ds_read_b64_tr_b16 v[150:151], v13 offset:4096
  v_mfma_f32_16x16x32_bf16 v[92:95], a[88:91], a[12:15], v[92:95]
  ds_read_b64_tr_b16 v[152:153], v14 offset:0
  ds_read_b64_tr_b16 v[154:155], v14 offset:4096
  v_mfma_f32_16x16x32_bf16 v[112:115], a[92:95], a[12:15], v[112:115]
  ds_read_b64_tr_b16 v[156:157], v15 offset:0
  ds_read_b64_tr_b16 v[158:159], v15 offset:4096
  v_mfma_f32_16x16x32_bf16 v[56:59], a[80:83], a[16:19], v[56:59]
  ds_read_b64_tr_b16 v[160:161], v16 offset:0
  ds_read_b64_tr_b16 v[162:163], v16 offset:4096
  v_mfma_f32_16x16x32_bf16 v[76:79], a[84:87], a[16:19], v[76:79]
  ds_read_b64_tr_b16 v[164:165], v17 offset:0
  ds_read_b64_tr_b16 v[166:167], v17 offset:4096
  v_mfma_f32_16x16x32_bf16 v[96:99], a[88:91], a[16:19], v[96:99]
  ds_read_b64_tr_b16 v[168:169], v18 offset:0
  ds_read_b64_tr_b16 v[170:171], v18 offset:4096
  v_mfma_f32_16x16x32_bf16 v[116:119], a[92:95], a[16:19], v[116:119]
  ds_read_b64_tr_b16 v[172:173], v19 offset:0
  ds_read_b64_tr_b16 v[174:175], v19 offset:4096
  s_waitcnt lgkmcnt(0)
  s_barrier
  s_cmp_eq_u32 s66, 1
  s_cbranch_scc1 L_ry2
  s_add_u32 m0, s30, 0
  s_mov_b32 s77, 8192
  buffer_load_dwordx4 v1, s[40:43], s77 offen offset:0  lds
  buffer_load_dwordx4 v2, s[40:43], s77 offen offset:1024  lds
  buffer_load_dwordx4 v3, s[40:43], s77 offen offset:2048  lds
  buffer_load_dwordx4 v4, s[40:43], s77 offen offset:3072  lds
  s_add_u32 m0, s30, 4096
  s_mov_b32 s77, 12288
  buffer_load_dwordx4 v1, s[40:43], s77 offen offset:0  lds
  buffer_load_dwordx4 v2, s[40:43], s77 offen offset:1024  lds
  buffer_load_dwordx4 v3, s[40:43], s77 offen offset:2048  lds
  buffer_load_dwordx4 v4, s[40:43], s77 offen offset:3072  lds
  s_add_u32 m0, s30, 8192
  s_mov_b32 s77, 8192
  buffer_load_dwordx4 v5, s[44:47], s77 offen offset:0  lds
  buffer_load_dwordx4 v6, s[44:47], s77 offen offset:1024  lds
  buffer_load_dwordx4 v5, s[44:47], s77 offen offset:2048  lds
  buffer_load_dwordx4 v6, s[44:47], s77 offen offset:3072  lds
  s_add_u32 m0, s30, 12288
  s_mov_b32 s77, 12288
  buffer_load_dwordx4 v5, s[44:47], s77 offen offset:0  lds
  buffer_load_dwordx4 v6, s[44:47], s77 offen offset:1024  lds
  buffer_load_dwordx4 v5, s[44:47], s77 offen offset:2048  lds
  buffer_load_dwordx4 v6, s[44:47], s77 offen offset:3072  lds
  s_branch L_re2
L_ry2:
  s_add_u32 m0, s13, 8192
  s_add_u32 s77, s12, 8192
  buffer_load_dwordx4 v1, s[40:43], s77 offen offset:0  lds
  buffer_load_dwordx4 v2, s[40:43], s77 offen offset:1024  lds
  buffer_load_dwordx4 v3, s[40:43], s77 offen offset:2048  lds
  buffer_load_dwordx4 v4, s[40:43], s77 offen offset:3072  lds
  s_add_u32 m0, s14, 8192
  s_add_u32 s77, s12, 8192
  buffer_load_dwordx4 v5, s[44:47], s77 offen offset:0  lds
  buffer_load_dwordx4 v6, s[44:47], s77 offen offset:1024  lds
  buffer_load_dwordx4 v5, s[44:47], s77 offen offset:2048  lds
  buffer_load_dwordx4 v6, s[44:47], s77 offen offset:3072  lds
  s_add_u32 m0, s13, 0
  s_add_u32 s77, s12, 16384
  buffer_load_dwordx4 v1, s[40:43], s77 offen offset:0  lds
  buffer_load_dwordx4 v2, s[40:43], s77 offen offset:1024  lds
  buffer_load_dwordx4 v3, s[40:43], s77 offen offset:2048  lds
  buffer_load_dwordx4 v4, s[40:43], s77 offen offset:3072  lds
  s_lshl_b32 s72, s67, 12
  s_add_u32 s72, s72, s101
  s_add_u32 s77, s72, 131072
  buffer_load_dwordx4 v[248:251], v24, s[24:27], s77 offen
  s_add_u32 s77, s72, 0
  buffer_load_dwordx4 v[248:251], v24, s[24:27], s77 offen
  s_add_u32 s77, s72, 32768
  buffer_load_dwordx4 v[248:251], v24, s[24:27], s77 offen
  s_add_u32 s77, s72, 65536
  buffer_load_dwordx4 v[248:251], v24, s[24:27], s77 offen
L_re2:
  v_mfma_f32_16x16x32_bf16 v[40:43], a[96:99], a[20:23], v[40:43]
  v_mfma_f32_16x16x32_bf16 v[60:63], a[100:103], a[20:23], v[60:63]
  v_mfma_f32_16x16x32_bf16 v[80:83], a[104:107], a[20:23], v[80:83]
  v_mfma_f32_16x16x32_bf16 v[100:103], a[108:111], a[20:23], v[100:103]
  v_mfma_f32_16x16x32_bf16 v[44:47], a[96:99], a[24:27], v[44:47]
  v_mfma_f32_16x16x32_bf16 v[64:67], a[100:103], a[24:27], v[64:67]
  v_mfma_f32_16x16x32_bf16 v[84:87], a[104:107], a[24:27], v[84:87]
  v_mfma_f32_16x16x32_bf16 v[104:107], a[108:111], a[24:27], v[104:107]
  v_mfma_f32_16x16x32_bf16 v[48:51], a[96:99], a[28:31], v[48:51]
  v_mfma_f32_16x16x32_bf16 v[68:71], a[100:103], a[28:31], v[68:71]
  v_mfma_f32_16x16x32_bf16 v[88:91], a[104:107], a[28:31], v[88:91]
  v_mfma_f32_16x16x32_bf16 v[108:111], a[108:111], a[28:31], v[108:111]
  v_mfma_f32_16x16x32_bf16 v[52:55], a[96:99], a[32:35], v[52:55]
  v_mfma_f32_16x16x32_bf16 v[72:75], a[100:103], a[32:35], v[72:75]
  v_mfma_f32_16x16x32_bf16 v[92:95], a[104:107], a[32:35], v[92:95]
  v_mfma_f32_16x16x32_bf16 v[112:115], a[108:111], a[32:35], v[112:115]
  v_mfma_f32_16x16x32_bf16 v[56:59], a[96:99], a[36:39], v[56:59]
  v_mfma_f32_16x16x32_bf16 v[76:79], a[100:103], a[36:39], v[76:79]
  v_mfma_f32_16x16x32_bf16 v[96:99], a[104:107], a[36:39], v[96:99]
  v_mfma_f32_16x16x32_bf16 v[116:119], a[108:111], a[36:39], v[116:119]
  s_waitcnt vmcnt(27)
  s_barrier
  v_mfma_f32_16x16x32_bf16 v[40:43], a[112:115], a[40:43], v[40:43]
  ds_read_b64_tr_b16 a[80:81], v125 offset:16384
  ds_read_b64_tr_b16 a[82:83], v125 offset:18432
  v_mfma_f32_16x16x32_bf16 v[60:63], a[116:119], a[40:43], v[60:63]
  ds_read_b64_tr_b16 a[84:85], v125 offset:16392
  v_mfma_f32_16x16x32_bf16 v[80:83], a[120:123], a[40:43], v[80:83]
  ds_read_b64_tr_b16 a[86:87], v125 offset:18440
  v_mfma_f32_16x16x32_bf16 v[100:103], a[124:127], a[40:43], v[100:103]
  ds_read_b64_tr_b16 a[88:89], v126 offset:16384
  ds_read_b64_tr_b16 a[90:91], v126 offset:18432
  v_mfma_f32_16x16x32_bf16 v[44:47], a[112:115], a[44:47], v[44:47]
  ds_read_b64_tr_b16 a[92:93], v126 offset:16392
  v_mfma_f32_16x16x32_bf16 v[64:67], a[116:119], a[44:47], v[64:67]
  ds_read_b64_tr_b16 a[94:95], v126 offset:18440
  v_mfma_f32_16x16x32_bf16 v[84:87], a[120:123], a[44:47], v[84:87]
  ds_read_b128 a[0:3], v123 offset:0
  ds_read_b128 a[4:7], v123 offset:2048
  v_mfma_f32_16x16x32_bf16 v[104:107], a[124:127], a[44:47], v[104:107]
  ds_read_b128 a[8:11], v123 offset:4096
  v_mfma_f32_16x16x32_bf16 v[48:51], a[112:115], a[48:51], v[48:51]
  ds_read_b128 a[12:15], v123 offset:6144
  v_mfma_f32_16x16x32_bf16 v[68:71], a[116:119], a[48:51], v[68:71]
  ds_read_b128 a[16:19], v123 offset:8192
  v_mfma_f32_16x16x32_bf16 v[88:91], a[120:123], a[48:51], v[88:91]
  ds_read_b64_tr_b16 a[96:97], v127 offset:16384
  ds_read_b64_tr_b16 a[98:99], v127 offset:18432
  v_mfma_f32_16x16x32_bf16 v[108:111], a[124:127], a[48:51], v[108:111]
  ds_read_b64_tr_b16 a[100:101], v127 offset:16392
  v_mfma_f32_16x16x32_bf16 v[52:55], a[112:115], a[52:55], v[52:55]
  ds_read_b64_tr_b16 a[102:103], v127 offset:18440
  v_mfma_f32_16x16x32_bf16 v[72:75], a[116:119], a[52:55], v[72:75]
  ds_read_b64_tr_b16 a[104:105], v128 offset:16384
  ds_read_b64_tr_b16 a[106:107], v128 offset:18432
  v_mfma_f32_16x16x32_bf16 v[92:95], a[120:123], a[52:55], v[92:95]
  ds_read_b64_tr_b16 a[108:109], v128 offset:16392
  v_mfma_f32_16x16x32_bf16 v[112:115], a[124:127], a[52:55], v[112:115]
  ds_read_b64_tr_b16 a[110:111], v128 offset:18440
  v_mfma_f32_16x16x32_bf16 v[56:59], a[112:115], a[56:59], v[56:59]
  ds_read_b128 a[20:23], v124 offset:0
  ds_read_b128 a[24:27], v124 offset:2048
  v_mfma_f32_16x16x32_bf16 v[76:79], a[116:119], a[56:59], v[76:79]
  ds_read_b128 a[28:31], v124 offset:4096
  v_mfma_f32_16x16x32_bf16 v[96:99], a[120:123], a[56:59], v[96:99]
  ds_read_b128 a[32:35], v124 offset:6144
  v_mfma_f32_16x16x32_bf16 v[116:119], a[124:127], a[56:59], v[116:119]
  ds_read_b128 a[36:39], v124 offset:8192
  s_waitcnt lgkmcnt(0)
  s_barrier
  s_cmp_eq_u32 s66, 1
  s_cbranch_scc1 L_ry3
  s_add_u32 m0, s30, 16384
  s_mov_b32 s77, 16384
  buffer_load_dwordx4 v1, s[40:43], s77 offen offset:0  lds
  buffer_load_dwordx4 v2, s[40:43], s77 offen offset:1024  lds
  buffer_load_dwordx4 v3, s[40:43], s77 offen offset:2048  lds
  buffer_load_dwordx4 v4, s[40:43], s77 offen offset:3072  lds
  s_add_u32 m0, s30, 20480
  s_mov_b32 s77, 20480
  buffer_load_dwordx4 v1, s[40:43], s77 offen offset:0  lds
  buffer_load_dwordx4 v2, s[40:43], s77 offen offset:1024  lds
  buffer_load_dwordx4 v3, s[40:43], s77 offen offset:2048  lds
  buffer_load_dwordx4 v4, s[40:43], s77 offen offset:3072  lds
  s_branch L_re3
L_ry3:
  s_add_u32 m0, s69, 16384
  s_add_u32 s77, s101, 0
  buffer_load_dwordx4 v24, s[48:51], s77 offen offset:0 lds
  buffer_load_dwordx4 v25, s[48:51], s77 offen offset:1024 lds
  buffer_load_dwordx4 v26, s[48:51], s77 offen offset:2048 lds
  buffer_load_dwordx4 v27, s[48:51], s77 offen offset:3072 lds
  s_add_u32 m0, s69, 20480
  s_add_u32 s77, s101, 16384
  buffer_load_dwordx4 v24, s[48:51], s77 offen offset:0 lds
  buffer_load_dwordx4 v25, s[48:51], s77 offen offset:1024 lds
  buffer_load_dwordx4 v26, s[48:51], s77 offen offset:2048 lds
  buffer_load_dwordx4 v27, s[48:51], s77 offen offset:3072 lds
L_re3:
  v_mfma_f32_16x16x32_bf16 v[40:43], a[128:131], a[60:63], v[40:43]
  v_mfma_f32_16x16x32_bf16 v[60:63], a[132:135], a[60:63], v[60:63]
  v_mfma_f32_16x16x32_bf16 v[80:83], a[136:139], a[60:63], v[80:83]
  v_mfma_f32_16x16x32_bf16 v[100:103], a[140:143], a[60:63], v[100:103]
  v_mfma_f32_16x16x32_bf16 v[44:47], a[128:131], a[64:67], v[44:47]
  v_mfma_f32_16x16x32_bf16 v[64:67], a[132:135], a[64:67], v[64:67]
  v_mfma_f32_16x16x32_bf16 v[84:87], a[136:139], a[64:67], v[84:87]
  v_mfma_f32_16x16x32_bf16 v[104:107], a[140:143], a[64:67], v[104:107]
  v_mfma_f32_16x16x32_bf16 v[48:51], a[128:131], a[68:71], v[48:51]
  v_mfma_f32_16x16x32_bf16 v[68:71], a[132:135], a[68:71], v[68:71]
  v_mfma_f32_16x16x32_bf16 v[88:91], a[136:139], a[68:71], v[88:91]
  v_mfma_f32_16x16x32_bf16 v[108:111], a[140:143], a[68:71], v[108:111]
  v_mfma_f32_16x16x32_bf16 v[52:55], a[128:131], a[72:75], v[52:55]
  v_mfma_f32_16x16x32_bf16 v[72:75], a[132:135], a[72:75], v[72:75]
  v_mfma_f32_16x16x32_bf16 v[92:95], a[136:139], a[72:75], v[92:95]
  v_mfma_f32_16x16x32_bf16 v[112:115], a[140:143], a[72:75], v[112:115]
  v_mfma_f32_16x16x32_bf16 v[56:59], a[128:131], a[76:79], v[56:59]
  v_mfma_f32_16x16x32_bf16 v[76:79], a[132:135], a[76:79], v[76:79]
  v_mfma_f32_16x16x32_bf16 v[96:99], a[136:139], a[76:79], v[96:99]
  v_mfma_f32_16x16x32_bf16 v[116:119], a[140:143], a[76:79], v[116:119]
  s_waitcnt vmcnt(24)
  s_barrier
  v_mfma_f32_16x16x32_bf16 v[40:43], a[80:83], a[0:3], v[40:43]
  ds_read_b64_tr_b16 a[112:113], v125 offset:24576
  ds_read_b64_tr_b16 a[114:115], v125 offset:26624
  v_mfma_f32_16x16x32_bf16 v[60:63], a[84:87], a[0:3], v[60:63]
  ds_read_b64_tr_b16 a[116:117], v125 offset:24584
  v_mfma_f32_16x16x32_bf16 v[80:83], a[88:91], a[0:3], v[80:83]
  ds_read_b64_tr_b16 a[118:119], v125 offset:26632
  v_mfma_f32_16x16x32_bf16 v[100:103], a[92:95], a[0:3], v[100:103]
  ds_read_b64_tr_b16 a[120:121], v126 offset:24576
  ds_read_b64_tr_b16 a[122:123], v126 offset:26624
  v_mfma_f32_16x16x32_bf16 v[44:47], a[80:83], a[4:7], v[44:47]
  ds_read_b64_tr_b16 a[124:125], v126 offset:24584
  v_mfma_f32_16x16x32_bf16 v[64:67], a[84:87], a[4:7], v[64:67]
  ds_read_b64_tr_b16 a[126:127], v126 offset:26632
  v_mfma_f32_16x16x32_bf16 v[84:87], a[88:91], a[4:7], v[84:87]
  ds_read_b128 a[40:43], v123 offset:10240
  ds_read_b128 a[44:47], v123 offset:12288
  v_mfma_f32_16x16x32_bf16 v[104:107], a[92:95], a[4:7], v[104:107]
  ds_read_b128 a[48:51], v123 offset:14336
  v_mfma_f32_16x16x32_bf16 v[48:51], a[80:83], a[8:11], v[48:51]
  ds_read_b128 a[52:55], v123 offset:16384
  v_mfma_f32_16x16x32_bf16 v[68:71], a[84:87], a[8:11], v[68:71]
  ds_read_b128 a[56:59], v123 offset:18432
  v_mfma_f32_16x16x32_bf16 v[88:91], a[88:91], a[8:11], v[88:91]
  ds_read_b64_tr_b16 a[128:129], v127 offset:24576
  ds_read_b64_tr_b16 a[130:131], v127 offset:26624
  v_mfma_f32_16x16x32_bf16 v[108:111], a[92:95], a[8:11], v[108:111]
  ds_read_b64_tr_b16 a[132:133], v127 offset:24584
  v_mfma_f32_16x16x32_bf16 v[52:55], a[80:83], a[12:15], v[52:55]
  ds_read_b64_tr_b16 a[134:135], v127 offset:26632
  v_mfma_f32_16x16x32_bf16 v[72:75], a[84:87], a[12:15], v[72:75]
  ds_read_b64_tr_b16 a[136:137], v128 offset:24576
  ds_read_b64_tr_b16 a[138:139], v128 offset:26624
  v_mfma_f32_16x16x32_bf16 v[92:95], a[88:91], a[12:15], v[92:95]
  ds_read_b64_tr_b16 a[140:141], v128 offset:24584
  v_mfma_f32_16x16x32_bf16 v[112:115], a[92:95], a[12:15], v[112:115]
  ds_read_b64_tr_b16 a[142:143], v128 offset:26632
  v_mfma_f32_16x16x32_bf16 v[56:59], a[80:83], a[16:19], v[56:59]
  ds_read_b128 a[60:63], v124 offset:10240
  ds_read_b128 a[64:67], v124 offset:12288
  v_mfma_f32_16x16x32_bf16 v[76:79], a[84:87], a[16:19], v[76:79]
  ds_read_b128 a[68:71], v124 offset:14336
  v_mfma_f32_16x16x32_bf16 v[96:99], a[88:91], a[16:19], v[96:99]
  ds_read_b128 a[72:75], v124 offset:16384
  v_mfma_f32_16x16x32_bf16 v[116:119], a[92:95], a[16:19], v[116:119]
  ds_read_b128 a[76:79], v124 offset:18432
  s_waitcnt lgkmcnt(0)
  s_barrier
  v_mfma_f32_16x16x32_bf16 v[40:43], a[96:99], a[20:23], v[40:43]
  v_mfma_f32_16x16x32_bf16 v[60:63], a[100:103], a[20:23], v[60:63]
  v_mfma_f32_16x16x32_bf16 v[80:83], a[104:107], a[20:23], v[80:83]
  v_mfma_f32_16x16x32_bf16 v[100:103], a[108:111], a[20:23], v[100:103]
  v_mfma_f32_16x16x32_bf16 v[44:47], a[96:99], a[24:27], v[44:47]
  v_mfma_f32_16x16x32_bf16 v[64:67], a[100:103], a[24:27], v[64:67]
  v_mfma_f32_16x16x32_bf16 v[84:87], a[104:107], a[24:27], v[84:87]
  v_mfma_f32_16x16x32_bf16 v[104:107], a[108:111], a[24:27], v[104:107]
  v_mfma_f32_16x16x32_bf16 v[48:51], a[96:99], a[28:31], v[48:51]
  v_mfma_f32_16x16x32_bf16 v[68:71], a[100:103], a[28:31], v[68:71]
  v_mfma_f32_16x16x32_bf16 v[88:91], a[104:107], a[28:31], v[88:91]
  v_mfma_f32_16x16x32_bf16 v[108:111], a[108:111], a[28:31], v[108:111]
  v_mfma_f32_16x16x32_bf16 v[52:55], a[96:99], a[32:35], v[52:55]
  v_mfma_f32_16x16x32_bf16 v[72:75], a[100:103], a[32:35], v[72:75]
  v_mfma_f32_16x16x32_bf16 v[92:95], a[104:107], a[32:35], v[92:95]
  v_mfma_f32_16x16x32_bf16 v[112:115], a[108:111], a[32:35], v[112:115]
  v_mfma_f32_16x16x32_bf16 v[56:59], a[96:99], a[36:39], v[56:59]
  v_mfma_f32_16x16x32_bf16 v[76:79], a[100:103], a[36:39], v[76:79]
  v_mfma_f32_16x16x32_bf16 v[96:99], a[104:107], a[36:39], v[96:99]
  v_mfma_f32_16x16x32_bf16 v[116:119], a[108:111], a[36:39], v[116:119]
  v_mfma_f32_16x16x32_bf16 v[40:43], a[112:115], a[40:43], v[40:43]
  v_accvgpr_write_b32 a0, 0
  v_accvgpr_write_b32 a1, 0
  v_mfma_f32_16x16x32_bf16 v[60:63], a[116:119], a[40:43], v[60:63]
  v_accvgpr_write_b32 a2, 0
  v_accvgpr_write_b32 a3, 0
  v_mfma_f32_16x16x32_bf16 v[80:83], a[120:123], a[40:43], v[80:83]
  v_accvgpr_write_b32 a4, 0
  v_accvgpr_write_b32 a5, 0
  v_mfma_f32_16x16x32_bf16 v[100:103], a[124:127], a[40:43], v[100:103]
  v_accvgpr_write_b32 a6, 0
  v_accvgpr_write_b32 a7, 0
  v_mfma_f32_16x16x32_bf16 v[44:47], a[112:115], a[44:47], v[44:47]
  v_accvgpr_write_b32 a8, 0
  v_mfma_f32_16x16x32_bf16 v[64:67], a[116:119], a[44:47], v[64:67]
  v_accvgpr_write_b32 a9, 0
  v_accvgpr_write_b32 a10, 0
  v_mfma_f32_16x16x32_bf16 v[84:87], a[120:123], a[44:47], v[84:87]
  v_accvgpr_write_b32 a11, 0
  v_accvgpr_write_b32 a12, 0
  v_mfma_f32_16x16x32_bf16 v[104:107], a[124:127], a[44:47], v[104:107]
  v_accvgpr_write_b32 a13, 0
  v_accvgpr_write_b32 a14, 0
  v_mfma_f32_16x16x32_bf16 v[48:51], a[112:115], a[48:51], v[48:51]
  v_accvgpr_write_b32 a15, 0
  v_accvgpr_write_b32 a16, 0
  v_mfma_f32_16x16x32_bf16 v[68:71], a[116:119], a[48:51], v[68:71]
  v_accvgpr_write_b32 a17, 0
  v_mfma_f32_16x16x32_bf16 v[88:91], a[120:123], a[48:51], v[88:91]
  v_accvgpr_write_b32 a18, 0
  v_accvgpr_write_b32 a19, 0
  v_mfma_f32_16x16x32_bf16 v[108:111], a[124:127], a[48:51], v[108:111]
  v_accvgpr_write_b32 a20, 0
  v_accvgpr_write_b32 a21, 0
  v_mfma_f32_16x16x32_bf16 v[52:55], a[112:115], a[52:55], v[52:55]
  v_accvgpr_write_b32 a22, 0
  v_accvgpr_write_b32 a23, 0
  v_mfma_f32_16x16x32_bf16 v[72:75], a[116:119], a[52:55], v[72:75]
  v_accvgpr_write_b32 a24, 0
  v_accvgpr_write_b32 a25, 0
  v_mfma_f32_16x16x32_bf16 v[92:95], a[120:123], a[52:55], v[92:95]
  v_accvgpr_write_b32 a26, 0
  v_mfma_f32_16x16x32_bf16 v[112:115], a[124:127], a[52:55], v[112:115]
  v_accvgpr_write_b32 a27, 0
  v_accvgpr_write_b32 a28, 0
  v_mfma_f32_16x16x32_bf16 v[56:59], a[112:115], a[56:59], v[56:59]
  v_accvgpr_write_b32 a29, 0
  v_accvgpr_write_b32 a30, 0
  v_mfma_f32_16x16x32_bf16 v[76:79], a[116:119], a[56:59], v[76:79]
  v_accvgpr_write_b32 a31, 0
  v_accvgpr_write_b32 a32, 0
  v_mfma_f32_16x16x32_bf16 v[96:99], a[120:123], a[56:59], v[96:99]
  v_accvgpr_write_b32 a33, 0
  v_accvgpr_write_b32 a34, 0
  v_mfma_f32_16x16x32_bf16 v[116:119], a[124:127], a[56:59], v[116:119]
  v_accvgpr_write_b32 a35, 0
  v_mfma_f32_16x16x32_bf16 v[40:43], a[128:131], a[60:63], v[40:43]
  v_accvgpr_write_b32 a36, 0
  v_accvgpr_write_b32 a37, 0
  v_mfma_f32_16x16x32_bf16 v[60:63], a[132:135], a[60:63], v[60:63]
  v_accvgpr_write_b32 a38, 0
  v_accvgpr_write_b32 a39, 0
  v_mfma_f32_16x16x32_bf16 v[80:83], a[136:139], a[60:63], v[80:83]
  v_accvgpr_write_b32 a80, 0
  v_accvgpr_write_b32 a81, 0
  v_mfma_f32_16x16x32_bf16 v[100:103], a[140:143], a[60:63], v[100:103]
  v_accvgpr_write_b32 a82, 0
  v_accvgpr_write_b32 a83, 0
  v_mfma_f32_16x16x32_bf16 v[44:47], a[128:131], a[64:67], v[44:47]
  v_accvgpr_write_b32 a84, 0
  v_mfma_f32_16x16x32_bf16 v[64:67], a[132:135], a[64:67], v[64:67]
  v_accvgpr_write_b32 a85, 0
  v_accvgpr_write_b32 a86, 0
  v_mfma_f32_16x16x32_bf16 v[84:87], a[136:139], a[64:67], v[84:87]
  v_accvgpr_write_b32 a87, 0
  v_accvgpr_write_b32 a88, 0
  v_mfma_f32_16x16x32_bf16 v[104:107], a[140:143], a[64:67], v[104:107]
  v_accvgpr_write_b32 a89, 0
  v_accvgpr_write_b32 a90, 0
  v_mfma_f32_16x16x32_bf16 v[48:51], a[128:131], a[68:71], v[48:51]
  v_accvgpr_write_b32 a91, 0
  v_accvgpr_write_b32 a92, 0
  v_mfma_f32_16x16x32_bf16 v[68:71], a[132:135], a[68:71], v[68:71]
  v_accvgpr_write_b32 a93, 0
  v_mfma_f32_16x16x32_bf16 v[88:91], a[136:139], a[68:71], v[88:91]
  v_accvgpr_write_b32 a94, 0
  v_accvgpr_write_b32 a95, 0
  v_mfma_f32_16x16x32_bf16 v[108:111], a[140:143], a[68:71], v[108:111]
  v_accvgpr_write_b32 a96, 0
  v_accvgpr_write_b32 a97, 0
  v_mfma_f32_16x16x32_bf16 v[52:55], a[128:131], a[72:75], v[52:55]
  v_accvgpr_write_b32 a98, 0
  v_accvgpr_write_b32 a99, 0
  v_mfma_f32_16x16x32_bf16 v[72:75], a[132:135], a[72:75], v[72:75]
  v_accvgpr_write_b32 a100, 0
  v_accvgpr_write_b32 a101, 0
  v_mfma_f32_16x16x32_bf16 v[92:95], a[136:139], a[72:75], v[92:95]
  v_accvgpr_write_b32 a102, 0
  v_mfma_f32_16x16x32_bf16 v[112:115], a[140:143], a[72:75], v[112:115]
  v_accvgpr_write_b32 a103, 0
  v_accvgpr_write_b32 a104, 0
  v_mfma_f32_16x16x32_bf16 v[56:59], a[128:131], a[76:79], v[56:59]
  v_accvgpr_write_b32 a105, 0
  v_accvgpr_write_b32 a106, 0
  v_mfma_f32_16x16x32_bf16 v[76:79], a[132:135], a[76:79], v[76:79]
  v_accvgpr_write_b32 a107, 0
  v_accvgpr_write_b32 a108, 0
  v_mfma_f32_16x16x32_bf16 v[96:99], a[136:139], a[76:79], v[96:99]
  v_accvgpr_write_b32 a109, 0
  v_accvgpr_write_b32 a110, 0
  v_mfma_f32_16x16x32_bf16 v[116:119], a[140:143], a[76:79], v[116:119]
  v_accvgpr_write_b32 a111, 0
  v_accvgpr_write_b32 a40, 0
  v_accvgpr_write_b32 a41, 0
  v_accvgpr_write_b32 a42, 0
  v_accvgpr_write_b32 a43, 0
  v_accvgpr_write_b32 a44, 0
  v_accvgpr_write_b32 a45, 0
  v_accvgpr_write_b32 a46, 0
  v_accvgpr_write_b32 a47, 0
  v_accvgpr_write_b32 a48, 0
  v_accvgpr_write_b32 a49, 0
  v_accvgpr_write_b32 a50, 0
  v_accvgpr_write_b32 a51, 0
  v_accvgpr_write_b32 a52, 0
  v_accvgpr_write_b32 a53, 0
  v_accvgpr_write_b32 a54, 0
  v_accvgpr_write_b32 a55, 0
  v_accvgpr_write_b32 a56, 0
  v_accvgpr_write_b32 a57, 0
  v_accvgpr_write_b32 a58, 0
  v_accvgpr_write_b32 a59, 0
  v_accvgpr_write_b32 a60, 0
  v_accvgpr_write_b32 a61, 0
  v_accvgpr_write_b32 a62, 0
  v_accvgpr_write_b32 a63, 0
  v_accvgpr_write_b32 a64, 0
  v_accvgpr_write_b32 a65, 0
  v_accvgpr_write_b32 a66, 0
  v_accvgpr_write_b32 a67, 0
  v_accvgpr_write_b32 a68, 0
  v_accvgpr_write_b32 a69, 0
  v_accvgpr_write_b32 a70, 0
  v_accvgpr_write_b32 a71, 0
  v_accvgpr_write_b32 a72, 0
  v_accvgpr_write_b32 a73, 0
  v_accvgpr_write_b32 a74, 0
  v_accvgpr_write_b32 a75, 0
  v_accvgpr_write_b32 a76, 0
  v_accvgpr_write_b32 a77, 0
  v_accvgpr_write_b32 a78, 0
  v_accvgpr_write_b32 a79, 0
  v_accvgpr_write_b32 a112, 0
  v_accvgpr_write_b32 a113, 0
  v_accvgpr_write_b32 a114, 0
  v_accvgpr_write_b32 a115, 0
  v_accvgpr_write_b32 a116, 0
  v_accvgpr_write_b32 a117, 0
  v_accvgpr_write_b32 a118, 0
  v_accvgpr_write_b32 a119, 0
  v_accvgpr_write_b32 a120, 0
  v_accvgpr_write_b32 a121, 0
  v_accvgpr_write_b32 a122, 0
  v_accvgpr_write_b32 a123, 0
  v_accvgpr_write_b32 a124, 0
  v_accvgpr_write_b32 a125, 0
  v_accvgpr_write_b32 a126, 0
  v_accvgpr_write_b32 a127, 0
  v_accvgpr_write_b32 a128, 0
  v_accvgpr_write_b32 a129, 0
  v_accvgpr_write_b32 a130, 0
  v_accvgpr_write_b32 a131, 0
  v_accvgpr_write_b32 a132, 0
  v_accvgpr_write_b32 a133, 0
  v_accvgpr_write_b32 a134, 0
  v_accvgpr_write_b32 a135, 0
  v_accvgpr_write_b32 a136, 0
  v_accvgpr_write_b32 a137, 0
  v_accvgpr_write_b32 a138, 0
  v_accvgpr_write_b32 a139, 0
  v_accvgpr_write_b32 a140, 0
  v_accvgpr_write_b32 a141, 0
  v_accvgpr_write_b32 a142, 0
  v_accvgpr_write_b32 a143, 0
  v_add_u32 v228, s69, v7
  v_add_u32 v229, s70, v7
  v_add_u32 v230, s78, v7
  v_add_u32 v231, s79, v7
  v_pk_mul_f32 v[40:41], v[40:41], s[82:83]
  v_pk_mul_f32 v[42:43], v[42:43], s[82:83]
  v_cvt_pk_bf16_f32 v40, v40, v41
  v_cvt_pk_bf16_f32 v41, v42, v43
  v_pk_mul_f32 v[60:61], v[60:61], s[82:83]
  v_pk_mul_f32 v[62:63], v[62:63], s[82:83]
  v_cvt_pk_bf16_f32 v42, v60, v61
  v_cvt_pk_bf16_f32 v43, v62, v63
  ds_write_b128 v228, v[40:43] offset:24576
  v_pk_mul_f32 v[44:45], v[44:45], s[82:83]
  v_pk_mul_f32 v[46:47], v[46:47], s[82:83]
  v_cvt_pk_bf16_f32 v44, v44, v45
  v_cvt_pk_bf16_f32 v45, v46, v47
  v_pk_mul_f32 v[64:65], v[64:65], s[82:83]
  v_pk_mul_f32 v[66:67], v[66:67], s[82:83]
  v_cvt_pk_bf16_f32 v46, v64, v65
  v_cvt_pk_bf16_f32 v47, v66, v67
  ds_write_b128 v228, v[44:47] offset:25600
  v_pk_mul_f32 v[48:49], v[48:49], s[82:83]
  v_pk_mul_f32 v[50:51], v[50:51], s[82:83]
  v_cvt_pk_bf16_f32 v48, v48, v49
  v_cvt_pk_bf16_f32 v49, v50, v51
  v_pk_mul_f32 v[68:69], v[68:69], s[82:83]
  v_pk_mul_f32 v[70:71], v[70:71], s[82:83]
  v_cvt_pk_bf16_f32 v50, v68, v69
  v_cvt_pk_bf16_f32 v51, v70, v71
  ds_write_b128 v228, v[48:51] offset:26624
  v_pk_mul_f32 v[52:53], v[52:53], s[82:83]
  v_pk_mul_f32 v[54:55], v[54:55], s[82:83]
  v_cvt_pk_bf16_f32 v52, v52, v53
  v_cvt_pk_bf16_f32 v53, v54, v55
  v_pk_mul_f32 v[72:73], v[72:73], s[82:83]
  v_pk_mul_f32 v[74:75], v[74:75], s[82:83]
  v_cvt_pk_bf16_f32 v54, v72, v73
  v_cvt_pk_bf16_f32 v55, v74, v75
  ds_write_b128 v228, v[52:55] offset:27648
  v_pk_mul_f32 v[56:57], v[56:57], s[82:83]
  v_pk_mul_f32 v[58:59], v[58:59], s[82:83]
  v_cvt_pk_bf16_f32 v56, v56, v57
  v_cvt_pk_bf16_f32 v57, v58, v59
  v_pk_mul_f32 v[76:77], v[76:77], s[82:83]
  v_pk_mul_f32 v[78:79], v[78:79], s[82:83]
  v_cvt_pk_bf16_f32 v58, v76, v77
  v_cvt_pk_bf16_f32 v59, v78, v79
  ds_write_b128 v228, v[56:59] offset:28672
  v_pk_mul_f32 v[80:81], v[80:81], s[82:83]
  v_pk_mul_f32 v[82:83], v[82:83], s[82:83]
  v_cvt_pk_bf16_f32 v60, v80, v81
  v_cvt_pk_bf16_f32 v61, v82, v83
  v_pk_mul_f32 v[100:101], v[100:101], s[82:83]
  v_pk_mul_f32 v[102:103], v[102:103], s[82:83]
  v_cvt_pk_bf16_f32 v62, v100, v101
  v_cvt_pk_bf16_f32 v63, v102, v103
  ds_write_b128 v228, v[60:63] offset:29696
  v_pk_mul_f32 v[84:85], v[84:85], s[82:83]
  v_pk_mul_f32 v[86:87], v[86:87], s[82:83]
  v_cvt_pk_bf16_f32 v64, v84, v85
  v_cvt_pk_bf16_f32 v65, v86, v87
  v_pk_mul_f32 v[104:105], v[104:105], s[82:83]
  v_pk_mul_f32 v[106:107], v[106:107], s[82:83]
  v_cvt_pk_bf16_f32 v66, v104, v105
  v_cvt_pk_bf16_f32 v67, v106, v107
  ds_write_b128 v228, v[64:67] offset:30720
  v_pk_mul_f32 v[88:89], v[88:89], s[82:83]
  v_pk_mul_f32 v[90:91], v[90:91], s[82:83]
  v_cvt_pk_bf16_f32 v68, v88, v89
  v_cvt_pk_bf16_f32 v69, v90, v91
  v_pk_mul_f32 v[108:109], v[108:109], s[82:83]
  v_pk_mul_f32 v[110:111], v[110:111], s[82:83]
  v_cvt_pk_bf16_f32 v70, v108, v109
  v_cvt_pk_bf16_f32 v71, v110, v111
  ds_write_b128 v228, v[68:71] offset:31744
  v_pk_mul_f32 v[92:93], v[92:93], s[82:83]
  v_pk_mul_f32 v[94:95], v[94:95], s[82:83]
  v_cvt_pk_bf16_f32 v72, v92, v93
  v_cvt_pk_bf16_f32 v73, v94, v95
  v_pk_mul_f32 v[112:113], v[112:113], s[82:83]
  v_pk_mul_f32 v[114:115], v[114:115], s[82:83]
  v_cvt_pk_bf16_f32 v74, v112, v113
  v_cvt_pk_bf16_f32 v75, v114, v115
  ds_write_b128 v229, v[72:75] offset:0
  v_pk_mul_f32 v[96:97], v[96:97], s[82:83]
  v_pk_mul_f32 v[98:99], v[98:99], s[82:83]
  v_cvt_pk_bf16_f32 v76, v96, v97
  v_cvt_pk_bf16_f32 v77, v98, v99
  v_pk_mul_f32 v[116:117], v[116:117], s[82:83]
  v_pk_mul_f32 v[118:119], v[118:119], s[82:83]
  v_cvt_pk_bf16_f32 v78, v116, v117
  v_cvt_pk_bf16_f32 v79, v118, v119
  ds_write_b128 v229, v[76:79] offset:1024
  s_waitcnt lgkmcnt(0)
  s_barrier
  ds_read_b128 v[80:83], v230 offset:24576
  ds_read_b128 v[84:87], v230 offset:25600
  ds_read_b128 v[88:91], v230 offset:26624
  ds_read_b128 v[92:95], v230 offset:27648
  ds_read_b128 v[96:99], v230 offset:28672
  ds_read_b128 v[100:103], v230 offset:29696
  ds_read_b128 v[104:107], v230 offset:30720
  ds_read_b128 v[108:111], v230 offset:31744
  ds_read_b128 v[112:115], v231 offset:0
  ds_read_b128 v[116:119], v231 offset:1024
  s_waitcnt lgkmcnt(0)
  s_barrier
  s_add_u32 m0, s70, 0
  s_add_u32 s77, s101, 131072
  buffer_load_dwordx4 v24, s[48:51], s77 offen offset:0 lds
  buffer_load_dwordx4 v25, s[48:51], s77 offen offset:1024 lds
  buffer_load_dwordx4 v26, s[48:51], s77 offen offset:2048 lds
  buffer_load_dwordx4 v27, s[48:51], s77 offen offset:3072 lds
  s_add_u32 m0, s70, 4096
  s_add_u32 s77, s101, 147456
  buffer_load_dwordx4 v24, s[48:51], s77 offen offset:0 lds
  buffer_load_dwordx4 v25, s[48:51], s77 offen offset:1024 lds
  buffer_load_dwordx4 v26, s[48:51], s77 offen offset:2048 lds
  buffer_load_dwordx4 v27, s[48:51], s77 offen offset:3072 lds
  s_cmp_eq_u32 s66, 1
  s_cbranch_scc1 L_ry4
  s_add_u32 m0, s30, 24576
  s_mov_b32 s77, 16384
  buffer_load_dwordx4 v5, s[44:47], s77 offen offset:0  lds
  s_branch L_re4
L_ry4:
  s_add_u32 m0, s69, 24576
  s_add_u32 s77, s101, 32768
  buffer_load_dwordx4 v24, s[48:51], s77 offen offset:0 lds
  buffer_load_dwordx4 v25, s[48:51], s77 offen offset:1024 lds
  buffer_load_dwordx4 v26, s[48:51], s77 offen offset:2048 lds
  buffer_load_dwordx4 v27, s[48:51], s77 offen offset:3072 lds
  s_add_u32 m0, s69, 28672
  s_add_u32 s77, s101, 49152
  buffer_load_dwordx4 v24, s[48:51], s77 offen offset:0 lds
  buffer_load_dwordx4 v25, s[48:51], s77 offen offset:1024 lds
  buffer_load_dwordx4 v26, s[48:51], s77 offen offset:2048 lds
  buffer_load_dwordx4 v27, s[48:51], s77 offen offset:3072 lds
  s_lshl_b32 s72, s67, 12
  s_add_u32 s72, s72, s101
  s_add_u32 s77, s72, 98304
  buffer_load_dwordx4 v[248:251], v24, s[24:27], s77 offen
  s_add_u32 s77, s72, 163840
  buffer_load_dwordx4 v[248:251], v24, s[24:27], s77 offen
  s_add_u32 s77, s72, 196608
  buffer_load_dwordx4 v[248:251], v24, s[24:27], s77 offen
  s_add_u32 s77, s72, 229376
  buffer_load_dwordx4 v[248:251], v24, s[24:27], s77 offen
L_re4:
  s_mov_b32 s73, 24576
  s_add_u32 s71, s12, 16384
  s_mov_b32 s72, 0
  v_mfma_f32_16x16x32_bf16 v[120:123], a[180:183], v[40:43], v[208:211]
  v_mfma_f32_16x16x32_bf16 v[120:123], a[184:187], v[60:63], v[120:123]
  v_mfma_f32_16x16x32_bf16 v[120:123], a[188:191], v[80:83], v[120:123]
  v_mfma_f32_16x16x32_bf16 v[120:123], a[192:195], v[100:103], v[120:123]
  v_mfma_f32_16x16x32_bf16 v[124:127], a[196:199], v[40:43], v[208:211]
  v_mfma_f32_16x16x32_bf16 v[124:127], a[200:203], v[60:63], v[124:127]
  v_mfma_f32_16x16x32_bf16 v[124:127], a[204:207], v[80:83], v[124:127]
  v_mfma_f32_16x16x32_bf16 v[124:127], a[208:211], v[100:103], v[124:127]
  s_cmp_eq_u32 s66, 1
  s_nop 5
  s_cbranch_scc0 L_preX
  s_add_u32 s73, s73, s12
  s_branch L_loopY
L_preX:
  s_mov_b32 s71, 16384
L_loopX:
  v_mfma_f32_16x16x32_bf16 v[128:131], a[180:183], v[44:47], v[212:215]
  v_max3_f32 v228, v120, v121, v122
  v_max3_f32 v229, v123, v124, v125
  v_mfma_f32_16x16x32_bf16 v[128:131], a[184:187], v[64:67], v[128:131]
  v_max3_f32 v228, v228, v126, v127
  v_max_f32 v228, v228, v229
  v_mfma_f32_16x16x32_bf16 v[128:131], a[188:191], v[84:87], v[128:131]
  v_cmp_lt_f32 vcc, s80, v228
  s_cbranch_vccnz L_slowX0
L_retX0:
  v_mfma_f32_16x16x32_bf16 v[128:131], a[192:195], v[104:107], v[128:131]
  v_exp_f32 v120, v120
  v_mfma_f32_16x16x32_bf16 v[132:135], a[196:199], v[44:47], v[212:215]
  v_exp_f32 v121, v121
  s_add_u32 m0, s30, 24576
  v_mfma_f32_16x16x32_bf16 v[132:135], a[200:203], v[64:67], v[132:135]
  buffer_load_dwordx4 v6, s[44:47], s71 offen offset:1024 nt lds
  v_mfma_f32_16x16x32_bf16 v[132:135], a[204:207], v[84:87], v[132:135]
  v_exp_f32 v122, v122
  v_mfma_f32_16x16x32_bf16 v[132:135], a[208:211], v[104:107], v[132:135]
  v_exp_f32 v123, v123
  s_add_u32 m0, s30, 24576
  v_mfma_f32_16x16x32_bf16 a[16:19], v[176:179], v[140:143], a[16:19]
  v_cvt_pk_bf16_f32 v136, v120, v121
  buffer_load_dwordx4 v5, s[44:47], s71 offen offset:2048 nt lds
  v_mfma_f32_16x16x32_bf16 a[36:39], v[180:183], v[140:143], a[36:39]
  v_exp_f32 v124, v124
  v_mfma_f32_16x16x32_bf16 a[56:59], v[184:187], v[140:143], a[56:59]
  v_exp_f32 v125, v125
  s_add_u32 m0, s30, 24576
  v_mfma_f32_16x16x32_bf16 a[76:79], v[188:191], v[140:143], a[76:79]
  v_cvt_pk_bf16_f32 v137, v122, v123
  buffer_load_dwordx4 v6, s[44:47], s71 offen offset:3072 nt lds
  v_mfma_f32_16x16x32_bf16 a[96:99], v[192:195], v[140:143], a[96:99]
  v_exp_f32 v126, v126
  v_mfma_f32_16x16x32_bf16 a[116:119], v[196:199], v[140:143], a[116:119]
  v_exp_f32 v127, v127
  v_mfma_f32_16x16x32_bf16 a[136:139], v[200:203], v[140:143], a[136:139]
  v_cvt_pk_bf16_f32 v138, v124, v125
  s_add_u32 m0, s30, 28672
  s_add_u32 s77, s71, 4096
  v_mfma_f32_16x16x32_bf16 a[156:159], v[204:207], v[140:143], a[156:159]
  buffer_load_dwordx4 v5, s[44:47], s77 offen offset:0 nt lds
  v_mfma_f32_16x16x32_bf16 a[176:179], v[20:23], v[140:143], a[176:179]
  v_cvt_pk_bf16_f32 v139, v126, v127
  s_waitcnt vmcnt(21)
  v_mfma_f32_16x16x32_bf16 v[120:123], a[180:183], v[48:51], v[216:219]
  v_max3_f32 v228, v128, v129, v130
  v_max3_f32 v229, v131, v132, v133
  v_mfma_f32_16x16x32_bf16 v[120:123], a[184:187], v[68:71], v[120:123]
  v_max3_f32 v228, v228, v134, v135
  v_max_f32 v228, v228, v229
  v_mfma_f32_16x16x32_bf16 v[120:123], a[188:191], v[88:91], v[120:123]
  v_cmp_lt_f32 vcc, s80, v228
  s_cbranch_vccnz L_slowX1
L_retX1:
  v_mfma_f32_16x16x32_bf16 v[120:123], a[192:195], v[108:111], v[120:123]
  v_exp_f32 v128, v128
  v_mfma_f32_16x16x32_bf16 v[124:127], a[196:199], v[48:51], v[216:219]
  v_exp_f32 v129, v129
  v_mfma_f32_16x16x32_bf16 v[124:127], a[200:203], v[68:71], v[124:127]
  s_add_u32 m0, s30, 28672
  s_add_u32 s77, s71, 4096
  ds_read_b128 a[212:215], v8 offset:0
  ds_read_b128 a[216:219], v9 offset:0
  v_mfma_f32_16x16x32_bf16 v[124:127], a[204:207], v[88:91], v[124:127]
  v_exp_f32 v130, v130
  buffer_load_dwordx4 v6, s[44:47], s77 offen offset:1024 nt lds
  v_mfma_f32_16x16x32_bf16 v[124:127], a[208:211], v[108:111], v[124:127]
  v_exp_f32 v131, v131
  v_mfma_f32_16x16x32_bf16 a[0:3], v[144:147], v[136:139], a[0:3]
  v_cvt_pk_bf16_f32 v140, v128, v129
  ds_read_b128 a[220:223], v10 offset:0
  ds_read_b128 a[224:227], v11 offset:0
  v_mfma_f32_16x16x32_bf16 a[20:23], v[148:151], v[136:139], a[20:23]
  v_exp_f32 v132, v132
  s_add_u32 m0, s30, 28672
  s_add_u32 s77, s71, 4096
  v_mfma_f32_16x16x32_bf16 a[40:43], v[152:155], v[136:139], a[40:43]
  v_exp_f32 v133, v133
  buffer_load_dwordx4 v5, s[44:47], s77 offen offset:2048 nt lds
  v_mfma_f32_16x16x32_bf16 a[60:63], v[156:159], v[136:139], a[60:63]
  v_cvt_pk_bf16_f32 v141, v130, v131
  ds_read_b128 a[228:231], v8 offset:4096
  ds_read_b128 a[232:235], v9 offset:4096
  v_mfma_f32_16x16x32_bf16 a[80:83], v[160:163], v[136:139], a[80:83]
  v_exp_f32 v134, v134
  v_mfma_f32_16x16x32_bf16 a[100:103], v[164:167], v[136:139], a[100:103]
  v_exp_f32 v135, v135
  s_add_u32 m0, s30, 28672
  s_add_u32 s77, s71, 4096
  v_mfma_f32_16x16x32_bf16 a[120:123], v[168:171], v[136:139], a[120:123]
  v_cvt_pk_bf16_f32 v142, v132, v133
  buffer_load_dwordx4 v6, s[44:47], s77 offen offset:3072 nt lds
  s_add_u32 s71, s71, 8192
  v_mfma_f32_16x16x32_bf16 a[140:143], v[172:175], v[136:139], a[140:143]
  ds_read_b128 a[236:239], v10 offset:4096
  ds_read_b128 a[240:243], v11 offset:4096
  v_mfma_f32_16x16x32_bf16 a[160:163], v[20:23], v[136:139], a[160:163]
  v_cvt_pk_bf16_f32 v143, v134, v135
  s_waitcnt lgkmcnt(0)
  v_mfma_f32_16x16x32_bf16 v[128:131], a[180:183], v[52:55], v[220:223]
  v_max3_f32 v228, v120, v121, v122
  v_max3_f32 v229, v123, v124, v125
  v_mfma_f32_16x16x32_bf16 v[128:131], a[184:187], v[72:75], v[128:131]
  v_max3_f32 v228, v228, v126, v127
  v_max_f32 v228, v228, v229
  v_mfma_f32_16x16x32_bf16 v[128:131], a[188:191], v[92:95], v[128:131]
  v_cmp_lt_f32 vcc, s80, v228
  s_cbranch_vccnz L_slowX2
L_retX2:
  v_mfma_f32_16x16x32_bf16 v[128:131], a[192:195], v[112:115], v[128:131]
  v_exp_f32 v120, v120
  s_cmp_eq_u32 s72, 7
  s_cbranch_scc1 L_hkX2
L_hkX2_ret:
  v_mfma_f32_16x16x32_bf16 v[132:135], a[196:199], v[52:55], v[220:223]
  v_exp_f32 v121, v121
  s_add_u32 m0, s30, 0
  v_mfma_f32_16x16x32_bf16 v[132:135], a[200:203], v[72:75], v[132:135]
  buffer_load_dwordx4 v1, s[40:43], s73 offen offset:0 nt lds
  v_mfma_f32_16x16x32_bf16 v[132:135], a[204:207], v[92:95], v[132:135]
  v_exp_f32 v122, v122
  v_mfma_f32_16x16x32_bf16 v[132:135], a[208:211], v[112:115], v[132:135]
  v_exp_f32 v123, v123
  v_mfma_f32_16x16x32_bf16 a[4:7], v[144:147], v[140:143], a[4:7]
  v_cvt_pk_bf16_f32 v136, v120, v121
  s_add_u32 m0, s30, 0
  v_mfma_f32_16x16x32_bf16 a[24:27], v[148:151], v[140:143], a[24:27]
  v_exp_f32 v124, v124
  buffer_load_dwordx4 v2, s[40:43], s73 offen offset:1024 nt lds
  v_mfma_f32_16x16x32_bf16 a[44:47], v[152:155], v[140:143], a[44:47]
  v_exp_f32 v125, v125
  v_mfma_f32_16x16x32_bf16 a[64:67], v[156:159], v[140:143], a[64:67]
  v_cvt_pk_bf16_f32 v137, v122, v123
  v_mfma_f32_16x16x32_bf16 a[84:87], v[160:163], v[140:143], a[84:87]
  v_exp_f32 v126, v126
  v_mfma_f32_16x16x32_bf16 a[104:107], v[164:167], v[140:143], a[104:107]
  v_exp_f32 v127, v127
  v_mfma_f32_16x16x32_bf16 a[124:127], v[168:171], v[140:143], a[124:127]
  v_cvt_pk_bf16_f32 v138, v124, v125
  s_add_u32 m0, s30, 0
  v_mfma_f32_16x16x32_bf16 a[144:147], v[172:175], v[140:143], a[144:147]
  buffer_load_dwordx4 v3, s[40:43], s73 offen offset:2048 nt lds
  v_mfma_f32_16x16x32_bf16 a[164:167], v[20:23], v[140:143], a[164:167]
  v_cvt_pk_bf16_f32 v139, v126, v127
  s_waitcnt vmcnt(19)
  v_mfma_f32_16x16x32_bf16 v[120:123], a[180:183], v[56:59], v[224:227]
  v_max3_f32 v228, v128, v129, v130
  v_max3_f32 v229, v131, v132, v133
  v_mfma_f32_16x16x32_bf16 v[120:123], a[184:187], v[76:79], v[120:123]
  v_max3_f32 v228, v228, v134, v135
  v_max_f32 v228, v228, v229
  ds_read_b64_tr_b16 v[176:177], v12 offset:8192
  v_mfma_f32_16x16x32_bf16 v[120:123], a[188:191], v[96:99], v[120:123]
  v_cmp_lt_f32 vcc, s80, v228
  s_cbranch_vccnz L_slowX3
L_retX3:
  ds_read_b64_tr_b16 v[178:179], v12 offset:12288
  v_mfma_f32_16x16x32_bf16 v[120:123], a[192:195], v[116:119], v[120:123]
  v_exp_f32 v128, v128
  ds_read_b64_tr_b16 v[180:181], v13 offset:8192
  v_mfma_f32_16x16x32_bf16 v[124:127], a[196:199], v[56:59], v[224:227]
  v_exp_f32 v129, v129
  s_add_u32 m0, s30, 0
  ds_read_b64_tr_b16 v[182:183], v13 offset:12288
  v_mfma_f32_16x16x32_bf16 v[124:127], a[200:203], v[76:79], v[124:127]
  buffer_load_dwordx4 v4, s[40:43], s73 offen offset:3072 nt lds
  ds_read_b64_tr_b16 v[184:185], v14 offset:8192
  v_mfma_f32_16x16x32_bf16 v[124:127], a[204:207], v[96:99], v[124:127]
  v_exp_f32 v130, v130
  ds_read_b64_tr_b16 v[186:187], v14 offset:12288
  v_mfma_f32_16x16x32_bf16 v[124:127], a[208:211], v[116:119], v[124:127]
  v_exp_f32 v131, v131
  ds_read_b64_tr_b16 v[188:189], v15 offset:8192
  v_mfma_f32_16x16x32_bf16 a[8:11], v[144:147], v[136:139], a[8:11]
  v_cvt_pk_bf16_f32 v140, v128, v129
  ds_read_b64_tr_b16 v[190:191], v15 offset:12288
  v_mfma_f32_16x16x32_bf16 a[28:31], v[148:151], v[136:139], a[28:31]
  v_exp_f32 v132, v132
  s_add_u32 m0, s30, 4096
  s_add_u32 s77, s73, 4096
  ds_read_b64_tr_b16 v[192:193], v16 offset:8192
  v_mfma_f32_16x16x32_bf16 a[48:51], v[152:155], v[136:139], a[48:51]
  v_exp_f32 v133, v133
  buffer_load_dwordx4 v1, s[40:43], s77 offen offset:0 nt lds
  ds_read_b64_tr_b16 v[194:195], v16 offset:12288
  v_mfma_f32_16x16x32_bf16 a[68:71], v[156:159], v[136:139], a[68:71]
  v_cvt_pk_bf16_f32 v141, v130, v131
  ds_read_b64_tr_b16 v[196:197], v17 offset:8192
  v_mfma_f32_16x16x32_bf16 a[88:91], v[160:163], v[136:139], a[88:91]
  v_exp_f32 v134, v134
  ds_read_b64_tr_b16 v[198:199], v17 offset:12288
  v_mfma_f32_16x16x32_bf16 a[108:111], v[164:167], v[136:139], a[108:111]
  v_exp_f32 v135, v135
  ds_read_b64_tr_b16 v[200:201], v18 offset:8192
  v_mfma_f32_16x16x32_bf16 a[128:131], v[168:171], v[136:139], a[128:131]
  v_cvt_pk_bf16_f32 v142, v132, v133
  s_add_u32 m0, s30, 4096
  s_add_u32 s77, s73, 4096
  ds_read_b64_tr_b16 v[202:203], v18 offset:12288
  v_mfma_f32_16x16x32_bf16 a[148:151], v[172:175], v[136:139], a[148:151]
  buffer_load_dwordx4 v2, s[40:43], s77 offen offset:1024 nt lds
  ds_read_b64_tr_b16 v[204:205], v19 offset:8192
  v_mfma_f32_16x16x32_bf16 a[168:171], v[20:23], v[136:139], a[168:171]
  v_cvt_pk_bf16_f32 v143, v134, v135
  ds_read_b64_tr_b16 v[206:207], v19 offset:12288
  s_waitcnt lgkmcnt(0)
  v_mfma_f32_16x16x32_bf16 v[128:131], a[212:215], v[40:43], v[208:211]
  v_max3_f32 v228, v120, v121, v122
  v_max3_f32 v229, v123, v124, v125
  v_mfma_f32_16x16x32_bf16 v[128:131], a[216:219], v[60:63], v[128:131]
  v_max3_f32 v228, v228, v126, v127
  v_max_f32 v228, v228, v229
  v_mfma_f32_16x16x32_bf16 v[128:131], a[220:223], v[80:83], v[128:131]
  v_cmp_lt_f32 vcc, s80, v228
  s_cbranch_vccnz L_slowX4
L_retX4:
  v_mfma_f32_16x16x32_bf16 v[128:131], a[224:227], v[100:103], v[128:131]
  v_exp_f32 v120, v120
  s_cmp_eq_u32 s72, 7
  s_cbranch_scc1 L_hkX3
L_hkX3_ret:
  v_mfma_f32_16x16x32_bf16 v[132:135], a[228:231], v[40:43], v[208:211]
  v_exp_f32 v121, v121
  s_add_u32 m0, s30, 4096
  s_add_u32 s77, s73, 4096
  v_mfma_f32_16x16x32_bf16 v[132:135], a[232:235], v[60:63], v[132:135]
  buffer_load_dwordx4 v3, s[40:43], s77 offen offset:2048 nt lds
  v_mfma_f32_16x16x32_bf16 v[132:135], a[236:239], v[80:83], v[132:135]
  v_exp_f32 v122, v122
  v_mfma_f32_16x16x32_bf16 v[132:135], a[240:243], v[100:103], v[132:135]
  v_exp_f32 v123, v123
  v_mfma_f32_16x16x32_bf16 a[12:15], v[144:147], v[140:143], a[12:15]
  v_cvt_pk_bf16_f32 v136, v120, v121
  s_add_u32 m0, s30, 4096
  s_add_u32 s77, s73, 4096
  v_mfma_f32_16x16x32_bf16 a[32:35], v[148:151], v[140:143], a[32:35]
  v_exp_f32 v124, v124
  buffer_load_dwordx4 v4, s[40:43], s77 offen offset:3072 nt lds
  s_add_u32 s73, s73, 8192
  v_mfma_f32_16x16x32_bf16 a[52:55], v[152:155], v[140:143], a[52:55]
  v_exp_f32 v125, v125
  v_mfma_f32_16x16x32_bf16 a[72:75], v[156:159], v[140:143], a[72:75]
  v_cvt_pk_bf16_f32 v137, v122, v123
  v_mfma_f32_16x16x32_bf16 a[92:95], v[160:163], v[140:143], a[92:95]
  v_exp_f32 v126, v126
  v_mfma_f32_16x16x32_bf16 a[112:115], v[164:167], v[140:143], a[112:115]
  v_exp_f32 v127, v127
  v_mfma_f32_16x16x32_bf16 a[132:135], v[168:171], v[140:143], a[132:135]
  v_cvt_pk_bf16_f32 v138, v124, v125
  s_add_u32 m0, s30, 8192
  v_mfma_f32_16x16x32_bf16 a[152:155], v[172:175], v[140:143], a[152:155]
  buffer_load_dwordx4 v5, s[44:47], s71 offen offset:0 nt lds
  v_mfma_f32_16x16x32_bf16 a[172:175], v[20:23], v[140:143], a[172:175]
  v_cvt_pk_bf16_f32 v139, v126, v127
  s_mov_b32 s80, 0x41000000
  s_mov_b32 s81, 0
  v_mfma_f32_16x16x32_bf16 v[120:123], a[212:215], v[44:47], v[212:215]
  v_max3_f32 v228, v128, v129, v130
  v_max3_f32 v229, v131, v132, v133
  v_mfma_f32_16x16x32_bf16 v[120:123], a[216:219], v[64:67], v[120:123]
  v_max3_f32 v228, v228, v134, v135
  v_max_f32 v228, v228, v229
  v_mfma_f32_16x16x32_bf16 v[120:123], a[220:223], v[84:87], v[120:123]
  v_cmp_lt_f32 vcc, s80, v228
  s_cbranch_vccnz L_slowX5
L_retX5:
  v_mfma_f32_16x16x32_bf16 v[120:123], a[224:227], v[104:107], v[120:123]
  v_exp_f32 v128, v128
  v_mfma_f32_16x16x32_bf16 v[124:127], a[228:231], v[44:47], v[212:215]
  v_exp_f32 v129, v129
  s_add_u32 m0, s30, 8192
  v_mfma_f32_16x16x32_bf16 v[124:127], a[232:235], v[64:67], v[124:127]
  buffer_load_dwordx4 v6, s[44:47], s71 offen offset:1024 nt lds
  v_mfma_f32_16x16x32_bf16 v[124:127], a[236:239], v[84:87], v[124:127]
  v_exp_f32 v130, v130
  v_mfma_f32_16x16x32_bf16 v[124:127], a[240:243], v[104:107], v[124:127]
  v_exp_f32 v131, v131
  s_add_u32 m0, s30, 8192
  v_mfma_f32_16x16x32_bf16 a[16:19], v[144:147], v[136:139], a[16:19]
  v_cvt_pk_bf16_f32 v140, v128, v129
  buffer_load_dwordx4 v5, s[44:47], s71 offen offset:2048 nt lds
  v_mfma_f32_16x16x32_bf16 a[36:39], v[148:151], v[136:139], a[36:39]
  v_exp_f32 v132, v132
  v_mfma_f32_16x16x32_bf16 a[56:59], v[152:155], v[136:139], a[56:59]
  v_exp_f32 v133, v133
  s_add_u32 m0, s30, 8192
  v_mfma_f32_16x16x32_bf16 a[76:79], v[156:159], v[136:139], a[76:79]
  v_cvt_pk_bf16_f32 v141, v130, v131
  buffer_load_dwordx4 v6, s[44:47], s71 offen offset:3072 nt lds
  v_mfma_f32_16x16x32_bf16 a[96:99], v[160:163], v[136:139], a[96:99]
  v_exp_f32 v134, v134
  v_mfma_f32_16x16x32_bf16 a[116:119], v[164:167], v[136:139], a[116:119]
  v_exp_f32 v135, v135
  v_mfma_f32_16x16x32_bf16 a[136:139], v[168:171], v[136:139], a[136:139]
  v_cvt_pk_bf16_f32 v142, v132, v133
  s_add_u32 m0, s30, 12288
  s_add_u32 s77, s71, 4096
  v_mfma_f32_16x16x32_bf16 a[156:159], v[172:175], v[136:139], a[156:159]
  buffer_load_dwordx4 v5, s[44:47], s77 offen offset:0 nt lds
  v_mfma_f32_16x16x32_bf16 a[176:179], v[20:23], v[136:139], a[176:179]
  v_cvt_pk_bf16_f32 v143, v134, v135
  s_waitcnt vmcnt(21)
  v_mfma_f32_16x16x32_bf16 v[128:131], a[212:215], v[48:51], v[216:219]
  v_max3_f32 v228, v120, v121, v122
  v_max3_f32 v229, v123, v124, v125
  v_mfma_f32_16x16x32_bf16 v[128:131], a[216:219], v[68:71], v[128:131]
  v_max3_f32 v228, v228, v126, v127
  v_max_f32 v228, v228, v229
  v_mfma_f32_16x16x32_bf16 v[128:131], a[220:223], v[88:91], v[128:131]
  v_cmp_lt_f32 vcc, s80, v228
  s_cbranch_vccnz L_slowX6
L_retX6:
  v_mfma_f32_16x16x32_bf16 v[128:131], a[224:227], v[108:111], v[128:131]
  v_exp_f32 v120, v120
  v_mfma_f32_16x16x32_bf16 v[132:135], a[228:231], v[48:51], v[216:219]
  v_exp_f32 v121, v121
  v_mfma_f32_16x16x32_bf16 v[132:135], a[232:235], v[68:71], v[132:135]
  s_add_u32 m0, s30, 12288
  s_add_u32 s77, s71, 4096
  ds_read_b128 a[180:183], v8 offset:16384
  ds_read_b128 a[184:187], v9 offset:16384
  v_mfma_f32_16x16x32_bf16 v[132:135], a[236:239], v[88:91], v[132:135]
  v_exp_f32 v122, v122
  buffer_load_dwordx4 v6, s[44:47], s77 offen offset:1024 nt lds
  v_mfma_f32_16x16x32_bf16 v[132:135], a[240:243], v[108:111], v[132:135]
  v_exp_f32 v123, v123
  v_mfma_f32_16x16x32_bf16 a[0:3], v[176:179], v[140:143], a[0:3]
  v_cvt_pk_bf16_f32 v136, v120, v121
  ds_read_b128 a[188:191], v10 offset:16384
  ds_read_b128 a[192:195], v11 offset:16384
  v_mfma_f32_16x16x32_bf16 a[20:23], v[180:183], v[140:143], a[20:23]
  v_exp_f32 v124, v124
  s_add_u32 m0, s30, 12288
  s_add_u32 s77, s71, 4096
  v_mfma_f32_16x16x32_bf16 a[40:43], v[184:187], v[140:143], a[40:43]
  v_exp_f32 v125, v125
  buffer_load_dwordx4 v5, s[44:47], s77 offen offset:2048 nt lds
  v_mfma_f32_16x16x32_bf16 a[60:63], v[188:191], v[140:143], a[60:63]
  v_cvt_pk_bf16_f32 v137, v122, v123
  ds_read_b128 a[196:199], v8 offset:20480
  ds_read_b128 a[200:203], v9 offset:20480
  v_mfma_f32_16x16x32_bf16 a[80:83], v[192:195], v[140:143], a[80:83]
  v_exp_f32 v126, v126
  v_mfma_f32_16x16x32_bf16 a[100:103], v[196:199], v[140:143], a[100:103]
  v_exp_f32 v127, v127
  s_add_u32 m0, s30, 12288
  s_add_u32 s77, s71, 4096
  v_mfma_f32_16x16x32_bf16 a[120:123], v[200:203], v[140:143], a[120:123]
  v_cvt_pk_bf16_f32 v138, v124, v125
  buffer_load_dwordx4 v6, s[44:47], s77 offen offset:3072 nt lds
  s_add_u32 s71, s71, 8192
  v_mfma_f32_16x16x32_bf16 a[140:143], v[204:207], v[140:143], a[140:143]
  ds_read_b128 a[204:207], v10 offset:20480
  ds_read_b128 a[208:211], v11 offset:20480
  v_mfma_f32_16x16x32_bf16 a[160:163], v[20:23], v[140:143], a[160:163]
  v_cvt_pk_bf16_f32 v139, v126, v127
  s_waitcnt lgkmcnt(0)
  v_mfma_f32_16x16x32_bf16 v[120:123], a[212:215], v[52:55], v[220:223]
  v_max3_f32 v228, v128, v129, v130
  v_max3_f32 v229, v131, v132, v133
  v_mfma_f32_16x16x32_bf16 v[120:123], a[216:219], v[72:75], v[120:123]
  v_max3_f32 v228, v228, v134, v135
  v_max_f32 v228, v228, v229
  v_mfma_f32_16x16x32_bf16 v[120:123], a[220:223], v[92:95], v[120:123]
  v_cmp_lt_f32 vcc, s80, v228
  s_cbranch_vccnz L_slowX7
L_retX7:
  v_mfma_f32_16x16x32_bf16 v[120:123], a[224:227], v[112:115], v[120:123]
  v_exp_f32 v128, v128
  s_cmp_eq_u32 s72, 6
  s_cbranch_scc1 L_hkX0
L_hkX0_ret:
  v_mfma_f32_16x16x32_bf16 v[124:127], a[228:231], v[52:55], v[220:223]
  v_exp_f32 v129, v129
  s_add_u32 m0, s30, 16384
  v_mfma_f32_16x16x32_bf16 v[124:127], a[232:235], v[72:75], v[124:127]
  buffer_load_dwordx4 v1, s[40:43], s73 offen offset:0 nt lds
  v_mfma_f32_16x16x32_bf16 v[124:127], a[236:239], v[92:95], v[124:127]
  v_exp_f32 v130, v130
  v_mfma_f32_16x16x32_bf16 v[124:127], a[240:243], v[112:115], v[124:127]
  v_exp_f32 v131, v131
  v_mfma_f32_16x16x32_bf16 a[4:7], v[176:179], v[136:139], a[4:7]
  v_cvt_pk_bf16_f32 v140, v128, v129
  s_add_u32 m0, s30, 16384
  v_mfma_f32_16x16x32_bf16 a[24:27], v[180:183], v[136:139], a[24:27]
  v_exp_f32 v132, v132
  buffer_load_dwordx4 v2, s[40:43], s73 offen offset:1024 nt lds
  v_mfma_f32_16x16x32_bf16 a[44:47], v[184:187], v[136:139], a[44:47]
  v_exp_f32 v133, v133
  v_mfma_f32_16x16x32_bf16 a[64:67], v[188:191], v[136:139], a[64:67]
  v_cvt_pk_bf16_f32 v141, v130, v131
  v_mfma_f32_16x16x32_bf16 a[84:87], v[192:195], v[136:139], a[84:87]
  v_exp_f32 v134, v134
  v_mfma_f32_16x16x32_bf16 a[104:107], v[196:199], v[136:139], a[104:107]
  v_exp_f32 v135, v135
  v_mfma_f32_16x16x32_bf16 a[124:127], v[200:203], v[136:139], a[124:127]
  v_cvt_pk_bf16_f32 v142, v132, v133
  s_add_u32 m0, s30, 16384
  v_mfma_f32_16x16x32_bf16 a[144:147], v[204:207], v[136:139], a[144:147]
  buffer_load_dwordx4 v3, s[40:43], s73 offen offset:2048 nt lds
  v_mfma_f32_16x16x32_bf16 a[164:167], v[20:23], v[136:139], a[164:167]
  v_cvt_pk_bf16_f32 v143, v134, v135
  s_waitcnt vmcnt(19)
  v_mfma_f32_16x16x32_bf16 v[128:131], a[212:215], v[56:59], v[224:227]
  v_max3_f32 v228, v120, v121, v122
  v_max3_f32 v229, v123, v124, v125
  v_mfma_f32_16x16x32_bf16 v[128:131], a[216:219], v[76:79], v[128:131]
  v_max3_f32 v228, v228, v126, v127
  v_max_f32 v228, v228, v229
  ds_read_b64_tr_b16 v[144:145], v12 offset:24576
  v_mfma_f32_16x16x32_bf16 v[128:131], a[220:223], v[96:99], v[128:131]
  v_cmp_lt_f32 vcc, s80, v228
  s_cbranch_vccnz L_slowX8
L_retX8:
  ds_read_b64_tr_b16 v[146:147], v12 offset:28672
  v_mfma_f32_16x16x32_bf16 v[128:131], a[224:227], v[116:119], v[128:131]
  v_exp_f32 v120, v120
  ds_read_b64_tr_b16 v[148:149], v13 offset:24576
  v_mfma_f32_16x16x32_bf16 v[132:135], a[228:231], v[56:59], v[224:227]
  v_exp_f32 v121, v121
  s_add_u32 m0, s30, 16384
  ds_read_b64_tr_b16 v[150:151], v13 offset:28672
  v_mfma_f32_16x16x32_bf16 v[132:135], a[232:235], v[76:79], v[132:135]
  buffer_load_dwordx4 v4, s[40:43], s73 offen offset:3072 nt lds
  ds_read_b64_tr_b16 v[152:153], v14 offset:24576
  v_mfma_f32_16x16x32_bf16 v[132:135], a[236:239], v[96:99], v[132:135]
  v_exp_f32 v122, v122
  ds_read_b64_tr_b16 v[154:155], v14 offset:28672
  v_mfma_f32_16x16x32_bf16 v[132:135], a[240:243], v[116:119], v[132:135]
  v_exp_f32 v123, v123
  ds_read_b64_tr_b16 v[156:157], v15 offset:24576
  v_mfma_f32_16x16x32_bf16 a[8:11], v[176:179], v[140:143], a[8:11]
  v_cvt_pk_bf16_f32 v136, v120, v121
  ds_read_b64_tr_b16 v[158:159], v15 offset:28672
  v_mfma_f32_16x16x32_bf16 a[28:31], v[180:183], v[140:143], a[28:31]
  v_exp_f32 v124, v124
  s_add_u32 m0, s30, 20480
  s_add_u32 s77, s73, 4096
  ds_read_b64_tr_b16 v[160:161], v16 offset:24576
  v_mfma_f32_16x16x32_bf16 a[48:51], v[184:187], v[140:143], a[48:51]
  v_exp_f32 v125, v125
  buffer_load_dwordx4 v1, s[40:43], s77 offen offset:0 nt lds
  ds_read_b64_tr_b16 v[162:163], v16 offset:28672
  v_mfma_f32_16x16x32_bf16 a[68:71], v[188:191], v[140:143], a[68:71]
  v_cvt_pk_bf16_f32 v137, v122, v123
  ds_read_b64_tr_b16 v[164:165], v17 offset:24576
  v_mfma_f32_16x16x32_bf16 a[88:91], v[192:195], v[140:143], a[88:91]
  v_exp_f32 v126, v126
  ds_read_b64_tr_b16 v[166:167], v17 offset:28672
  v_mfma_f32_16x16x32_bf16 a[108:111], v[196:199], v[140:143], a[108:111]
  v_exp_f32 v127, v127
  ds_read_b64_tr_b16 v[168:169], v18 offset:24576
  v_mfma_f32_16x16x32_bf16 a[128:131], v[200:203], v[140:143], a[128:131]
  v_cvt_pk_bf16_f32 v138, v124, v125
  s_add_u32 m0, s30, 20480
  s_add_u32 s77, s73, 4096
  ds_read_b64_tr_b16 v[170:171], v18 offset:28672
  v_mfma_f32_16x16x32_bf16 a[148:151], v[204:207], v[140:143], a[148:151]
  buffer_load_dwordx4 v2, s[40:43], s77 offen offset:1024 nt lds
  ds_read_b64_tr_b16 v[172:173], v19 offset:24576
  v_mfma_f32_16x16x32_bf16 a[168:171], v[20:23], v[140:143], a[168:171]
  v_cvt_pk_bf16_f32 v139, v126, v127
  ds_read_b64_tr_b16 v[174:175], v19 offset:28672
  s_waitcnt lgkmcnt(0)
  v_mfma_f32_16x16x32_bf16 v[120:123], a[180:183], v[40:43], v[208:211]
  v_max3_f32 v228, v128, v129, v130
  v_max3_f32 v229, v131, v132, v133
  v_mfma_f32_16x16x32_bf16 v[120:123], a[184:187], v[60:63], v[120:123]
  v_max3_f32 v228, v228, v134, v135
  v_max_f32 v228, v228, v229
  v_mfma_f32_16x16x32_bf16 v[120:123], a[188:191], v[80:83], v[120:123]
  v_cmp_lt_f32 vcc, s80, v228
  s_cbranch_vccnz L_slowX9
L_retX9:
  v_mfma_f32_16x16x32_bf16 v[120:123], a[192:195], v[100:103], v[120:123]
  v_exp_f32 v128, v128
  s_cmp_eq_u32 s72, 6
  s_cbranch_scc1 L_hkX1
L_hkX1_ret:
  v_mfma_f32_16x16x32_bf16 v[124:127], a[196:199], v[40:43], v[208:211]
  v_exp_f32 v129, v129
  s_add_u32 m0, s30, 20480
  s_add_u32 s77, s73, 4096
  v_mfma_f32_16x16x32_bf16 v[124:127], a[200:203], v[60:63], v[124:127]
  buffer_load_dwordx4 v3, s[40:43], s77 offen offset:2048 nt lds
  v_mfma_f32_16x16x32_bf16 v[124:127], a[204:207], v[80:83], v[124:127]
  v_exp_f32 v130, v130
  v_mfma_f32_16x16x32_bf16 v[124:127], a[208:211], v[100:103], v[124:127]
  v_exp_f32 v131, v131
  v_mfma_f32_16x16x32_bf16 a[12:15], v[176:179], v[136:139], a[12:15]
  v_cvt_pk_bf16_f32 v140, v128, v129
  s_add_u32 m0, s30, 20480
  s_add_u32 s77, s73, 4096
  v_mfma_f32_16x16x32_bf16 a[32:35], v[180:183], v[136:139], a[32:35]
  v_exp_f32 v132, v132
  buffer_load_dwordx4 v4, s[40:43], s77 offen offset:3072 nt lds
  s_add_u32 s73, s73, 8192
  v_mfma_f32_16x16x32_bf16 a[52:55], v[184:187], v[136:139], a[52:55]
  v_exp_f32 v133, v133
  v_mfma_f32_16x16x32_bf16 a[72:75], v[188:191], v[136:139], a[72:75]
  v_cvt_pk_bf16_f32 v141, v130, v131
  v_mfma_f32_16x16x32_bf16 a[92:95], v[192:195], v[136:139], a[92:95]
  v_exp_f32 v134, v134
  v_mfma_f32_16x16x32_bf16 a[112:115], v[196:199], v[136:139], a[112:115]
  v_exp_f32 v135, v135
  v_mfma_f32_16x16x32_bf16 a[132:135], v[200:203], v[136:139], a[132:135]
  v_cvt_pk_bf16_f32 v142, v132, v133
  s_add_u32 m0, s30, 24576
  v_mfma_f32_16x16x32_bf16 a[152:155], v[204:207], v[136:139], a[152:155]
  buffer_load_dwordx4 v5, s[44:47], s71 offen offset:0 nt lds
  v_mfma_f32_16x16x32_bf16 a[172:175], v[20:23], v[136:139], a[172:175]
  v_cvt_pk_bf16_f32 v143, v134, v135
  s_add_u32 s72, s72, 1
  s_cmp_lt_u32 s72, 8
  s_cbranch_scc1 L_loopX
  s_cmp_lg_u32 s64, 0
  s_cbranch_scc1 L_epi
  v_add_u32 v246, 1, v246
  s_mov_b64 exec, 1
  buffer_store_dword v246, v247, s[52:55], s18 offen sc1
  s_mov_b64 exec, -1
  s_branch L_epi
L_hkX2:
  s_add_u32 m0, s69, 0
  s_add_u32 s77, s101, 65536
  buffer_load_dwordx4 v24, s[48:51], s77 offen offset:0 lds
  buffer_load_dwordx4 v25, s[48:51], s77 offen offset:1024 lds
  buffer_load_dwordx4 v26, s[48:51], s77 offen offset:2048 lds
  buffer_load_dwordx4 v27, s[48:51], s77 offen offset:3072 lds
  s_add_u32 m0, s69, 4096
  s_add_u32 s77, s101, 81920
  buffer_load_dwordx4 v24, s[48:51], s77 offen offset:0 lds
  buffer_load_dwordx4 v25, s[48:51], s77 offen offset:1024 lds
  buffer_load_dwordx4 v26, s[48:51], s77 offen offset:2048 lds
  buffer_load_dwordx4 v27, s[48:51], s77 offen offset:3072 lds
  s_branch L_hkX2_ret
L_hkX3:
  s_add_u32 m0, s69, 8192
  s_add_u32 s77, s101, 98304
  buffer_load_dwordx4 v24, s[48:51], s77 offen offset:0 lds
  buffer_load_dwordx4 v25, s[48:51], s77 offen offset:1024 lds
  buffer_load_dwordx4 v26, s[48:51], s77 offen offset:2048 lds
  buffer_load_dwordx4 v27, s[48:51], s77 offen offset:3072 lds
  s_add_u32 m0, s69, 12288
  s_add_u32 s77, s101, 114688
  buffer_load_dwordx4 v24, s[48:51], s77 offen offset:0 lds
  buffer_load_dwordx4 v25, s[48:51], s77 offen offset:1024 lds
  buffer_load_dwordx4 v26, s[48:51], s77 offen offset:2048 lds
  buffer_load_dwordx4 v27, s[48:51], s77 offen offset:3072 lds
  s_branch L_hkX3_ret
L_hkX0:
  s_mov_b32 s42, 0
  s_mov_b32 s46, 0
  s_mov_b32 s30, 0x30000
  s_add_u32 m0, s69, 16384
  s_add_u32 s77, s101, 0
  buffer_load_dwordx4 v24, s[48:51], s77 offen offset:0 lds
  buffer_load_dwordx4 v25, s[48:51], s77 offen offset:1024 lds
  buffer_load_dwordx4 v26, s[48:51], s77 offen offset:2048 lds
  buffer_load_dwordx4 v27, s[48:51], s77 offen offset:3072 lds
  s_add_u32 m0, s69, 20480
  s_add_u32 s77, s101, 16384
  buffer_load_dwordx4 v24, s[48:51], s77 offen offset:0 lds
  buffer_load_dwordx4 v25, s[48:51], s77 offen offset:1024 lds
  buffer_load_dwordx4 v26, s[48:51], s77 offen offset:2048 lds
  buffer_load_dwordx4 v27, s[48:51], s77 offen offset:3072 lds
  s_branch L_hkX0_ret
L_hkX1:
  s_add_u32 m0, s69, 24576
  s_add_u32 s77, s101, 32768
  buffer_load_dwordx4 v24, s[48:51], s77 offen offset:0 lds
  buffer_load_dwordx4 v25, s[48:51], s77 offen offset:1024 lds
  buffer_load_dwordx4 v26, s[48:51], s77 offen offset:2048 lds
  buffer_load_dwordx4 v27, s[48:51], s77 offen offset:3072 lds
  s_add_u32 m0, s69, 28672
  s_add_u32 s77, s101, 49152
  buffer_load_dwordx4 v24, s[48:51], s77 offen offset:0 lds
  buffer_load_dwordx4 v25, s[48:51], s77 offen offset:1024 lds
  buffer_load_dwordx4 v26, s[48:51], s77 offen offset:2048 lds
  buffer_load_dwordx4 v27, s[48:51], s77 offen offset:3072 lds
  s_branch L_hkX1_ret
L_slowX0:
  v_mov_b32 v229, v228
  s_nop 1
  v_permlane32_swap_b32 v228, v229
  v_max_f32 v228, v228, v229
  v_mov_b32 v229, v228
  s_nop 1
  v_permlane16_swap_b32 v228, v229
  v_max_f32 v228, v228, v229
  v_max_f32 v228, s81, v228
  v_max_f32 v230, 0, v228
  v_exp_f32 v230, -v230
  v_sub_f32 v208, v208, v228
  v_sub_f32 v120, v120, v228
  v_sub_f32 v121, v121, v228
  v_sub_f32 v122, v122, v228
  v_sub_f32 v123, v123, v228
  v_sub_f32 v124, v124, v228
  v_sub_f32 v125, v125, v228
  v_sub_f32 v126, v126, v228
  v_sub_f32 v127, v127, v228
  v_mov_b32 v209, v208
  v_mov_b32 v210, v208
  v_mov_b32 v211, v208
  v_accvgpr_read_b32 v229, a0
  v_accvgpr_read_b32 v231, a1
  v_mul_f32 v229, v229, v230
  v_mul_f32 v231, v231, v230
  v_accvgpr_write_b32 a0, v229
  v_accvgpr_write_b32 a1, v231
  v_accvgpr_read_b32 v229, a2
  v_accvgpr_read_b32 v231, a3
  v_mul_f32 v229, v229, v230
  v_mul_f32 v231, v231, v230
  v_accvgpr_write_b32 a2, v229
  v_accvgpr_write_b32 a3, v231
  v_accvgpr_read_b32 v229, a20
  v_accvgpr_read_b32 v231, a21
  v_mul_f32 v229, v229, v230
  v_mul_f32 v231, v231, v230
  v_accvgpr_write_b32 a20, v229
  v_accvgpr_write_b32 a21, v231
  v_accvgpr_read_b32 v229, a22
  v_accvgpr_read_b32 v231, a23
  v_mul_f32 v229, v229, v230
  v_mul_f32 v231, v231, v230
  v_accvgpr_write_b32 a22, v229
  v_accvgpr_write_b32 a23, v231
  v_accvgpr_read_b32 v229, a40
  v_accvgpr_read_b32 v231, a41
  v_mul_f32 v229, v229, v230
  v_mul_f32 v231, v231, v230
  v_accvgpr_write_b32 a40, v229
  v_accvgpr_write_b32 a41, v231
  v_accvgpr_read_b32 v229, a42
  v_accvgpr_read_b32 v231, a43
  v_mul_f32 v229, v229, v230
  v_mul_f32 v231, v231, v230
  v_accvgpr_write_b32 a42, v229
  v_accvgpr_write_b32 a43, v231
  v_accvgpr_read_b32 v229, a60
  v_accvgpr_read_b32 v231, a61
  v_mul_f32 v229, v229, v230
  v_mul_f32 v231, v231, v230
  v_accvgpr_write_b32 a60, v229
  v_accvgpr_write_b32 a61, v231
  v_accvgpr_read_b32 v229, a62
  v_accvgpr_read_b32 v231, a63
  v_mul_f32 v229, v229, v230
  v_mul_f32 v231, v231, v230
  v_accvgpr_write_b32 a62, v229
  v_accvgpr_write_b32 a63, v231
  v_accvgpr_read_b32 v229, a80
  v_accvgpr_read_b32 v231, a81
  v_mul_f32 v229, v229, v230
  v_mul_f32 v231, v231, v230
  v_accvgpr_write_b32 a80, v229
  v_accvgpr_write_b32 a81, v231
  v_accvgpr_read_b32 v229, a82
  v_accvgpr_read_b32 v231, a83
  v_mul_f32 v229, v229, v230
  v_mul_f32 v231, v231, v230
  v_accvgpr_write_b32 a82, v229
  v_accvgpr_write_b32 a83, v231
  v_accvgpr_read_b32 v229, a100
  v_accvgpr_read_b32 v231, a101
  v_mul_f32 v229, v229, v230
  v_mul_f32 v231, v231, v230
  v_accvgpr_write_b32 a100, v229
  v_accvgpr_write_b32 a101, v231
  v_accvgpr_read_b32 v229, a102
  v_accvgpr_read_b32 v231, a103
  v_mul_f32 v229, v229, v230
  v_mul_f32 v231, v231, v230
  v_accvgpr_write_b32 a102, v229
  v_accvgpr_write_b32 a103, v231
  v_accvgpr_read_b32 v229, a120
  v_accvgpr_read_b32 v231, a121
  v_mul_f32 v229, v229, v230
  v_mul_f32 v231, v231, v230
  v_accvgpr_write_b32 a120, v229
  v_accvgpr_write_b32 a121, v231
  v_accvgpr_read_b32 v229, a122
  v_accvgpr_read_b32 v231, a123
  v_mul_f32 v229, v229, v230
  v_mul_f32 v231, v231, v230
  v_accvgpr_write_b32 a122, v229
  v_accvgpr_write_b32 a123, v231
  v_accvgpr_read_b32 v229, a140
  v_accvgpr_read_b32 v231, a141
  v_mul_f32 v229, v229, v230
  v_mul_f32 v231, v231, v230
  v_accvgpr_write_b32 a140, v229
  v_accvgpr_write_b32 a141, v231
  v_accvgpr_read_b32 v229, a142
  v_accvgpr_read_b32 v231, a143
  v_mul_f32 v229, v229, v230
  v_mul_f32 v231, v231, v230
  v_accvgpr_write_b32 a142, v229
  v_accvgpr_write_b32 a143, v231
  v_accvgpr_read_b32 v229, a160
  v_accvgpr_read_b32 v231, a161
  v_mul_f32 v229, v229, v230
  v_mul_f32 v231, v231, v230
  v_accvgpr_write_b32 a160, v229
  v_accvgpr_write_b32 a161, v231
  v_accvgpr_read_b32 v229, a162
  v_accvgpr_read_b32 v231, a163
  v_mul_f32 v229, v229, v230
  v_mul_f32 v231, v231, v230
  v_accvgpr_write_b32 a162, v229
  v_accvgpr_write_b32 a163, v231
  s_nop 1
  s_branch L_retX0
L_slowX1:
  v_mov_b32 v229, v228
  s_nop 1
  v_permlane32_swap_b32 v228, v229
  v_max_f32 v228, v228, v229
  v_mov_b32 v229, v228
  s_nop 1
  v_permlane16_swap_b32 v228, v229
  v_max_f32 v228, v228, v229
  v_max_f32 v228, s81, v228
  v_max_f32 v230, 0, v228
  v_exp_f32 v230, -v230
  v_sub_f32 v212, v212, v228
  v_sub_f32 v128, v128, v228
  v_sub_f32 v129, v129, v228
  v_sub_f32 v130, v130, v228
  v_sub_f32 v131, v131, v228
  v_sub_f32 v132, v132, v228
  v_sub_f32 v133, v133, v228
  v_sub_f32 v134, v134, v228
  v_sub_f32 v135, v135, v228
  v_mov_b32 v213, v212
  v_mov_b32 v214, v212
  v_mov_b32 v215, v212
  v_accvgpr_read_b32 v229, a4
  v_accvgpr_read_b32 v231, a5
  v_mul_f32 v229, v229, v230
  v_mul_f32 v231, v231, v230
  v_accvgpr_write_b32 a4, v229
  v_accvgpr_write_b32 a5, v231
  v_accvgpr_read_b32 v229, a6
  v_accvgpr_read_b32 v231, a7
  v_mul_f32 v229, v229, v230
  v_mul_f32 v231, v231, v230
  v_accvgpr_write_b32 a6, v229
  v_accvgpr_write_b32 a7, v231
  v_accvgpr_read_b32 v229, a24
  v_accvgpr_read_b32 v231, a25
  v_mul_f32 v229, v229, v230
  v_mul_f32 v231, v231, v230
  v_accvgpr_write_b32 a24, v229
  v_accvgpr_write_b32 a25, v231
  v_accvgpr_read_b32 v229, a26
  v_accvgpr_read_b32 v231, a27
  v_mul_f32 v229, v229, v230
  v_mul_f32 v231, v231, v230
  v_accvgpr_write_b32 a26, v229
  v_accvgpr_write_b32 a27, v231
  v_accvgpr_read_b32 v229, a44
  v_accvgpr_read_b32 v231, a45
  v_mul_f32 v229, v229, v230
  v_mul_f32 v231, v231, v230
  v_accvgpr_write_b32 a44, v229
  v_accvgpr_write_b32 a45, v231
  v_accvgpr_read_b32 v229, a46
  v_accvgpr_read_b32 v231, a47
  v_mul_f32 v229, v229, v230
  v_mul_f32 v231, v231, v230
  v_accvgpr_write_b32 a46, v229
  v_accvgpr_write_b32 a47, v231
  v_accvgpr_read_b32 v229, a64
  v_accvgpr_read_b32 v231, a65
  v_mul_f32 v229, v229, v230
  v_mul_f32 v231, v231, v230
  v_accvgpr_write_b32 a64, v229
  v_accvgpr_write_b32 a65, v231
  v_accvgpr_read_b32 v229, a66
  v_accvgpr_read_b32 v231, a67
  v_mul_f32 v229, v229, v230
  v_mul_f32 v231, v231, v230
  v_accvgpr_write_b32 a66, v229
  v_accvgpr_write_b32 a67, v231
  v_accvgpr_read_b32 v229, a84
  v_accvgpr_read_b32 v231, a85
  v_mul_f32 v229, v229, v230
  v_mul_f32 v231, v231, v230
  v_accvgpr_write_b32 a84, v229
  v_accvgpr_write_b32 a85, v231
  v_accvgpr_read_b32 v229, a86
  v_accvgpr_read_b32 v231, a87
  v_mul_f32 v229, v229, v230
  v_mul_f32 v231, v231, v230
  v_accvgpr_write_b32 a86, v229
  v_accvgpr_write_b32 a87, v231
  v_accvgpr_read_b32 v229, a104
  v_accvgpr_read_b32 v231, a105
  v_mul_f32 v229, v229, v230
  v_mul_f32 v231, v231, v230
  v_accvgpr_write_b32 a104, v229
  v_accvgpr_write_b32 a105, v231
  v_accvgpr_read_b32 v229, a106
  v_accvgpr_read_b32 v231, a107
  v_mul_f32 v229, v229, v230
  v_mul_f32 v231, v231, v230
  v_accvgpr_write_b32 a106, v229
  v_accvgpr_write_b32 a107, v231
  v_accvgpr_read_b32 v229, a124
  v_accvgpr_read_b32 v231, a125
  v_mul_f32 v229, v229, v230
  v_mul_f32 v231, v231, v230
  v_accvgpr_write_b32 a124, v229
  v_accvgpr_write_b32 a125, v231
  v_accvgpr_read_b32 v229, a126
  v_accvgpr_read_b32 v231, a127
  v_mul_f32 v229, v229, v230
  v_mul_f32 v231, v231, v230
  v_accvgpr_write_b32 a126, v229
  v_accvgpr_write_b32 a127, v231
  v_accvgpr_read_b32 v229, a144
  v_accvgpr_read_b32 v231, a145
  v_mul_f32 v229, v229, v230
  v_mul_f32 v231, v231, v230
  v_accvgpr_write_b32 a144, v229
  v_accvgpr_write_b32 a145, v231
  v_accvgpr_read_b32 v229, a146
  v_accvgpr_read_b32 v231, a147
  v_mul_f32 v229, v229, v230
  v_mul_f32 v231, v231, v230
  v_accvgpr_write_b32 a146, v229
  v_accvgpr_write_b32 a147, v231
  v_accvgpr_read_b32 v229, a164
  v_accvgpr_read_b32 v231, a165
  v_mul_f32 v229, v229, v230
  v_mul_f32 v231, v231, v230
  v_accvgpr_write_b32 a164, v229
  v_accvgpr_write_b32 a165, v231
  v_accvgpr_read_b32 v229, a166
  v_accvgpr_read_b32 v231, a167
  v_mul_f32 v229, v229, v230
  v_mul_f32 v231, v231, v230
  v_accvgpr_write_b32 a166, v229
  v_accvgpr_write_b32 a167, v231
  s_nop 1
  s_branch L_retX1
L_slowX2:
  v_mov_b32 v229, v228
  s_nop 1
  v_permlane32_swap_b32 v228, v229
  v_max_f32 v228, v228, v229
  v_mov_b32 v229, v228
  s_nop 1
  v_permlane16_swap_b32 v228, v229
  v_max_f32 v228, v228, v229
  v_max_f32 v228, s81, v228
  v_max_f32 v230, 0, v228
  v_exp_f32 v230, -v230
  v_sub_f32 v216, v216, v228
  v_sub_f32 v120, v120, v228
  v_sub_f32 v121, v121, v228
  v_sub_f32 v122, v122, v228
  v_sub_f32 v123, v123, v228
  v_sub_f32 v124, v124, v228
  v_sub_f32 v125, v125, v228
  v_sub_f32 v126, v126, v228
  v_sub_f32 v127, v127, v228
  v_mov_b32 v217, v216
  v_mov_b32 v218, v216
  v_mov_b32 v219, v216
  v_accvgpr_read_b32 v229, a8
  v_accvgpr_read_b32 v231, a9
  v_mul_f32 v229, v229, v230
  v_mul_f32 v231, v231, v230
  v_accvgpr_write_b32 a8, v229
  v_accvgpr_write_b32 a9, v231
  v_accvgpr_read_b32 v229, a10
  v_accvgpr_read_b32 v231, a11
  v_mul_f32 v229, v229, v230
  v_mul_f32 v231, v231, v230
  v_accvgpr_write_b32 a10, v229
  v_accvgpr_write_b32 a11, v231
  v_accvgpr_read_b32 v229, a28
  v_accvgpr_read_b32 v231, a29
  v_mul_f32 v229, v229, v230
  v_mul_f32 v231, v231, v230
  v_accvgpr_write_b32 a28, v229
  v_accvgpr_write_b32 a29, v231
  v_accvgpr_read_b32 v229, a30
  v_accvgpr_read_b32 v231, a31
  v_mul_f32 v229, v229, v230
  v_mul_f32 v231, v231, v230
  v_accvgpr_write_b32 a30, v229
  v_accvgpr_write_b32 a31, v231
  v_accvgpr_read_b32 v229, a48
  v_accvgpr_read_b32 v231, a49
  v_mul_f32 v229, v229, v230
  v_mul_f32 v231, v231, v230
  v_accvgpr_write_b32 a48, v229
  v_accvgpr_write_b32 a49, v231
  v_accvgpr_read_b32 v229, a50
  v_accvgpr_read_b32 v231, a51
  v_mul_f32 v229, v229, v230
  v_mul_f32 v231, v231, v230
  v_accvgpr_write_b32 a50, v229
  v_accvgpr_write_b32 a51, v231
  v_accvgpr_read_b32 v229, a68
  v_accvgpr_read_b32 v231, a69
  v_mul_f32 v229, v229, v230
  v_mul_f32 v231, v231, v230
  v_accvgpr_write_b32 a68, v229
  v_accvgpr_write_b32 a69, v231
  v_accvgpr_read_b32 v229, a70
  v_accvgpr_read_b32 v231, a71
  v_mul_f32 v229, v229, v230
  v_mul_f32 v231, v231, v230
  v_accvgpr_write_b32 a70, v229
  v_accvgpr_write_b32 a71, v231
  v_accvgpr_read_b32 v229, a88
  v_accvgpr_read_b32 v231, a89
  v_mul_f32 v229, v229, v230
  v_mul_f32 v231, v231, v230
  v_accvgpr_write_b32 a88, v229
  v_accvgpr_write_b32 a89, v231
  v_accvgpr_read_b32 v229, a90
  v_accvgpr_read_b32 v231, a91
  v_mul_f32 v229, v229, v230
  v_mul_f32 v231, v231, v230
  v_accvgpr_write_b32 a90, v229
  v_accvgpr_write_b32 a91, v231
  v_accvgpr_read_b32 v229, a108
  v_accvgpr_read_b32 v231, a109
  v_mul_f32 v229, v229, v230
  v_mul_f32 v231, v231, v230
  v_accvgpr_write_b32 a108, v229
  v_accvgpr_write_b32 a109, v231
  v_accvgpr_read_b32 v229, a110
  v_accvgpr_read_b32 v231, a111
  v_mul_f32 v229, v229, v230
  v_mul_f32 v231, v231, v230
  v_accvgpr_write_b32 a110, v229
  v_accvgpr_write_b32 a111, v231
  v_accvgpr_read_b32 v229, a128
  v_accvgpr_read_b32 v231, a129
  v_mul_f32 v229, v229, v230
  v_mul_f32 v231, v231, v230
  v_accvgpr_write_b32 a128, v229
  v_accvgpr_write_b32 a129, v231
  v_accvgpr_read_b32 v229, a130
  v_accvgpr_read_b32 v231, a131
  v_mul_f32 v229, v229, v230
  v_mul_f32 v231, v231, v230
  v_accvgpr_write_b32 a130, v229
  v_accvgpr_write_b32 a131, v231
  v_accvgpr_read_b32 v229, a148
  v_accvgpr_read_b32 v231, a149
  v_mul_f32 v229, v229, v230
  v_mul_f32 v231, v231, v230
  v_accvgpr_write_b32 a148, v229
  v_accvgpr_write_b32 a149, v231
  v_accvgpr_read_b32 v229, a150
  v_accvgpr_read_b32 v231, a151
  v_mul_f32 v229, v229, v230
  v_mul_f32 v231, v231, v230
  v_accvgpr_write_b32 a150, v229
  v_accvgpr_write_b32 a151, v231
  v_accvgpr_read_b32 v229, a168
  v_accvgpr_read_b32 v231, a169
  v_mul_f32 v229, v229, v230
  v_mul_f32 v231, v231, v230
  v_accvgpr_write_b32 a168, v229
  v_accvgpr_write_b32 a169, v231
  v_accvgpr_read_b32 v229, a170
  v_accvgpr_read_b32 v231, a171
  v_mul_f32 v229, v229, v230
  v_mul_f32 v231, v231, v230
  v_accvgpr_write_b32 a170, v229
  v_accvgpr_write_b32 a171, v231
  s_nop 1
  s_branch L_retX2
L_slowX3:
  v_mov_b32 v229, v228
  s_nop 1
  v_permlane32_swap_b32 v228, v229
  v_max_f32 v228, v228, v229
  v_mov_b32 v229, v228
  s_nop 1
  v_permlane16_swap_b32 v228, v229
  v_max_f32 v228, v228, v229
  v_max_f32 v228, s81, v228
  v_max_f32 v230, 0, v228
  v_exp_f32 v230, -v230
  v_sub_f32 v220, v220, v228
  v_sub_f32 v128, v128, v228
  v_sub_f32 v129, v129, v228
  v_sub_f32 v130, v130, v228
  v_sub_f32 v131, v131, v228
  v_sub_f32 v132, v132, v228
  v_sub_f32 v133, v133, v228
  v_sub_f32 v134, v134, v228
  v_sub_f32 v135, v135, v228
  v_mov_b32 v221, v220
  v_mov_b32 v222, v220
  v_mov_b32 v223, v220
  v_accvgpr_read_b32 v229, a12
  v_accvgpr_read_b32 v231, a13
  v_mul_f32 v229, v229, v230
  v_mul_f32 v231, v231, v230
  v_accvgpr_write_b32 a12, v229
  v_accvgpr_write_b32 a13, v231
  v_accvgpr_read_b32 v229, a14
  v_accvgpr_read_b32 v231, a15
  v_mul_f32 v229, v229, v230
  v_mul_f32 v231, v231, v230
  v_accvgpr_write_b32 a14, v229
  v_accvgpr_write_b32 a15, v231
  v_accvgpr_read_b32 v229, a32
  v_accvgpr_read_b32 v231, a33
  v_mul_f32 v229, v229, v230
  v_mul_f32 v231, v231, v230
  v_accvgpr_write_b32 a32, v229
  v_accvgpr_write_b32 a33, v231
  v_accvgpr_read_b32 v229, a34
  v_accvgpr_read_b32 v231, a35
  v_mul_f32 v229, v229, v230
  v_mul_f32 v231, v231, v230
  v_accvgpr_write_b32 a34, v229
  v_accvgpr_write_b32 a35, v231
  v_accvgpr_read_b32 v229, a52
  v_accvgpr_read_b32 v231, a53
  v_mul_f32 v229, v229, v230
  v_mul_f32 v231, v231, v230
  v_accvgpr_write_b32 a52, v229
  v_accvgpr_write_b32 a53, v231
  v_accvgpr_read_b32 v229, a54
  v_accvgpr_read_b32 v231, a55
  v_mul_f32 v229, v229, v230
  v_mul_f32 v231, v231, v230
  v_accvgpr_write_b32 a54, v229
  v_accvgpr_write_b32 a55, v231
  v_accvgpr_read_b32 v229, a72
  v_accvgpr_read_b32 v231, a73
  v_mul_f32 v229, v229, v230
  v_mul_f32 v231, v231, v230
  v_accvgpr_write_b32 a72, v229
  v_accvgpr_write_b32 a73, v231
  v_accvgpr_read_b32 v229, a74
  v_accvgpr_read_b32 v231, a75
  v_mul_f32 v229, v229, v230
  v_mul_f32 v231, v231, v230
  v_accvgpr_write_b32 a74, v229
  v_accvgpr_write_b32 a75, v231
  v_accvgpr_read_b32 v229, a92
  v_accvgpr_read_b32 v231, a93
  v_mul_f32 v229, v229, v230
  v_mul_f32 v231, v231, v230
  v_accvgpr_write_b32 a92, v229
  v_accvgpr_write_b32 a93, v231
  v_accvgpr_read_b32 v229, a94
  v_accvgpr_read_b32 v231, a95
  v_mul_f32 v229, v229, v230
  v_mul_f32 v231, v231, v230
  v_accvgpr_write_b32 a94, v229
  v_accvgpr_write_b32 a95, v231
  v_accvgpr_read_b32 v229, a112
  v_accvgpr_read_b32 v231, a113
  v_mul_f32 v229, v229, v230
  v_mul_f32 v231, v231, v230
  v_accvgpr_write_b32 a112, v229
  v_accvgpr_write_b32 a113, v231
  v_accvgpr_read_b32 v229, a114
  v_accvgpr_read_b32 v231, a115
  v_mul_f32 v229, v229, v230
  v_mul_f32 v231, v231, v230
  v_accvgpr_write_b32 a114, v229
  v_accvgpr_write_b32 a115, v231
  v_accvgpr_read_b32 v229, a132
  v_accvgpr_read_b32 v231, a133
  v_mul_f32 v229, v229, v230
  v_mul_f32 v231, v231, v230
  v_accvgpr_write_b32 a132, v229
  v_accvgpr_write_b32 a133, v231
  v_accvgpr_read_b32 v229, a134
  v_accvgpr_read_b32 v231, a135
  v_mul_f32 v229, v229, v230
  v_mul_f32 v231, v231, v230
  v_accvgpr_write_b32 a134, v229
  v_accvgpr_write_b32 a135, v231
  v_accvgpr_read_b32 v229, a152
  v_accvgpr_read_b32 v231, a153
  v_mul_f32 v229, v229, v230
  v_mul_f32 v231, v231, v230
  v_accvgpr_write_b32 a152, v229
  v_accvgpr_write_b32 a153, v231
  v_accvgpr_read_b32 v229, a154
  v_accvgpr_read_b32 v231, a155
  v_mul_f32 v229, v229, v230
  v_mul_f32 v231, v231, v230
  v_accvgpr_write_b32 a154, v229
  v_accvgpr_write_b32 a155, v231
  v_accvgpr_read_b32 v229, a172
  v_accvgpr_read_b32 v231, a173
  v_mul_f32 v229, v229, v230
  v_mul_f32 v231, v231, v230
  v_accvgpr_write_b32 a172, v229
  v_accvgpr_write_b32 a173, v231
  v_accvgpr_read_b32 v229, a174
  v_accvgpr_read_b32 v231, a175
  v_mul_f32 v229, v229, v230
  v_mul_f32 v231, v231, v230
  v_accvgpr_write_b32 a174, v229
  v_accvgpr_write_b32 a175, v231
  s_nop 1
  s_branch L_retX3
L_slowX4:
  v_mov_b32 v229, v228
  s_nop 1
  v_permlane32_swap_b32 v228, v229
  v_max_f32 v228, v228, v229
  v_mov_b32 v229, v228
  s_nop 1
  v_permlane16_swap_b32 v228, v229
  v_max_f32 v228, v228, v229
  v_max_f32 v228, s81, v228
  v_max_f32 v230, 0, v228
  v_exp_f32 v230, -v230
  v_sub_f32 v224, v224, v228
  v_sub_f32 v120, v120, v228
  v_sub_f32 v121, v121, v228
  v_sub_f32 v122, v122, v228
  v_sub_f32 v123, v123, v228
  v_sub_f32 v124, v124, v228
  v_sub_f32 v125, v125, v228
  v_sub_f32 v126, v126, v228
  v_sub_f32 v127, v127, v228
  v_mov_b32 v225, v224
  v_mov_b32 v226, v224
  v_mov_b32 v227, v224
  v_accvgpr_read_b32 v229, a16
  v_accvgpr_read_b32 v231, a17
  v_mul_f32 v229, v229, v230
  v_mul_f32 v231, v231, v230
  v_accvgpr_write_b32 a16, v229
  v_accvgpr_write_b32 a17, v231
  v_accvgpr_read_b32 v229, a18
  v_accvgpr_read_b32 v231, a19
  v_mul_f32 v229, v229, v230
  v_mul_f32 v231, v231, v230
  v_accvgpr_write_b32 a18, v229
  v_accvgpr_write_b32 a19, v231
  v_accvgpr_read_b32 v229, a36
  v_accvgpr_read_b32 v231, a37
  v_mul_f32 v229, v229, v230
  v_mul_f32 v231, v231, v230
  v_accvgpr_write_b32 a36, v229
  v_accvgpr_write_b32 a37, v231
  v_accvgpr_read_b32 v229, a38
  v_accvgpr_read_b32 v231, a39
  v_mul_f32 v229, v229, v230
  v_mul_f32 v231, v231, v230
  v_accvgpr_write_b32 a38, v229
  v_accvgpr_write_b32 a39, v231
  v_accvgpr_read_b32 v229, a56
  v_accvgpr_read_b32 v231, a57
  v_mul_f32 v229, v229, v230
  v_mul_f32 v231, v231, v230
  v_accvgpr_write_b32 a56, v229
  v_accvgpr_write_b32 a57, v231
  v_accvgpr_read_b32 v229, a58
  v_accvgpr_read_b32 v231, a59
  v_mul_f32 v229, v229, v230
  v_mul_f32 v231, v231, v230
  v_accvgpr_write_b32 a58, v229
  v_accvgpr_write_b32 a59, v231
  v_accvgpr_read_b32 v229, a76
  v_accvgpr_read_b32 v231, a77
  v_mul_f32 v229, v229, v230
  v_mul_f32 v231, v231, v230
  v_accvgpr_write_b32 a76, v229
  v_accvgpr_write_b32 a77, v231
  v_accvgpr_read_b32 v229, a78
  v_accvgpr_read_b32 v231, a79
  v_mul_f32 v229, v229, v230
  v_mul_f32 v231, v231, v230
  v_accvgpr_write_b32 a78, v229
  v_accvgpr_write_b32 a79, v231
  v_accvgpr_read_b32 v229, a96
  v_accvgpr_read_b32 v231, a97
  v_mul_f32 v229, v229, v230
  v_mul_f32 v231, v231, v230
  v_accvgpr_write_b32 a96, v229
  v_accvgpr_write_b32 a97, v231
  v_accvgpr_read_b32 v229, a98
  v_accvgpr_read_b32 v231, a99
  v_mul_f32 v229, v229, v230
  v_mul_f32 v231, v231, v230
  v_accvgpr_write_b32 a98, v229
  v_accvgpr_write_b32 a99, v231
  v_accvgpr_read_b32 v229, a116
  v_accvgpr_read_b32 v231, a117
  v_mul_f32 v229, v229, v230
  v_mul_f32 v231, v231, v230
  v_accvgpr_write_b32 a116, v229
  v_accvgpr_write_b32 a117, v231
  v_accvgpr_read_b32 v229, a118
  v_accvgpr_read_b32 v231, a119
  v_mul_f32 v229, v229, v230
  v_mul_f32 v231, v231, v230
  v_accvgpr_write_b32 a118, v229
  v_accvgpr_write_b32 a119, v231
  v_accvgpr_read_b32 v229, a136
  v_accvgpr_read_b32 v231, a137
  v_mul_f32 v229, v229, v230
  v_mul_f32 v231, v231, v230
  v_accvgpr_write_b32 a136, v229
  v_accvgpr_write_b32 a137, v231
  v_accvgpr_read_b32 v229, a138
  v_accvgpr_read_b32 v231, a139
  v_mul_f32 v229, v229, v230
  v_mul_f32 v231, v231, v230
  v_accvgpr_write_b32 a138, v229
  v_accvgpr_write_b32 a139, v231
  v_accvgpr_read_b32 v229, a156
  v_accvgpr_read_b32 v231, a157
  v_mul_f32 v229, v229, v230
  v_mul_f32 v231, v231, v230
  v_accvgpr_write_b32 a156, v229
  v_accvgpr_write_b32 a157, v231
  v_accvgpr_read_b32 v229, a158
  v_accvgpr_read_b32 v231, a159
  v_mul_f32 v229, v229, v230
  v_mul_f32 v231, v231, v230
  v_accvgpr_write_b32 a158, v229
  v_accvgpr_write_b32 a159, v231
  v_accvgpr_read_b32 v229, a176
  v_accvgpr_read_b32 v231, a177
  v_mul_f32 v229, v229, v230
  v_mul_f32 v231, v231, v230
  v_accvgpr_write_b32 a176, v229
  v_accvgpr_write_b32 a177, v231
  v_accvgpr_read_b32 v229, a178
  v_accvgpr_read_b32 v231, a179
  v_mul_f32 v229, v229, v230
  v_mul_f32 v231, v231, v230
  v_accvgpr_write_b32 a178, v229
  v_accvgpr_write_b32 a179, v231
  s_nop 1
  s_branch L_retX4
L_slowX5:
  v_mov_b32 v229, v228
  s_nop 1
  v_permlane32_swap_b32 v228, v229
  v_max_f32 v228, v228, v229
  v_mov_b32 v229, v228
  s_nop 1
  v_permlane16_swap_b32 v228, v229
  v_max_f32 v228, v228, v229
  v_max_f32 v228, s81, v228
  v_max_f32 v230, 0, v228
  v_exp_f32 v230, -v230
  v_sub_f32 v208, v208, v228
  v_sub_f32 v128, v128, v228
  v_sub_f32 v129, v129, v228
  v_sub_f32 v130, v130, v228
  v_sub_f32 v131, v131, v228
  v_sub_f32 v132, v132, v228
  v_sub_f32 v133, v133, v228
  v_sub_f32 v134, v134, v228
  v_sub_f32 v135, v135, v228
  v_mov_b32 v209, v208
  v_mov_b32 v210, v208
  v_mov_b32 v211, v208
  v_accvgpr_read_b32 v229, a0
  v_accvgpr_read_b32 v231, a1
  v_mul_f32 v229, v229, v230
  v_mul_f32 v231, v231, v230
  v_accvgpr_write_b32 a0, v229
  v_accvgpr_write_b32 a1, v231
  v_accvgpr_read_b32 v229, a2
  v_accvgpr_read_b32 v231, a3
  v_mul_f32 v229, v229, v230
  v_mul_f32 v231, v231, v230
  v_accvgpr_write_b32 a2, v229
  v_accvgpr_write_b32 a3, v231
  v_accvgpr_read_b32 v229, a20
  v_accvgpr_read_b32 v231, a21
  v_mul_f32 v229, v229, v230
  v_mul_f32 v231, v231, v230
  v_accvgpr_write_b32 a20, v229
  v_accvgpr_write_b32 a21, v231
  v_accvgpr_read_b32 v229, a22
  v_accvgpr_read_b32 v231, a23
  v_mul_f32 v229, v229, v230
  v_mul_f32 v231, v231, v230
  v_accvgpr_write_b32 a22, v229
  v_accvgpr_write_b32 a23, v231
  v_accvgpr_read_b32 v229, a40
  v_accvgpr_read_b32 v231, a41
  v_mul_f32 v229, v229, v230
  v_mul_f32 v231, v231, v230
  v_accvgpr_write_b32 a40, v229
  v_accvgpr_write_b32 a41, v231
  v_accvgpr_read_b32 v229, a42
  v_accvgpr_read_b32 v231, a43
  v_mul_f32 v229, v229, v230
  v_mul_f32 v231, v231, v230
  v_accvgpr_write_b32 a42, v229
  v_accvgpr_write_b32 a43, v231
  v_accvgpr_read_b32 v229, a60
  v_accvgpr_read_b32 v231, a61
  v_mul_f32 v229, v229, v230
  v_mul_f32 v231, v231, v230
  v_accvgpr_write_b32 a60, v229
  v_accvgpr_write_b32 a61, v231
  v_accvgpr_read_b32 v229, a62
  v_accvgpr_read_b32 v231, a63
  v_mul_f32 v229, v229, v230
  v_mul_f32 v231, v231, v230
  v_accvgpr_write_b32 a62, v229
  v_accvgpr_write_b32 a63, v231
  v_accvgpr_read_b32 v229, a80
  v_accvgpr_read_b32 v231, a81
  v_mul_f32 v229, v229, v230
  v_mul_f32 v231, v231, v230
  v_accvgpr_write_b32 a80, v229
  v_accvgpr_write_b32 a81, v231
  v_accvgpr_read_b32 v229, a82
  v_accvgpr_read_b32 v231, a83
  v_mul_f32 v229, v229, v230
  v_mul_f32 v231, v231, v230
  v_accvgpr_write_b32 a82, v229
  v_accvgpr_write_b32 a83, v231
  v_accvgpr_read_b32 v229, a100
  v_accvgpr_read_b32 v231, a101
  v_mul_f32 v229, v229, v230
  v_mul_f32 v231, v231, v230
  v_accvgpr_write_b32 a100, v229
  v_accvgpr_write_b32 a101, v231
  v_accvgpr_read_b32 v229, a102
  v_accvgpr_read_b32 v231, a103
  v_mul_f32 v229, v229, v230
  v_mul_f32 v231, v231, v230
  v_accvgpr_write_b32 a102, v229
  v_accvgpr_write_b32 a103, v231
  v_accvgpr_read_b32 v229, a120
  v_accvgpr_read_b32 v231, a121
  v_mul_f32 v229, v229, v230
  v_mul_f32 v231, v231, v230
  v_accvgpr_write_b32 a120, v229
  v_accvgpr_write_b32 a121, v231
  v_accvgpr_read_b32 v229, a122
  v_accvgpr_read_b32 v231, a123
  v_mul_f32 v229, v229, v230
  v_mul_f32 v231, v231, v230
  v_accvgpr_write_b32 a122, v229
  v_accvgpr_write_b32 a123, v231
  v_accvgpr_read_b32 v229, a140
  v_accvgpr_read_b32 v231, a141
  v_mul_f32 v229, v229, v230
  v_mul_f32 v231, v231, v230
  v_accvgpr_write_b32 a140, v229
  v_accvgpr_write_b32 a141, v231
  v_accvgpr_read_b32 v229, a142
  v_accvgpr_read_b32 v231, a143
  v_mul_f32 v229, v229, v230
  v_mul_f32 v231, v231, v230
  v_accvgpr_write_b32 a142, v229
  v_accvgpr_write_b32 a143, v231
  v_accvgpr_read_b32 v229, a160
  v_accvgpr_read_b32 v231, a161
  v_mul_f32 v229, v229, v230
  v_mul_f32 v231, v231, v230
  v_accvgpr_write_b32 a160, v229
  v_accvgpr_write_b32 a161, v231
  v_accvgpr_read_b32 v229, a162
  v_accvgpr_read_b32 v231, a163
  v_mul_f32 v229, v229, v230
  v_mul_f32 v231, v231, v230
  v_accvgpr_write_b32 a162, v229
  v_accvgpr_write_b32 a163, v231
  s_nop 1
  s_branch L_retX5
L_slowX6:
  v_mov_b32 v229, v228
  s_nop 1
  v_permlane32_swap_b32 v228, v229
  v_max_f32 v228, v228, v229
  v_mov_b32 v229, v228
  s_nop 1
  v_permlane16_swap_b32 v228, v229
  v_max_f32 v228, v228, v229
  v_max_f32 v228, s81, v228
  v_max_f32 v230, 0, v228
  v_exp_f32 v230, -v230
  v_sub_f32 v212, v212, v228
  v_sub_f32 v120, v120, v228
  v_sub_f32 v121, v121, v228
  v_sub_f32 v122, v122, v228
  v_sub_f32 v123, v123, v228
  v_sub_f32 v124, v124, v228
  v_sub_f32 v125, v125, v228
  v_sub_f32 v126, v126, v228
  v_sub_f32 v127, v127, v228
  v_mov_b32 v213, v212
  v_mov_b32 v214, v212
  v_mov_b32 v215, v212
  v_accvgpr_read_b32 v229, a4
  v_accvgpr_read_b32 v231, a5
  v_mul_f32 v229, v229, v230
  v_mul_f32 v231, v231, v230
  v_accvgpr_write_b32 a4, v229
  v_accvgpr_write_b32 a5, v231
  v_accvgpr_read_b32 v229, a6
  v_accvgpr_read_b32 v231, a7
  v_mul_f32 v229, v229, v230
  v_mul_f32 v231, v231, v230
  v_accvgpr_write_b32 a6, v229
  v_accvgpr_write_b32 a7, v231
  v_accvgpr_read_b32 v229, a24
  v_accvgpr_read_b32 v231, a25
  v_mul_f32 v229, v229, v230
  v_mul_f32 v231, v231, v230
  v_accvgpr_write_b32 a24, v229
  v_accvgpr_write_b32 a25, v231
  v_accvgpr_read_b32 v229, a26
  v_accvgpr_read_b32 v231, a27
  v_mul_f32 v229, v229, v230
  v_mul_f32 v231, v231, v230
  v_accvgpr_write_b32 a26, v229
  v_accvgpr_write_b32 a27, v231
  v_accvgpr_read_b32 v229, a44
  v_accvgpr_read_b32 v231, a45
  v_mul_f32 v229, v229, v230
  v_mul_f32 v231, v231, v230
  v_accvgpr_write_b32 a44, v229
  v_accvgpr_write_b32 a45, v231
  v_accvgpr_read_b32 v229, a46
  v_accvgpr_read_b32 v231, a47
  v_mul_f32 v229, v229, v230
  v_mul_f32 v231, v231, v230
  v_accvgpr_write_b32 a46, v229
  v_accvgpr_write_b32 a47, v231
  v_accvgpr_read_b32 v229, a64
  v_accvgpr_read_b32 v231, a65
  v_mul_f32 v229, v229, v230
  v_mul_f32 v231, v231, v230
  v_accvgpr_write_b32 a64, v229
  v_accvgpr_write_b32 a65, v231
  v_accvgpr_read_b32 v229, a66
  v_accvgpr_read_b32 v231, a67
  v_mul_f32 v229, v229, v230
  v_mul_f32 v231, v231, v230
  v_accvgpr_write_b32 a66, v229
  v_accvgpr_write_b32 a67, v231
  v_accvgpr_read_b32 v229, a84
  v_accvgpr_read_b32 v231, a85
  v_mul_f32 v229, v229, v230
  v_mul_f32 v231, v231, v230
  v_accvgpr_write_b32 a84, v229
  v_accvgpr_write_b32 a85, v231
  v_accvgpr_read_b32 v229, a86
  v_accvgpr_read_b32 v231, a87
  v_mul_f32 v229, v229, v230
  v_mul_f32 v231, v231, v230
  v_accvgpr_write_b32 a86, v229
  v_accvgpr_write_b32 a87, v231
  v_accvgpr_read_b32 v229, a104
  v_accvgpr_read_b32 v231, a105
  v_mul_f32 v229, v229, v230
  v_mul_f32 v231, v231, v230
  v_accvgpr_write_b32 a104, v229
  v_accvgpr_write_b32 a105, v231
  v_accvgpr_read_b32 v229, a106
  v_accvgpr_read_b32 v231, a107
  v_mul_f32 v229, v229, v230
  v_mul_f32 v231, v231, v230
  v_accvgpr_write_b32 a106, v229
  v_accvgpr_write_b32 a107, v231
  v_accvgpr_read_b32 v229, a124
  v_accvgpr_read_b32 v231, a125
  v_mul_f32 v229, v229, v230
  v_mul_f32 v231, v231, v230
  v_accvgpr_write_b32 a124, v229
  v_accvgpr_write_b32 a125, v231
  v_accvgpr_read_b32 v229, a126
  v_accvgpr_read_b32 v231, a127
  v_mul_f32 v229, v229, v230
  v_mul_f32 v231, v231, v230
  v_accvgpr_write_b32 a126, v229
  v_accvgpr_write_b32 a127, v231
  v_accvgpr_read_b32 v229, a144
  v_accvgpr_read_b32 v231, a145
  v_mul_f32 v229, v229, v230
  v_mul_f32 v231, v231, v230
  v_accvgpr_write_b32 a144, v229
  v_accvgpr_write_b32 a145, v231
  v_accvgpr_read_b32 v229, a146
  v_accvgpr_read_b32 v231, a147
  v_mul_f32 v229, v229, v230
  v_mul_f32 v231, v231, v230
  v_accvgpr_write_b32 a146, v229
  v_accvgpr_write_b32 a147, v231
  v_accvgpr_read_b32 v229, a164
  v_accvgpr_read_b32 v231, a165
  v_mul_f32 v229, v229, v230
  v_mul_f32 v231, v231, v230
  v_accvgpr_write_b32 a164, v229
  v_accvgpr_write_b32 a165, v231
  v_accvgpr_read_b32 v229, a166
  v_accvgpr_read_b32 v231, a167
  v_mul_f32 v229, v229, v230
  v_mul_f32 v231, v231, v230
  v_accvgpr_write_b32 a166, v229
  v_accvgpr_write_b32 a167, v231
  s_nop 1
  s_branch L_retX6
L_slowX7:
  v_mov_b32 v229, v228
  s_nop 1
  v_permlane32_swap_b32 v228, v229
  v_max_f32 v228, v228, v229
  v_mov_b32 v229, v228
  s_nop 1
  v_permlane16_swap_b32 v228, v229
  v_max_f32 v228, v228, v229
  v_max_f32 v228, s81, v228
  v_max_f32 v230, 0, v228
  v_exp_f32 v230, -v230
  v_sub_f32 v216, v216, v228
  v_sub_f32 v128, v128, v228
  v_sub_f32 v129, v129, v228
  v_sub_f32 v130, v130, v228
  v_sub_f32 v131, v131, v228
  v_sub_f32 v132, v132, v228
  v_sub_f32 v133, v133, v228
  v_sub_f32 v134, v134, v228
  v_sub_f32 v135, v135, v228
  v_mov_b32 v217, v216
  v_mov_b32 v218, v216
  v_mov_b32 v219, v216
  v_accvgpr_read_b32 v229, a8
  v_accvgpr_read_b32 v231, a9
  v_mul_f32 v229, v229, v230
  v_mul_f32 v231, v231, v230
  v_accvgpr_write_b32 a8, v229
  v_accvgpr_write_b32 a9, v231
  v_accvgpr_read_b32 v229, a10
  v_accvgpr_read_b32 v231, a11
  v_mul_f32 v229, v229, v230
  v_mul_f32 v231, v231, v230
  v_accvgpr_write_b32 a10, v229
  v_accvgpr_write_b32 a11, v231
  v_accvgpr_read_b32 v229, a28
  v_accvgpr_read_b32 v231, a29
  v_mul_f32 v229, v229, v230
  v_mul_f32 v231, v231, v230
  v_accvgpr_write_b32 a28, v229
  v_accvgpr_write_b32 a29, v231
  v_accvgpr_read_b32 v229, a30
  v_accvgpr_read_b32 v231, a31
  v_mul_f32 v229, v229, v230
  v_mul_f32 v231, v231, v230
  v_accvgpr_write_b32 a30, v229
  v_accvgpr_write_b32 a31, v231
  v_accvgpr_read_b32 v229, a48
  v_accvgpr_read_b32 v231, a49
  v_mul_f32 v229, v229, v230
  v_mul_f32 v231, v231, v230
  v_accvgpr_write_b32 a48, v229
  v_accvgpr_write_b32 a49, v231
  v_accvgpr_read_b32 v229, a50
  v_accvgpr_read_b32 v231, a51
  v_mul_f32 v229, v229, v230
  v_mul_f32 v231, v231, v230
  v_accvgpr_write_b32 a50, v229
  v_accvgpr_write_b32 a51, v231
  v_accvgpr_read_b32 v229, a68
  v_accvgpr_read_b32 v231, a69
  v_mul_f32 v229, v229, v230
  v_mul_f32 v231, v231, v230
  v_accvgpr_write_b32 a68, v229
  v_accvgpr_write_b32 a69, v231
  v_accvgpr_read_b32 v229, a70
  v_accvgpr_read_b32 v231, a71
  v_mul_f32 v229, v229, v230
  v_mul_f32 v231, v231, v230
  v_accvgpr_write_b32 a70, v229
  v_accvgpr_write_b32 a71, v231
  v_accvgpr_read_b32 v229, a88
  v_accvgpr_read_b32 v231, a89
  v_mul_f32 v229, v229, v230
  v_mul_f32 v231, v231, v230
  v_accvgpr_write_b32 a88, v229
  v_accvgpr_write_b32 a89, v231
  v_accvgpr_read_b32 v229, a90
  v_accvgpr_read_b32 v231, a91
  v_mul_f32 v229, v229, v230
  v_mul_f32 v231, v231, v230
  v_accvgpr_write_b32 a90, v229
  v_accvgpr_write_b32 a91, v231
  v_accvgpr_read_b32 v229, a108
  v_accvgpr_read_b32 v231, a109
  v_mul_f32 v229, v229, v230
  v_mul_f32 v231, v231, v230
  v_accvgpr_write_b32 a108, v229
  v_accvgpr_write_b32 a109, v231
  v_accvgpr_read_b32 v229, a110
  v_accvgpr_read_b32 v231, a111
  v_mul_f32 v229, v229, v230
  v_mul_f32 v231, v231, v230
  v_accvgpr_write_b32 a110, v229
  v_accvgpr_write_b32 a111, v231
  v_accvgpr_read_b32 v229, a128
  v_accvgpr_read_b32 v231, a129
  v_mul_f32 v229, v229, v230
  v_mul_f32 v231, v231, v230
  v_accvgpr_write_b32 a128, v229
  v_accvgpr_write_b32 a129, v231
  v_accvgpr_read_b32 v229, a130
  v_accvgpr_read_b32 v231, a131
  v_mul_f32 v229, v229, v230
  v_mul_f32 v231, v231, v230
  v_accvgpr_write_b32 a130, v229
  v_accvgpr_write_b32 a131, v231
  v_accvgpr_read_b32 v229, a148
  v_accvgpr_read_b32 v231, a149
  v_mul_f32 v229, v229, v230
  v_mul_f32 v231, v231, v230
  v_accvgpr_write_b32 a148, v229
  v_accvgpr_write_b32 a149, v231
  v_accvgpr_read_b32 v229, a150
  v_accvgpr_read_b32 v231, a151
  v_mul_f32 v229, v229, v230
  v_mul_f32 v231, v231, v230
  v_accvgpr_write_b32 a150, v229
  v_accvgpr_write_b32 a151, v231
  v_accvgpr_read_b32 v229, a168
  v_accvgpr_read_b32 v231, a169
  v_mul_f32 v229, v229, v230
  v_mul_f32 v231, v231, v230
  v_accvgpr_write_b32 a168, v229
  v_accvgpr_write_b32 a169, v231
  v_accvgpr_read_b32 v229, a170
  v_accvgpr_read_b32 v231, a171
  v_mul_f32 v229, v229, v230
  v_mul_f32 v231, v231, v230
  v_accvgpr_write_b32 a170, v229
  v_accvgpr_write_b32 a171, v231
  s_nop 1
  s_branch L_retX7
L_slowX8:
  v_mov_b32 v229, v228
  s_nop 1
  v_permlane32_swap_b32 v228, v229
  v_max_f32 v228, v228, v229
  v_mov_b32 v229, v228
  s_nop 1
  v_permlane16_swap_b32 v228, v229
  v_max_f32 v228, v228, v229
  v_max_f32 v228, s81, v228
  v_max_f32 v230, 0, v228
  v_exp_f32 v230, -v230
  v_sub_f32 v220, v220, v228
  v_sub_f32 v120, v120, v228
  v_sub_f32 v121, v121, v228
  v_sub_f32 v122, v122, v228
  v_sub_f32 v123, v123, v228
  v_sub_f32 v124, v124, v228
  v_sub_f32 v125, v125, v228
  v_sub_f32 v126, v126, v228
  v_sub_f32 v127, v127, v228
  v_mov_b32 v221, v220
  v_mov_b32 v222, v220
  v_mov_b32 v223, v220
  v_accvgpr_read_b32 v229, a12
  v_accvgpr_read_b32 v231, a13
  v_mul_f32 v229, v229, v230
  v_mul_f32 v231, v231, v230
  v_accvgpr_write_b32 a12, v229
  v_accvgpr_write_b32 a13, v231
  v_accvgpr_read_b32 v229, a14
  v_accvgpr_read_b32 v231, a15
  v_mul_f32 v229, v229, v230
  v_mul_f32 v231, v231, v230
  v_accvgpr_write_b32 a14, v229
  v_accvgpr_write_b32 a15, v231
  v_accvgpr_read_b32 v229, a32
  v_accvgpr_read_b32 v231, a33
  v_mul_f32 v229, v229, v230
  v_mul_f32 v231, v231, v230
  v_accvgpr_write_b32 a32, v229
  v_accvgpr_write_b32 a33, v231
  v_accvgpr_read_b32 v229, a34
  v_accvgpr_read_b32 v231, a35
  v_mul_f32 v229, v229, v230
  v_mul_f32 v231, v231, v230
  v_accvgpr_write_b32 a34, v229
  v_accvgpr_write_b32 a35, v231
  v_accvgpr_read_b32 v229, a52
  v_accvgpr_read_b32 v231, a53
  v_mul_f32 v229, v229, v230
  v_mul_f32 v231, v231, v230
  v_accvgpr_write_b32 a52, v229
  v_accvgpr_write_b32 a53, v231
  v_accvgpr_read_b32 v229, a54
  v_accvgpr_read_b32 v231, a55
  v_mul_f32 v229, v229, v230
  v_mul_f32 v231, v231, v230
  v_accvgpr_write_b32 a54, v229
  v_accvgpr_write_b32 a55, v231
  v_accvgpr_read_b32 v229, a72
  v_accvgpr_read_b32 v231, a73
  v_mul_f32 v229, v229, v230
  v_mul_f32 v231, v231, v230
  v_accvgpr_write_b32 a72, v229
  v_accvgpr_write_b32 a73, v231
  v_accvgpr_read_b32 v229, a74
  v_accvgpr_read_b32 v231, a75
  v_mul_f32 v229, v229, v230
  v_mul_f32 v231, v231, v230
  v_accvgpr_write_b32 a74, v229
  v_accvgpr_write_b32 a75, v231
  v_accvgpr_read_b32 v229, a92
  v_accvgpr_read_b32 v231, a93
  v_mul_f32 v229, v229, v230
  v_mul_f32 v231, v231, v230
  v_accvgpr_write_b32 a92, v229
  v_accvgpr_write_b32 a93, v231
  v_accvgpr_read_b32 v229, a94
  v_accvgpr_read_b32 v231, a95
  v_mul_f32 v229, v229, v230
  v_mul_f32 v231, v231, v230
  v_accvgpr_write_b32 a94, v229
  v_accvgpr_write_b32 a95, v231
  v_accvgpr_read_b32 v229, a112
  v_accvgpr_read_b32 v231, a113
  v_mul_f32 v229, v229, v230
  v_mul_f32 v231, v231, v230
  v_accvgpr_write_b32 a112, v229
  v_accvgpr_write_b32 a113, v231
  v_accvgpr_read_b32 v229, a114
  v_accvgpr_read_b32 v231, a115
  v_mul_f32 v229, v229, v230
  v_mul_f32 v231, v231, v230
  v_accvgpr_write_b32 a114, v229
  v_accvgpr_write_b32 a115, v231
  v_accvgpr_read_b32 v229, a132
  v_accvgpr_read_b32 v231, a133
  v_mul_f32 v229, v229, v230
  v_mul_f32 v231, v231, v230
  v_accvgpr_write_b32 a132, v229
  v_accvgpr_write_b32 a133, v231
  v_accvgpr_read_b32 v229, a134
  v_accvgpr_read_b32 v231, a135
  v_mul_f32 v229, v229, v230
  v_mul_f32 v231, v231, v230
  v_accvgpr_write_b32 a134, v229
  v_accvgpr_write_b32 a135, v231
  v_accvgpr_read_b32 v229, a152
  v_accvgpr_read_b32 v231, a153
  v_mul_f32 v229, v229, v230
  v_mul_f32 v231, v231, v230
  v_accvgpr_write_b32 a152, v229
  v_accvgpr_write_b32 a153, v231
  v_accvgpr_read_b32 v229, a154
  v_accvgpr_read_b32 v231, a155
  v_mul_f32 v229, v229, v230
  v_mul_f32 v231, v231, v230
  v_accvgpr_write_b32 a154, v229
  v_accvgpr_write_b32 a155, v231
  v_accvgpr_read_b32 v229, a172
  v_accvgpr_read_b32 v231, a173
  v_mul_f32 v229, v229, v230
  v_mul_f32 v231, v231, v230
  v_accvgpr_write_b32 a172, v229
  v_accvgpr_write_b32 a173, v231
  v_accvgpr_read_b32 v229, a174
  v_accvgpr_read_b32 v231, a175
  v_mul_f32 v229, v229, v230
  v_mul_f32 v231, v231, v230
  v_accvgpr_write_b32 a174, v229
  v_accvgpr_write_b32 a175, v231
  s_nop 1
  s_branch L_retX8
L_slowX9:
  v_mov_b32 v229, v228
  s_nop 1
  v_permlane32_swap_b32 v228, v229
  v_max_f32 v228, v228, v229
  v_mov_b32 v229, v228
  s_nop 1
  v_permlane16_swap_b32 v228, v229
  v_max_f32 v228, v228, v229
  v_max_f32 v228, s81, v228
  v_max_f32 v230, 0, v228
  v_exp_f32 v230, -v230
  v_sub_f32 v224, v224, v228
  v_sub_f32 v128, v128, v228
  v_sub_f32 v129, v129, v228
  v_sub_f32 v130, v130, v228
  v_sub_f32 v131, v131, v228
  v_sub_f32 v132, v132, v228
  v_sub_f32 v133, v133, v228
  v_sub_f32 v134, v134, v228
  v_sub_f32 v135, v135, v228
  v_mov_b32 v225, v224
  v_mov_b32 v226, v224
  v_mov_b32 v227, v224
  v_accvgpr_read_b32 v229, a16
  v_accvgpr_read_b32 v231, a17
  v_mul_f32 v229, v229, v230
  v_mul_f32 v231, v231, v230
  v_accvgpr_write_b32 a16, v229
  v_accvgpr_write_b32 a17, v231
  v_accvgpr_read_b32 v229, a18
  v_accvgpr_read_b32 v231, a19
  v_mul_f32 v229, v229, v230
  v_mul_f32 v231, v231, v230
  v_accvgpr_write_b32 a18, v229
  v_accvgpr_write_b32 a19, v231
  v_accvgpr_read_b32 v229, a36
  v_accvgpr_read_b32 v231, a37
  v_mul_f32 v229, v229, v230
  v_mul_f32 v231, v231, v230
  v_accvgpr_write_b32 a36, v229
  v_accvgpr_write_b32 a37, v231
  v_accvgpr_read_b32 v229, a38
  v_accvgpr_read_b32 v231, a39
  v_mul_f32 v229, v229, v230
  v_mul_f32 v231, v231, v230
  v_accvgpr_write_b32 a38, v229
  v_accvgpr_write_b32 a39, v231
  v_accvgpr_read_b32 v229, a56
  v_accvgpr_read_b32 v231, a57
  v_mul_f32 v229, v229, v230
  v_mul_f32 v231, v231, v230
  v_accvgpr_write_b32 a56, v229
  v_accvgpr_write_b32 a57, v231
  v_accvgpr_read_b32 v229, a58
  v_accvgpr_read_b32 v231, a59
  v_mul_f32 v229, v229, v230
  v_mul_f32 v231, v231, v230
  v_accvgpr_write_b32 a58, v229
  v_accvgpr_write_b32 a59, v231
  v_accvgpr_read_b32 v229, a76
  v_accvgpr_read_b32 v231, a77
  v_mul_f32 v229, v229, v230
  v_mul_f32 v231, v231, v230
  v_accvgpr_write_b32 a76, v229
  v_accvgpr_write_b32 a77, v231
  v_accvgpr_read_b32 v229, a78
  v_accvgpr_read_b32 v231, a79
  v_mul_f32 v229, v229, v230
  v_mul_f32 v231, v231, v230
  v_accvgpr_write_b32 a78, v229
  v_accvgpr_write_b32 a79, v231
  v_accvgpr_read_b32 v229, a96
  v_accvgpr_read_b32 v231, a97
  v_mul_f32 v229, v229, v230
  v_mul_f32 v231, v231, v230
  v_accvgpr_write_b32 a96, v229
  v_accvgpr_write_b32 a97, v231
  v_accvgpr_read_b32 v229, a98
  v_accvgpr_read_b32 v231, a99
  v_mul_f32 v229, v229, v230
  v_mul_f32 v231, v231, v230
  v_accvgpr_write_b32 a98, v229
  v_accvgpr_write_b32 a99, v231
  v_accvgpr_read_b32 v229, a116
  v_accvgpr_read_b32 v231, a117
  v_mul_f32 v229, v229, v230
  v_mul_f32 v231, v231, v230
  v_accvgpr_write_b32 a116, v229
  v_accvgpr_write_b32 a117, v231
  v_accvgpr_read_b32 v229, a118
  v_accvgpr_read_b32 v231, a119
  v_mul_f32 v229, v229, v230
  v_mul_f32 v231, v231, v230
  v_accvgpr_write_b32 a118, v229
  v_accvgpr_write_b32 a119, v231
  v_accvgpr_read_b32 v229, a136
  v_accvgpr_read_b32 v231, a137
  v_mul_f32 v229, v229, v230
  v_mul_f32 v231, v231, v230
  v_accvgpr_write_b32 a136, v229
  v_accvgpr_write_b32 a137, v231
  v_accvgpr_read_b32 v229, a138
  v_accvgpr_read_b32 v231, a139
  v_mul_f32 v229, v229, v230
  v_mul_f32 v231, v231, v230
  v_accvgpr_write_b32 a138, v229
  v_accvgpr_write_b32 a139, v231
  v_accvgpr_read_b32 v229, a156
  v_accvgpr_read_b32 v231, a157
  v_mul_f32 v229, v229, v230
  v_mul_f32 v231, v231, v230
  v_accvgpr_write_b32 a156, v229
  v_accvgpr_write_b32 a157, v231
  v_accvgpr_read_b32 v229, a158
  v_accvgpr_read_b32 v231, a159
  v_mul_f32 v229, v229, v230
  v_mul_f32 v231, v231, v230
  v_accvgpr_write_b32 a158, v229
  v_accvgpr_write_b32 a159, v231
  v_accvgpr_read_b32 v229, a176
  v_accvgpr_read_b32 v231, a177
  v_mul_f32 v229, v229, v230
  v_mul_f32 v231, v231, v230
  v_accvgpr_write_b32 a176, v229
  v_accvgpr_write_b32 a177, v231
  v_accvgpr_read_b32 v229, a178
  v_accvgpr_read_b32 v231, a179
  v_mul_f32 v229, v229, v230
  v_mul_f32 v231, v231, v230
  v_accvgpr_write_b32 a178, v229
  v_accvgpr_write_b32 a179, v231
  s_nop 1
  s_branch L_retX9
L_loopY:
  v_mfma_f32_16x16x32_bf16 v[128:131], a[180:183], v[44:47], v[212:215]
  v_max3_f32 v228, v120, v121, v122
  v_max3_f32 v229, v123, v124, v125
  v_mfma_f32_16x16x32_bf16 v[128:131], a[184:187], v[64:67], v[128:131]
  v_max3_f32 v228, v228, v126, v127
  v_max_f32 v228, v228, v229
  v_mfma_f32_16x16x32_bf16 v[128:131], a[188:191], v[84:87], v[128:131]
  v_cmp_lt_f32 vcc, s80, v228
  s_cbranch_vccnz L_slowY0
L_retY0:
  v_mfma_f32_16x16x32_bf16 v[128:131], a[192:195], v[104:107], v[128:131]
  v_exp_f32 v120, v120
  v_mfma_f32_16x16x32_bf16 v[132:135], a[196:199], v[44:47], v[212:215]
  v_exp_f32 v121, v121
  v_mfma_f32_16x16x32_bf16 v[132:135], a[200:203], v[64:67], v[132:135]
  v_mfma_f32_16x16x32_bf16 v[132:135], a[204:207], v[84:87], v[132:135]
  v_exp_f32 v122, v122
  v_mfma_f32_16x16x32_bf16 v[132:135], a[208:211], v[104:107], v[132:135]
  v_exp_f32 v123, v123
  v_mfma_f32_16x16x32_bf16 a[16:19], v[176:179], v[140:143], a[16:19]
  v_cvt_pk_bf16_f32 v136, v120, v121
  v_mfma_f32_16x16x32_bf16 a[36:39], v[180:183], v[140:143], a[36:39]
  v_exp_f32 v124, v124
  v_mfma_f32_16x16x32_bf16 a[56:59], v[184:187], v[140:143], a[56:59]
  v_exp_f32 v125, v125
  v_mfma_f32_16x16x32_bf16 a[76:79], v[188:191], v[140:143], a[76:79]
  v_cvt_pk_bf16_f32 v137, v122, v123
  v_mfma_f32_16x16x32_bf16 a[96:99], v[192:195], v[140:143], a[96:99]
  v_exp_f32 v126, v126
  v_mfma_f32_16x16x32_bf16 a[116:119], v[196:199], v[140:143], a[116:119]
  v_exp_f32 v127, v127
  v_mfma_f32_16x16x32_bf16 a[136:139], v[200:203], v[140:143], a[136:139]
  v_cvt_pk_bf16_f32 v138, v124, v125
  v_mfma_f32_16x16x32_bf16 a[156:159], v[204:207], v[140:143], a[156:159]
  v_mfma_f32_16x16x32_bf16 a[176:179], v[20:23], v[140:143], a[176:179]
  v_cvt_pk_bf16_f32 v139, v126, v127
  s_waitcnt vmcnt(8)
  s_barrier
  v_mfma_f32_16x16x32_bf16 v[120:123], a[180:183], v[48:51], v[216:219]
  v_max3_f32 v228, v128, v129, v130
  v_max3_f32 v229, v131, v132, v133
  v_mfma_f32_16x16x32_bf16 v[120:123], a[184:187], v[68:71], v[120:123]
  v_max3_f32 v228, v228, v134, v135
  v_max_f32 v228, v228, v229
  ds_read_b128 a[212:215], v8 offset:8192
  ds_read_b128 a[216:219], v9 offset:8192
  v_mfma_f32_16x16x32_bf16 v[120:123], a[188:191], v[88:91], v[120:123]
  v_cmp_lt_f32 vcc, s80, v228
  s_cbranch_vccnz L_slowY1
L_retY1:
  v_mfma_f32_16x16x32_bf16 v[120:123], a[192:195], v[108:111], v[120:123]
  v_exp_f32 v128, v128
  v_mfma_f32_16x16x32_bf16 v[124:127], a[196:199], v[48:51], v[216:219]
  v_exp_f32 v129, v129
  v_mfma_f32_16x16x32_bf16 v[124:127], a[200:203], v[68:71], v[124:127]
  ds_read_b128 a[220:223], v10 offset:8192
  ds_read_b128 a[224:227], v11 offset:8192
  v_mfma_f32_16x16x32_bf16 v[124:127], a[204:207], v[88:91], v[124:127]
  v_exp_f32 v130, v130
  v_mfma_f32_16x16x32_bf16 v[124:127], a[208:211], v[108:111], v[124:127]
  v_exp_f32 v131, v131
  v_mfma_f32_16x16x32_bf16 a[0:3], v[144:147], v[136:139], a[0:3]
  v_cvt_pk_bf16_f32 v140, v128, v129
  ds_read_b128 a[228:231], v8 offset:12288
  ds_read_b128 a[232:235], v9 offset:12288
  v_mfma_f32_16x16x32_bf16 a[20:23], v[148:151], v[136:139], a[20:23]
  v_exp_f32 v132, v132
  v_mfma_f32_16x16x32_bf16 a[40:43], v[152:155], v[136:139], a[40:43]
  v_exp_f32 v133, v133
  v_mfma_f32_16x16x32_bf16 a[60:63], v[156:159], v[136:139], a[60:63]
  v_cvt_pk_bf16_f32 v141, v130, v131
  ds_read_b128 a[236:239], v10 offset:12288
  ds_read_b128 a[240:243], v11 offset:12288
  v_mfma_f32_16x16x32_bf16 a[80:83], v[160:163], v[136:139], a[80:83]
  v_exp_f32 v134, v134
  s_add_u32 m0, s14, 0
  s_nop 0
  buffer_load_dwordx4 v5, s[44:47], s71 offen offset:0  lds
  v_mfma_f32_16x16x32_bf16 a[100:103], v[164:167], v[136:139], a[100:103]
  v_exp_f32 v135, v135
  v_mfma_f32_16x16x32_bf16 a[120:123], v[168:171], v[136:139], a[120:123]
  v_cvt_pk_bf16_f32 v142, v132, v133
  buffer_load_dwordx4 v6, s[44:47], s71 offen offset:1024  lds
  v_mfma_f32_16x16x32_bf16 a[140:143], v[172:175], v[136:139], a[140:143]
  buffer_load_dwordx4 v5, s[44:47], s71 offen offset:2048  lds
  v_mfma_f32_16x16x32_bf16 a[160:163], v[20:23], v[136:139], a[160:163]
  v_cvt_pk_bf16_f32 v143, v134, v135
  buffer_load_dwordx4 v6, s[44:47], s71 offen offset:3072  lds
  s_add_u32 s71, s71, 8192
  v_mfma_f32_16x16x32_bf16 v[128:131], a[180:183], v[52:55], v[220:223]
  v_max3_f32 v228, v120, v121, v122
  v_max3_f32 v229, v123, v124, v125
  v_mfma_f32_16x16x32_bf16 v[128:131], a[184:187], v[72:75], v[128:131]
  v_max3_f32 v228, v228, v126, v127
  v_max_f32 v228, v228, v229
  v_mfma_f32_16x16x32_bf16 v[128:131], a[188:191], v[92:95], v[128:131]
  v_cmp_lt_f32 vcc, s80, v228
  s_cbranch_vccnz L_slowY2
L_retY2:
  v_mfma_f32_16x16x32_bf16 v[128:131], a[192:195], v[112:115], v[128:131]
  v_exp_f32 v120, v120
  v_mfma_f32_16x16x32_bf16 v[132:135], a[196:199], v[52:55], v[220:223]
  v_exp_f32 v121, v121
  v_mfma_f32_16x16x32_bf16 v[132:135], a[200:203], v[72:75], v[132:135]
  v_mfma_f32_16x16x32_bf16 v[132:135], a[204:207], v[92:95], v[132:135]
  v_exp_f32 v122, v122
  v_mfma_f32_16x16x32_bf16 v[132:135], a[208:211], v[112:115], v[132:135]
  v_exp_f32 v123, v123
  v_mfma_f32_16x16x32_bf16 a[4:7], v[144:147], v[140:143], a[4:7]
  v_cvt_pk_bf16_f32 v136, v120, v121
  v_mfma_f32_16x16x32_bf16 a[24:27], v[148:151], v[140:143], a[24:27]
  v_exp_f32 v124, v124
  v_mfma_f32_16x16x32_bf16 a[44:47], v[152:155], v[140:143], a[44:47]
  v_exp_f32 v125, v125
  v_mfma_f32_16x16x32_bf16 a[64:67], v[156:159], v[140:143], a[64:67]
  v_cvt_pk_bf16_f32 v137, v122, v123
  v_mfma_f32_16x16x32_bf16 a[84:87], v[160:163], v[140:143], a[84:87]
  v_exp_f32 v126, v126
  s_waitcnt lgkmcnt(0)
  v_mfma_f32_16x16x32_bf16 a[104:107], v[164:167], v[140:143], a[104:107]
  v_exp_f32 v127, v127
  v_mfma_f32_16x16x32_bf16 a[124:127], v[168:171], v[140:143], a[124:127]
  v_cvt_pk_bf16_f32 v138, v124, v125
  v_mfma_f32_16x16x32_bf16 a[144:147], v[172:175], v[140:143], a[144:147]
  v_mfma_f32_16x16x32_bf16 a[164:167], v[20:23], v[140:143], a[164:167]
  v_cvt_pk_bf16_f32 v139, v126, v127
  s_waitcnt vmcnt(8)
  s_barrier
  v_mfma_f32_16x16x32_bf16 v[120:123], a[180:183], v[56:59], v[224:227]
  v_max3_f32 v228, v128, v129, v130
  v_max3_f32 v229, v131, v132, v133
  v_mfma_f32_16x16x32_bf16 v[120:123], a[184:187], v[76:79], v[120:123]
  v_max3_f32 v228, v228, v134, v135
  v_max_f32 v228, v228, v229
  ds_read_b64_tr_b16 v[176:177], v12 offset:8192
  v_mfma_f32_16x16x32_bf16 v[120:123], a[188:191], v[96:99], v[120:123]
  v_cmp_lt_f32 vcc, s80, v228
  s_cbranch_vccnz L_slowY3
L_retY3:
  ds_read_b64_tr_b16 v[178:179], v12 offset:12288
  v_mfma_f32_16x16x32_bf16 v[120:123], a[192:195], v[116:119], v[120:123]
  v_exp_f32 v128, v128
  ds_read_b64_tr_b16 v[180:181], v13 offset:8192
  v_mfma_f32_16x16x32_bf16 v[124:127], a[196:199], v[56:59], v[224:227]
  v_exp_f32 v129, v129
  ds_read_b64_tr_b16 v[182:183], v13 offset:12288
  v_mfma_f32_16x16x32_bf16 v[124:127], a[200:203], v[76:79], v[124:127]
  ds_read_b64_tr_b16 v[184:185], v14 offset:8192
  v_mfma_f32_16x16x32_bf16 v[124:127], a[204:207], v[96:99], v[124:127]
  v_exp_f32 v130, v130
  ds_read_b64_tr_b16 v[186:187], v14 offset:12288
  v_mfma_f32_16x16x32_bf16 v[124:127], a[208:211], v[116:119], v[124:127]
  v_exp_f32 v131, v131
  ds_read_b64_tr_b16 v[188:189], v15 offset:8192
  v_mfma_f32_16x16x32_bf16 a[8:11], v[144:147], v[136:139], a[8:11]
  v_cvt_pk_bf16_f32 v140, v128, v129
  ds_read_b64_tr_b16 v[190:191], v15 offset:12288
  v_mfma_f32_16x16x32_bf16 a[28:31], v[148:151], v[136:139], a[28:31]
  v_exp_f32 v132, v132
  ds_read_b64_tr_b16 v[192:193], v16 offset:8192
  v_mfma_f32_16x16x32_bf16 a[48:51], v[152:155], v[136:139], a[48:51]
  v_exp_f32 v133, v133
  ds_read_b64_tr_b16 v[194:195], v16 offset:12288
  v_mfma_f32_16x16x32_bf16 a[68:71], v[156:159], v[136:139], a[68:71]
  v_cvt_pk_bf16_f32 v141, v130, v131
  ds_read_b64_tr_b16 v[196:197], v17 offset:8192
  v_mfma_f32_16x16x32_bf16 a[88:91], v[160:163], v[136:139], a[88:91]
  v_exp_f32 v134, v134
  ds_read_b64_tr_b16 v[198:199], v17 offset:12288
  v_mfma_f32_16x16x32_bf16 a[108:111], v[164:167], v[136:139], a[108:111]
  v_exp_f32 v135, v135
  ds_read_b64_tr_b16 v[200:201], v18 offset:8192
  v_mfma_f32_16x16x32_bf16 a[128:131], v[168:171], v[136:139], a[128:131]
  v_cvt_pk_bf16_f32 v142, v132, v133
  ds_read_b64_tr_b16 v[202:203], v18 offset:12288
  v_mfma_f32_16x16x32_bf16 a[148:151], v[172:175], v[136:139], a[148:151]
  ds_read_b64_tr_b16 v[204:205], v19 offset:8192
  v_mfma_f32_16x16x32_bf16 a[168:171], v[20:23], v[136:139], a[168:171]
  v_cvt_pk_bf16_f32 v143, v134, v135
  ds_read_b64_tr_b16 v[206:207], v19 offset:12288
  v_mfma_f32_16x16x32_bf16 v[128:131], a[212:215], v[40:43], v[208:211]
  v_max3_f32 v228, v120, v121, v122
  v_max3_f32 v229, v123, v124, v125
  v_mfma_f32_16x16x32_bf16 v[128:131], a[216:219], v[60:63], v[128:131]
  v_max3_f32 v228, v228, v126, v127
  v_max_f32 v228, v228, v229
  v_mfma_f32_16x16x32_bf16 v[128:131], a[220:223], v[80:83], v[128:131]
  v_cmp_lt_f32 vcc, s80, v228
  s_cbranch_vccnz L_slowY4
L_retY4:
  v_mfma_f32_16x16x32_bf16 v[128:131], a[224:227], v[100:103], v[128:131]
  v_exp_f32 v120, v120
  s_add_u32 m0, s13, 8192
  s_nop 0
  buffer_load_dwordx4 v1, s[40:43], s73 offen offset:0  lds
  v_mfma_f32_16x16x32_bf16 v[132:135], a[228:231], v[40:43], v[208:211]
  v_exp_f32 v121, v121
  v_mfma_f32_16x16x32_bf16 v[132:135], a[232:235], v[60:63], v[132:135]
  buffer_load_dwordx4 v2, s[40:43], s73 offen offset:1024  lds
  v_mfma_f32_16x16x32_bf16 v[132:135], a[236:239], v[80:83], v[132:135]
  v_exp_f32 v122, v122
  buffer_load_dwordx4 v3, s[40:43], s73 offen offset:2048  lds
  v_mfma_f32_16x16x32_bf16 v[132:135], a[240:243], v[100:103], v[132:135]
  v_exp_f32 v123, v123
  v_mfma_f32_16x16x32_bf16 a[12:15], v[144:147], v[140:143], a[12:15]
  v_cvt_pk_bf16_f32 v136, v120, v121
  buffer_load_dwordx4 v4, s[40:43], s73 offen offset:3072  lds
  s_add_u32 s73, s73, 8192
  v_mfma_f32_16x16x32_bf16 a[32:35], v[148:151], v[140:143], a[32:35]
  v_exp_f32 v124, v124
  v_mfma_f32_16x16x32_bf16 a[52:55], v[152:155], v[140:143], a[52:55]
  v_exp_f32 v125, v125
  v_mfma_f32_16x16x32_bf16 a[72:75], v[156:159], v[140:143], a[72:75]
  v_cvt_pk_bf16_f32 v137, v122, v123
  v_mfma_f32_16x16x32_bf16 a[92:95], v[160:163], v[140:143], a[92:95]
  v_exp_f32 v126, v126
  v_mfma_f32_16x16x32_bf16 a[112:115], v[164:167], v[140:143], a[112:115]
  v_exp_f32 v127, v127
  v_mfma_f32_16x16x32_bf16 a[132:135], v[168:171], v[140:143], a[132:135]
  v_cvt_pk_bf16_f32 v138, v124, v125
  v_mfma_f32_16x16x32_bf16 a[152:155], v[172:175], v[140:143], a[152:155]
  v_mfma_f32_16x16x32_bf16 a[172:175], v[20:23], v[140:143], a[172:175]
  v_cvt_pk_bf16_f32 v139, v126, v127
  s_waitcnt lgkmcnt(0)
  s_mov_b32 s80, 0x41000000
  s_mov_b32 s81, 0
  v_mfma_f32_16x16x32_bf16 v[120:123], a[212:215], v[44:47], v[212:215]
  v_max3_f32 v228, v128, v129, v130
  v_max3_f32 v229, v131, v132, v133
  v_mfma_f32_16x16x32_bf16 v[120:123], a[216:219], v[64:67], v[120:123]
  v_max3_f32 v228, v228, v134, v135
  v_max_f32 v228, v228, v229
  v_mfma_f32_16x16x32_bf16 v[120:123], a[220:223], v[84:87], v[120:123]
  v_cmp_lt_f32 vcc, s80, v228
  s_cbranch_vccnz L_slowY5
L_retY5:
  v_mfma_f32_16x16x32_bf16 v[120:123], a[224:227], v[104:107], v[120:123]
  v_exp_f32 v128, v128
  v_mfma_f32_16x16x32_bf16 v[124:127], a[228:231], v[44:47], v[212:215]
  v_exp_f32 v129, v129
  v_mfma_f32_16x16x32_bf16 v[124:127], a[232:235], v[64:67], v[124:127]
  v_mfma_f32_16x16x32_bf16 v[124:127], a[236:239], v[84:87], v[124:127]
  v_exp_f32 v130, v130
  v_mfma_f32_16x16x32_bf16 v[124:127], a[240:243], v[104:107], v[124:127]
  v_exp_f32 v131, v131
  v_mfma_f32_16x16x32_bf16 a[16:19], v[144:147], v[136:139], a[16:19]
  v_cvt_pk_bf16_f32 v140, v128, v129
  v_mfma_f32_16x16x32_bf16 a[36:39], v[148:151], v[136:139], a[36:39]
  v_exp_f32 v132, v132
  v_mfma_f32_16x16x32_bf16 a[56:59], v[152:155], v[136:139], a[56:59]
  v_exp_f32 v133, v133
  v_mfma_f32_16x16x32_bf16 a[76:79], v[156:159], v[136:139], a[76:79]
  v_cvt_pk_bf16_f32 v141, v130, v131
  v_mfma_f32_16x16x32_bf16 a[96:99], v[160:163], v[136:139], a[96:99]
  v_exp_f32 v134, v134
  v_mfma_f32_16x16x32_bf16 a[116:119], v[164:167], v[136:139], a[116:119]
  v_exp_f32 v135, v135
  v_mfma_f32_16x16x32_bf16 a[136:139], v[168:171], v[136:139], a[136:139]
  v_cvt_pk_bf16_f32 v142, v132, v133
  v_mfma_f32_16x16x32_bf16 a[156:159], v[172:175], v[136:139], a[156:159]
  v_mfma_f32_16x16x32_bf16 a[176:179], v[20:23], v[136:139], a[176:179]
  v_cvt_pk_bf16_f32 v143, v134, v135
  s_waitcnt vmcnt(8)
  s_barrier
  v_mfma_f32_16x16x32_bf16 v[128:131], a[212:215], v[48:51], v[216:219]
  v_max3_f32 v228, v120, v121, v122
  v_max3_f32 v229, v123, v124, v125
  v_mfma_f32_16x16x32_bf16 v[128:131], a[216:219], v[68:71], v[128:131]
  v_max3_f32 v228, v228, v126, v127
  v_max_f32 v228, v228, v229
  ds_read_b128 a[180:183], v8 offset:0
  ds_read_b128 a[184:187], v9 offset:0
  v_mfma_f32_16x16x32_bf16 v[128:131], a[220:223], v[88:91], v[128:131]
  v_cmp_lt_f32 vcc, s80, v228
  s_cbranch_vccnz L_slowY6
L_retY6:
  v_mfma_f32_16x16x32_bf16 v[128:131], a[224:227], v[108:111], v[128:131]
  v_exp_f32 v120, v120
  s_cmp_eq_u32 s72, 7
  s_cbranch_scc1 L_hkYW
L_hkYW_ret:
  v_mfma_f32_16x16x32_bf16 v[132:135], a[228:231], v[48:51], v[216:219]
  v_exp_f32 v121, v121
  v_mfma_f32_16x16x32_bf16 v[132:135], a[232:235], v[68:71], v[132:135]
  ds_read_b128 a[188:191], v10 offset:0
  ds_read_b128 a[192:195], v11 offset:0
  v_mfma_f32_16x16x32_bf16 v[132:135], a[236:239], v[88:91], v[132:135]
  v_exp_f32 v122, v122
  v_mfma_f32_16x16x32_bf16 v[132:135], a[240:243], v[108:111], v[132:135]
  v_exp_f32 v123, v123
  v_mfma_f32_16x16x32_bf16 a[0:3], v[176:179], v[140:143], a[0:3]
  v_cvt_pk_bf16_f32 v136, v120, v121
  ds_read_b128 a[196:199], v8 offset:4096
  ds_read_b128 a[200:203], v9 offset:4096
  v_mfma_f32_16x16x32_bf16 a[20:23], v[180:183], v[140:143], a[20:23]
  v_exp_f32 v124, v124
  v_mfma_f32_16x16x32_bf16 a[40:43], v[184:187], v[140:143], a[40:43]
  v_exp_f32 v125, v125
  v_mfma_f32_16x16x32_bf16 a[60:63], v[188:191], v[140:143], a[60:63]
  v_cvt_pk_bf16_f32 v137, v122, v123
  ds_read_b128 a[204:207], v10 offset:4096
  ds_read_b128 a[208:211], v11 offset:4096
  v_mfma_f32_16x16x32_bf16 a[80:83], v[192:195], v[140:143], a[80:83]
  v_exp_f32 v126, v126
  s_add_u32 m0, s14, 8192
  s_nop 0
  buffer_load_dwordx4 v5, s[44:47], s71 offen offset:0  lds
  v_mfma_f32_16x16x32_bf16 a[100:103], v[196:199], v[140:143], a[100:103]
  v_exp_f32 v127, v127
  v_mfma_f32_16x16x32_bf16 a[120:123], v[200:203], v[140:143], a[120:123]
  v_cvt_pk_bf16_f32 v138, v124, v125
  buffer_load_dwordx4 v6, s[44:47], s71 offen offset:1024  lds
  v_mfma_f32_16x16x32_bf16 a[140:143], v[204:207], v[140:143], a[140:143]
  buffer_load_dwordx4 v5, s[44:47], s71 offen offset:2048  lds
  v_mfma_f32_16x16x32_bf16 a[160:163], v[20:23], v[140:143], a[160:163]
  v_cvt_pk_bf16_f32 v139, v126, v127
  buffer_load_dwordx4 v6, s[44:47], s71 offen offset:3072  lds
  s_add_u32 s71, s71, 8192
  v_mfma_f32_16x16x32_bf16 v[120:123], a[212:215], v[52:55], v[220:223]
  v_max3_f32 v228, v128, v129, v130
  v_max3_f32 v229, v131, v132, v133
  v_mfma_f32_16x16x32_bf16 v[120:123], a[216:219], v[72:75], v[120:123]
  v_max3_f32 v228, v228, v134, v135
  v_max_f32 v228, v228, v229
  v_mfma_f32_16x16x32_bf16 v[120:123], a[220:223], v[92:95], v[120:123]
  v_cmp_lt_f32 vcc, s80, v228
  s_cbranch_vccnz L_slowY7
L_retY7:
  v_mfma_f32_16x16x32_bf16 v[120:123], a[224:227], v[112:115], v[120:123]
  v_exp_f32 v128, v128
  v_mfma_f32_16x16x32_bf16 v[124:127], a[228:231], v[52:55], v[220:223]
  v_exp_f32 v129, v129
  v_mfma_f32_16x16x32_bf16 v[124:127], a[232:235], v[72:75], v[124:127]
  v_mfma_f32_16x16x32_bf16 v[124:127], a[236:239], v[92:95], v[124:127]
  v_exp_f32 v130, v130
  v_mfma_f32_16x16x32_bf16 v[124:127], a[240:243], v[112:115], v[124:127]
  v_exp_f32 v131, v131
  v_mfma_f32_16x16x32_bf16 a[4:7], v[176:179], v[136:139], a[4:7]
  v_cvt_pk_bf16_f32 v140, v128, v129
  v_mfma_f32_16x16x32_bf16 a[24:27], v[180:183], v[136:139], a[24:27]
  v_exp_f32 v132, v132
  v_mfma_f32_16x16x32_bf16 a[44:47], v[184:187], v[136:139], a[44:47]
  v_exp_f32 v133, v133
  v_mfma_f32_16x16x32_bf16 a[64:67], v[188:191], v[136:139], a[64:67]
  v_cvt_pk_bf16_f32 v141, v130, v131
  v_mfma_f32_16x16x32_bf16 a[84:87], v[192:195], v[136:139], a[84:87]
  v_exp_f32 v134, v134
  s_waitcnt lgkmcnt(0)
  v_mfma_f32_16x16x32_bf16 a[104:107], v[196:199], v[136:139], a[104:107]
  v_exp_f32 v135, v135
  v_mfma_f32_16x16x32_bf16 a[124:127], v[200:203], v[136:139], a[124:127]
  v_cvt_pk_bf16_f32 v142, v132, v133
  v_mfma_f32_16x16x32_bf16 a[144:147], v[204:207], v[136:139], a[144:147]
  v_mfma_f32_16x16x32_bf16 a[164:167], v[20:23], v[136:139], a[164:167]
  v_cvt_pk_bf16_f32 v143, v134, v135
  s_waitcnt vmcnt(8)
  s_barrier
  v_mfma_f32_16x16x32_bf16 v[128:131], a[212:215], v[56:59], v[224:227]
  v_max3_f32 v228, v120, v121, v122
  v_max3_f32 v229, v123, v124, v125
  v_mfma_f32_16x16x32_bf16 v[128:131], a[216:219], v[76:79], v[128:131]
  v_max3_f32 v228, v228, v126, v127
  v_max_f32 v228, v228, v229
  ds_read_b64_tr_b16 v[144:145], v12 offset:0
  v_mfma_f32_16x16x32_bf16 v[128:131], a[220:223], v[96:99], v[128:131]
  v_cmp_lt_f32 vcc, s80, v228
  s_cbranch_vccnz L_slowY8
L_retY8:
  ds_read_b64_tr_b16 v[146:147], v12 offset:4096
  v_mfma_f32_16x16x32_bf16 v[128:131], a[224:227], v[116:119], v[128:131]
  v_exp_f32 v120, v120
  ds_read_b64_tr_b16 v[148:149], v13 offset:0
  v_mfma_f32_16x16x32_bf16 v[132:135], a[228:231], v[56:59], v[224:227]
  v_exp_f32 v121, v121
  ds_read_b64_tr_b16 v[150:151], v13 offset:4096
  v_mfma_f32_16x16x32_bf16 v[132:135], a[232:235], v[76:79], v[132:135]
  ds_read_b64_tr_b16 v[152:153], v14 offset:0
  v_mfma_f32_16x16x32_bf16 v[132:135], a[236:239], v[96:99], v[132:135]
  v_exp_f32 v122, v122
  ds_read_b64_tr_b16 v[154:155], v14 offset:4096
  v_mfma_f32_16x16x32_bf16 v[132:135], a[240:243], v[116:119], v[132:135]
  v_exp_f32 v123, v123
  ds_read_b64_tr_b16 v[156:157], v15 offset:0
  v_mfma_f32_16x16x32_bf16 a[8:11], v[176:179], v[140:143], a[8:11]
  v_cvt_pk_bf16_f32 v136, v120, v121
  ds_read_b64_tr_b16 v[158:159], v15 offset:4096
  v_mfma_f32_16x16x32_bf16 a[28:31], v[180:183], v[140:143], a[28:31]
  v_exp_f32 v124, v124
  ds_read_b64_tr_b16 v[160:161], v16 offset:0
  v_mfma_f32_16x16x32_bf16 a[48:51], v[184:187], v[140:143], a[48:51]
  v_exp_f32 v125, v125
  ds_read_b64_tr_b16 v[162:163], v16 offset:4096
  v_mfma_f32_16x16x32_bf16 a[68:71], v[188:191], v[140:143], a[68:71]
  v_cvt_pk_bf16_f32 v137, v122, v123
  ds_read_b64_tr_b16 v[164:165], v17 offset:0
  v_mfma_f32_16x16x32_bf16 a[88:91], v[192:195], v[140:143], a[88:91]
  v_exp_f32 v126, v126
  ds_read_b64_tr_b16 v[166:167], v17 offset:4096
  v_mfma_f32_16x16x32_bf16 a[108:111], v[196:199], v[140:143], a[108:111]
  v_exp_f32 v127, v127
  ds_read_b64_tr_b16 v[168:169], v18 offset:0
  v_mfma_f32_16x16x32_bf16 a[128:131], v[200:203], v[140:143], a[128:131]
  v_cvt_pk_bf16_f32 v138, v124, v125
  ds_read_b64_tr_b16 v[170:171], v18 offset:4096
  v_mfma_f32_16x16x32_bf16 a[148:151], v[204:207], v[140:143], a[148:151]
  ds_read_b64_tr_b16 v[172:173], v19 offset:0
  v_mfma_f32_16x16x32_bf16 a[168:171], v[20:23], v[140:143], a[168:171]
  v_cvt_pk_bf16_f32 v139, v126, v127
  ds_read_b64_tr_b16 v[174:175], v19 offset:4096
  v_mfma_f32_16x16x32_bf16 v[120:123], a[180:183], v[40:43], v[208:211]
  v_max3_f32 v228, v128, v129, v130
  v_max3_f32 v229, v131, v132, v133
  v_mfma_f32_16x16x32_bf16 v[120:123], a[184:187], v[60:63], v[120:123]
  v_max3_f32 v228, v228, v134, v135
  v_max_f32 v228, v228, v229
  s_cmp_eq_u32 s72, 6
  s_cbranch_scc1 L_hkYD
L_hkYD_ret:
  v_mfma_f32_16x16x32_bf16 v[120:123], a[188:191], v[80:83], v[120:123]
  v_cmp_lt_f32 vcc, s80, v228
  s_cbranch_vccnz L_slowY9
L_retY9:
  v_mfma_f32_16x16x32_bf16 v[120:123], a[192:195], v[100:103], v[120:123]
  v_exp_f32 v128, v128
  s_add_u32 m0, s13, 0
  s_nop 0
  buffer_load_dwordx4 v1, s[40:43], s73 offen offset:0  lds
  v_mfma_f32_16x16x32_bf16 v[124:127], a[196:199], v[40:43], v[208:211]
  v_exp_f32 v129, v129
  v_mfma_f32_16x16x32_bf16 v[124:127], a[200:203], v[60:63], v[124:127]
  buffer_load_dwordx4 v2, s[40:43], s73 offen offset:1024  lds
  v_mfma_f32_16x16x32_bf16 v[124:127], a[204:207], v[80:83], v[124:127]
  v_exp_f32 v130, v130
  buffer_load_dwordx4 v3, s[40:43], s73 offen offset:2048  lds
  v_mfma_f32_16x16x32_bf16 v[124:127], a[208:211], v[100:103], v[124:127]
  v_exp_f32 v131, v131
  v_mfma_f32_16x16x32_bf16 a[12:15], v[176:179], v[136:139], a[12:15]
  v_cvt_pk_bf16_f32 v140, v128, v129
  buffer_load_dwordx4 v4, s[40:43], s73 offen offset:3072  lds
  s_add_u32 s73, s73, 8192
  v_mfma_f32_16x16x32_bf16 a[32:35], v[180:183], v[136:139], a[32:35]
  v_exp_f32 v132, v132
  v_mfma_f32_16x16x32_bf16 a[52:55], v[184:187], v[136:139], a[52:55]
  v_exp_f32 v133, v133
  v_mfma_f32_16x16x32_bf16 a[72:75], v[188:191], v[136:139], a[72:75]
  v_cvt_pk_bf16_f32 v141, v130, v131
  v_mfma_f32_16x16x32_bf16 a[92:95], v[192:195], v[136:139], a[92:95]
  v_exp_f32 v134, v134
  v_mfma_f32_16x16x32_bf16 a[112:115], v[196:199], v[136:139], a[112:115]
  v_exp_f32 v135, v135
  v_mfma_f32_16x16x32_bf16 a[132:135], v[200:203], v[136:139], a[132:135]
  v_cvt_pk_bf16_f32 v142, v132, v133
  v_mfma_f32_16x16x32_bf16 a[152:155], v[204:207], v[136:139], a[152:155]
  v_mfma_f32_16x16x32_bf16 a[172:175], v[20:23], v[136:139], a[172:175]
  v_cvt_pk_bf16_f32 v143, v134, v135
  s_waitcnt lgkmcnt(0)
  s_add_u32 s72, s72, 1
  s_cmp_lt_u32 s72, 8
  s_cbranch_scc1 L_loopY
  s_waitcnt vmcnt(8)
  s_branch L_epi
L_hkYD:
  s_mov_b32 s42, 0
  s_mov_b32 s46, 0
  s_mov_b32 s13, 0x30000
  s_mov_b32 s14, 0x30000
  s_branch L_hkYD_ret
L_hkYW:
  s_add_u32 m0, s69, 0
  s_add_u32 s77, s101, 65536
  buffer_load_dwordx4 v24, s[48:51], s77 offen offset:0 lds
  buffer_load_dwordx4 v25, s[48:51], s77 offen offset:1024 lds
  buffer_load_dwordx4 v26, s[48:51], s77 offen offset:2048 lds
  buffer_load_dwordx4 v27, s[48:51], s77 offen offset:3072 lds
  s_add_u32 m0, s69, 4096
  s_add_u32 s77, s101, 81920
  buffer_load_dwordx4 v24, s[48:51], s77 offen offset:0 lds
  buffer_load_dwordx4 v25, s[48:51], s77 offen offset:1024 lds
  buffer_load_dwordx4 v26, s[48:51], s77 offen offset:2048 lds
  buffer_load_dwordx4 v27, s[48:51], s77 offen offset:3072 lds
  s_add_u32 m0, s69, 8192
  s_add_u32 s77, s101, 98304
  buffer_load_dwordx4 v24, s[48:51], s77 offen offset:0 lds
  buffer_load_dwordx4 v25, s[48:51], s77 offen offset:1024 lds
  buffer_load_dwordx4 v26, s[48:51], s77 offen offset:2048 lds
  buffer_load_dwordx4 v27, s[48:51], s77 offen offset:3072 lds
  s_add_u32 m0, s69, 12288
  s_add_u32 s77, s101, 114688
  buffer_load_dwordx4 v24, s[48:51], s77 offen offset:0 lds
  buffer_load_dwordx4 v25, s[48:51], s77 offen offset:1024 lds
  buffer_load_dwordx4 v26, s[48:51], s77 offen offset:2048 lds
  buffer_load_dwordx4 v27, s[48:51], s77 offen offset:3072 lds
  s_branch L_hkYW_ret
L_slowY0:
  v_mov_b32 v229, v228
  s_nop 1
  v_permlane32_swap_b32 v228, v229
  v_max_f32 v228, v228, v229
  v_mov_b32 v229, v228
  s_nop 1
  v_permlane16_swap_b32 v228, v229
  v_max_f32 v228, v228, v229
  v_max_f32 v228, s81, v228
  v_max_f32 v230, 0, v228
  v_exp_f32 v230, -v230
  v_sub_f32 v208, v208, v228
  v_sub_f32 v120, v120, v228
  v_sub_f32 v121, v121, v228
  v_sub_f32 v122, v122, v228
  v_sub_f32 v123, v123, v228
  v_sub_f32 v124, v124, v228
  v_sub_f32 v125, v125, v228
  v_sub_f32 v126, v126, v228
  v_sub_f32 v127, v127, v228
  v_mov_b32 v209, v208
  v_mov_b32 v210, v208
  v_mov_b32 v211, v208
  v_accvgpr_read_b32 v229, a0
  v_accvgpr_read_b32 v231, a1
  v_mul_f32 v229, v229, v230
  v_mul_f32 v231, v231, v230
  v_accvgpr_write_b32 a0, v229
  v_accvgpr_write_b32 a1, v231
  v_accvgpr_read_b32 v229, a2
  v_accvgpr_read_b32 v231, a3
  v_mul_f32 v229, v229, v230
  v_mul_f32 v231, v231, v230
  v_accvgpr_write_b32 a2, v229
  v_accvgpr_write_b32 a3, v231
  v_accvgpr_read_b32 v229, a20
  v_accvgpr_read_b32 v231, a21
  v_mul_f32 v229, v229, v230
  v_mul_f32 v231, v231, v230
  v_accvgpr_write_b32 a20, v229
  v_accvgpr_write_b32 a21, v231
  v_accvgpr_read_b32 v229, a22
  v_accvgpr_read_b32 v231, a23
  v_mul_f32 v229, v229, v230
  v_mul_f32 v231, v231, v230
  v_accvgpr_write_b32 a22, v229
  v_accvgpr_write_b32 a23, v231
  v_accvgpr_read_b32 v229, a40
  v_accvgpr_read_b32 v231, a41
  v_mul_f32 v229, v229, v230
  v_mul_f32 v231, v231, v230
  v_accvgpr_write_b32 a40, v229
  v_accvgpr_write_b32 a41, v231
  v_accvgpr_read_b32 v229, a42
  v_accvgpr_read_b32 v231, a43
  v_mul_f32 v229, v229, v230
  v_mul_f32 v231, v231, v230
  v_accvgpr_write_b32 a42, v229
  v_accvgpr_write_b32 a43, v231
  v_accvgpr_read_b32 v229, a60
  v_accvgpr_read_b32 v231, a61
  v_mul_f32 v229, v229, v230
  v_mul_f32 v231, v231, v230
  v_accvgpr_write_b32 a60, v229
  v_accvgpr_write_b32 a61, v231
  v_accvgpr_read_b32 v229, a62
  v_accvgpr_read_b32 v231, a63
  v_mul_f32 v229, v229, v230
  v_mul_f32 v231, v231, v230
  v_accvgpr_write_b32 a62, v229
  v_accvgpr_write_b32 a63, v231
  v_accvgpr_read_b32 v229, a80
  v_accvgpr_read_b32 v231, a81
  v_mul_f32 v229, v229, v230
  v_mul_f32 v231, v231, v230
  v_accvgpr_write_b32 a80, v229
  v_accvgpr_write_b32 a81, v231
  v_accvgpr_read_b32 v229, a82
  v_accvgpr_read_b32 v231, a83
  v_mul_f32 v229, v229, v230
  v_mul_f32 v231, v231, v230
  v_accvgpr_write_b32 a82, v229
  v_accvgpr_write_b32 a83, v231
  v_accvgpr_read_b32 v229, a100
  v_accvgpr_read_b32 v231, a101
  v_mul_f32 v229, v229, v230
  v_mul_f32 v231, v231, v230
  v_accvgpr_write_b32 a100, v229
  v_accvgpr_write_b32 a101, v231
  v_accvgpr_read_b32 v229, a102
  v_accvgpr_read_b32 v231, a103
  v_mul_f32 v229, v229, v230
  v_mul_f32 v231, v231, v230
  v_accvgpr_write_b32 a102, v229
  v_accvgpr_write_b32 a103, v231
  v_accvgpr_read_b32 v229, a120
  v_accvgpr_read_b32 v231, a121
  v_mul_f32 v229, v229, v230
  v_mul_f32 v231, v231, v230
  v_accvgpr_write_b32 a120, v229
  v_accvgpr_write_b32 a121, v231
  v_accvgpr_read_b32 v229, a122
  v_accvgpr_read_b32 v231, a123
  v_mul_f32 v229, v229, v230
  v_mul_f32 v231, v231, v230
  v_accvgpr_write_b32 a122, v229
  v_accvgpr_write_b32 a123, v231
  v_accvgpr_read_b32 v229, a140
  v_accvgpr_read_b32 v231, a141
  v_mul_f32 v229, v229, v230
  v_mul_f32 v231, v231, v230
  v_accvgpr_write_b32 a140, v229
  v_accvgpr_write_b32 a141, v231
  v_accvgpr_read_b32 v229, a142
  v_accvgpr_read_b32 v231, a143
  v_mul_f32 v229, v229, v230
  v_mul_f32 v231, v231, v230
  v_accvgpr_write_b32 a142, v229
  v_accvgpr_write_b32 a143, v231
  v_accvgpr_read_b32 v229, a160
  v_accvgpr_read_b32 v231, a161
  v_mul_f32 v229, v229, v230
  v_mul_f32 v231, v231, v230
  v_accvgpr_write_b32 a160, v229
  v_accvgpr_write_b32 a161, v231
  v_accvgpr_read_b32 v229, a162
  v_accvgpr_read_b32 v231, a163
  v_mul_f32 v229, v229, v230
  v_mul_f32 v231, v231, v230
  v_accvgpr_write_b32 a162, v229
  v_accvgpr_write_b32 a163, v231
  s_nop 1
  s_branch L_retY0
L_slowY1:
  v_mov_b32 v229, v228
  s_nop 1
  v_permlane32_swap_b32 v228, v229
  v_max_f32 v228, v228, v229
  v_mov_b32 v229, v228
  s_nop 1
  v_permlane16_swap_b32 v228, v229
  v_max_f32 v228, v228, v229
  v_max_f32 v228, s81, v228
  v_max_f32 v230, 0, v228
  v_exp_f32 v230, -v230
  v_sub_f32 v212, v212, v228
  v_sub_f32 v128, v128, v228
  v_sub_f32 v129, v129, v228
  v_sub_f32 v130, v130, v228
  v_sub_f32 v131, v131, v228
  v_sub_f32 v132, v132, v228
  v_sub_f32 v133, v133, v228
  v_sub_f32 v134, v134, v228
  v_sub_f32 v135, v135, v228
  v_mov_b32 v213, v212
  v_mov_b32 v214, v212
  v_mov_b32 v215, v212
  v_accvgpr_read_b32 v229, a4
  v_accvgpr_read_b32 v231, a5
  v_mul_f32 v229, v229, v230
  v_mul_f32 v231, v231, v230
  v_accvgpr_write_b32 a4, v229
  v_accvgpr_write_b32 a5, v231
  v_accvgpr_read_b32 v229, a6
  v_accvgpr_read_b32 v231, a7
  v_mul_f32 v229, v229, v230
  v_mul_f32 v231, v231, v230
  v_accvgpr_write_b32 a6, v229
  v_accvgpr_write_b32 a7, v231
  v_accvgpr_read_b32 v229, a24
  v_accvgpr_read_b32 v231, a25
  v_mul_f32 v229, v229, v230
  v_mul_f32 v231, v231, v230
  v_accvgpr_write_b32 a24, v229
  v_accvgpr_write_b32 a25, v231
  v_accvgpr_read_b32 v229, a26
  v_accvgpr_read_b32 v231, a27
  v_mul_f32 v229, v229, v230
  v_mul_f32 v231, v231, v230
  v_accvgpr_write_b32 a26, v229
  v_accvgpr_write_b32 a27, v231
  v_accvgpr_read_b32 v229, a44
  v_accvgpr_read_b32 v231, a45
  v_mul_f32 v229, v229, v230
  v_mul_f32 v231, v231, v230
  v_accvgpr_write_b32 a44, v229
  v_accvgpr_write_b32 a45, v231
  v_accvgpr_read_b32 v229, a46
  v_accvgpr_read_b32 v231, a47
  v_mul_f32 v229, v229, v230
  v_mul_f32 v231, v231, v230
  v_accvgpr_write_b32 a46, v229
  v_accvgpr_write_b32 a47, v231
  v_accvgpr_read_b32 v229, a64
  v_accvgpr_read_b32 v231, a65
  v_mul_f32 v229, v229, v230
  v_mul_f32 v231, v231, v230
  v_accvgpr_write_b32 a64, v229
  v_accvgpr_write_b32 a65, v231
  v_accvgpr_read_b32 v229, a66
  v_accvgpr_read_b32 v231, a67
  v_mul_f32 v229, v229, v230
  v_mul_f32 v231, v231, v230
  v_accvgpr_write_b32 a66, v229
  v_accvgpr_write_b32 a67, v231
  v_accvgpr_read_b32 v229, a84
  v_accvgpr_read_b32 v231, a85
  v_mul_f32 v229, v229, v230
  v_mul_f32 v231, v231, v230
  v_accvgpr_write_b32 a84, v229
  v_accvgpr_write_b32 a85, v231
  v_accvgpr_read_b32 v229, a86
  v_accvgpr_read_b32 v231, a87
  v_mul_f32 v229, v229, v230
  v_mul_f32 v231, v231, v230
  v_accvgpr_write_b32 a86, v229
  v_accvgpr_write_b32 a87, v231
  v_accvgpr_read_b32 v229, a104
  v_accvgpr_read_b32 v231, a105
  v_mul_f32 v229, v229, v230
  v_mul_f32 v231, v231, v230
  v_accvgpr_write_b32 a104, v229
  v_accvgpr_write_b32 a105, v231
  v_accvgpr_read_b32 v229, a106
  v_accvgpr_read_b32 v231, a107
  v_mul_f32 v229, v229, v230
  v_mul_f32 v231, v231, v230
  v_accvgpr_write_b32 a106, v229
  v_accvgpr_write_b32 a107, v231
  v_accvgpr_read_b32 v229, a124
  v_accvgpr_read_b32 v231, a125
  v_mul_f32 v229, v229, v230
  v_mul_f32 v231, v231, v230
  v_accvgpr_write_b32 a124, v229
  v_accvgpr_write_b32 a125, v231
  v_accvgpr_read_b32 v229, a126
  v_accvgpr_read_b32 v231, a127
  v_mul_f32 v229, v229, v230
  v_mul_f32 v231, v231, v230
  v_accvgpr_write_b32 a126, v229
  v_accvgpr_write_b32 a127, v231
  v_accvgpr_read_b32 v229, a144
  v_accvgpr_read_b32 v231, a145
  v_mul_f32 v229, v229, v230
  v_mul_f32 v231, v231, v230
  v_accvgpr_write_b32 a144, v229
  v_accvgpr_write_b32 a145, v231
  v_accvgpr_read_b32 v229, a146
  v_accvgpr_read_b32 v231, a147
  v_mul_f32 v229, v229, v230
  v_mul_f32 v231, v231, v230
  v_accvgpr_write_b32 a146, v229
  v_accvgpr_write_b32 a147, v231
  v_accvgpr_read_b32 v229, a164
  v_accvgpr_read_b32 v231, a165
  v_mul_f32 v229, v229, v230
  v_mul_f32 v231, v231, v230
  v_accvgpr_write_b32 a164, v229
  v_accvgpr_write_b32 a165, v231
  v_accvgpr_read_b32 v229, a166
  v_accvgpr_read_b32 v231, a167
  v_mul_f32 v229, v229, v230
  v_mul_f32 v231, v231, v230
  v_accvgpr_write_b32 a166, v229
  v_accvgpr_write_b32 a167, v231
  s_nop 1
  s_branch L_retY1
L_slowY2:
  v_mov_b32 v229, v228
  s_nop 1
  v_permlane32_swap_b32 v228, v229
  v_max_f32 v228, v228, v229
  v_mov_b32 v229, v228
  s_nop 1
  v_permlane16_swap_b32 v228, v229
  v_max_f32 v228, v228, v229
  v_max_f32 v228, s81, v228
  v_max_f32 v230, 0, v228
  v_exp_f32 v230, -v230
  v_sub_f32 v216, v216, v228
  v_sub_f32 v120, v120, v228
  v_sub_f32 v121, v121, v228
  v_sub_f32 v122, v122, v228
  v_sub_f32 v123, v123, v228
  v_sub_f32 v124, v124, v228
  v_sub_f32 v125, v125, v228
  v_sub_f32 v126, v126, v228
  v_sub_f32 v127, v127, v228
  v_mov_b32 v217, v216
  v_mov_b32 v218, v216
  v_mov_b32 v219, v216
  v_accvgpr_read_b32 v229, a8
  v_accvgpr_read_b32 v231, a9
  v_mul_f32 v229, v229, v230
  v_mul_f32 v231, v231, v230
  v_accvgpr_write_b32 a8, v229
  v_accvgpr_write_b32 a9, v231
  v_accvgpr_read_b32 v229, a10
  v_accvgpr_read_b32 v231, a11
  v_mul_f32 v229, v229, v230
  v_mul_f32 v231, v231, v230
  v_accvgpr_write_b32 a10, v229
  v_accvgpr_write_b32 a11, v231
  v_accvgpr_read_b32 v229, a28
  v_accvgpr_read_b32 v231, a29
  v_mul_f32 v229, v229, v230
  v_mul_f32 v231, v231, v230
  v_accvgpr_write_b32 a28, v229
  v_accvgpr_write_b32 a29, v231
  v_accvgpr_read_b32 v229, a30
  v_accvgpr_read_b32 v231, a31
  v_mul_f32 v229, v229, v230
  v_mul_f32 v231, v231, v230
  v_accvgpr_write_b32 a30, v229
  v_accvgpr_write_b32 a31, v231
  v_accvgpr_read_b32 v229, a48
  v_accvgpr_read_b32 v231, a49
  v_mul_f32 v229, v229, v230
  v_mul_f32 v231, v231, v230
  v_accvgpr_write_b32 a48, v229
  v_accvgpr_write_b32 a49, v231
  v_accvgpr_read_b32 v229, a50
  v_accvgpr_read_b32 v231, a51
  v_mul_f32 v229, v229, v230
  v_mul_f32 v231, v231, v230
  v_accvgpr_write_b32 a50, v229
  v_accvgpr_write_b32 a51, v231
  v_accvgpr_read_b32 v229, a68
  v_accvgpr_read_b32 v231, a69
  v_mul_f32 v229, v229, v230
  v_mul_f32 v231, v231, v230
  v_accvgpr_write_b32 a68, v229
  v_accvgpr_write_b32 a69, v231
  v_accvgpr_read_b32 v229, a70
  v_accvgpr_read_b32 v231, a71
  v_mul_f32 v229, v229, v230
  v_mul_f32 v231, v231, v230
  v_accvgpr_write_b32 a70, v229
  v_accvgpr_write_b32 a71, v231
  v_accvgpr_read_b32 v229, a88
  v_accvgpr_read_b32 v231, a89
  v_mul_f32 v229, v229, v230
  v_mul_f32 v231, v231, v230
  v_accvgpr_write_b32 a88, v229
  v_accvgpr_write_b32 a89, v231
  v_accvgpr_read_b32 v229, a90
  v_accvgpr_read_b32 v231, a91
  v_mul_f32 v229, v229, v230
  v_mul_f32 v231, v231, v230
  v_accvgpr_write_b32 a90, v229
  v_accvgpr_write_b32 a91, v231
  v_accvgpr_read_b32 v229, a108
  v_accvgpr_read_b32 v231, a109
  v_mul_f32 v229, v229, v230
  v_mul_f32 v231, v231, v230
  v_accvgpr_write_b32 a108, v229
  v_accvgpr_write_b32 a109, v231
  v_accvgpr_read_b32 v229, a110
  v_accvgpr_read_b32 v231, a111
  v_mul_f32 v229, v229, v230
  v_mul_f32 v231, v231, v230
  v_accvgpr_write_b32 a110, v229
  v_accvgpr_write_b32 a111, v231
  v_accvgpr_read_b32 v229, a128
  v_accvgpr_read_b32 v231, a129
  v_mul_f32 v229, v229, v230
  v_mul_f32 v231, v231, v230
  v_accvgpr_write_b32 a128, v229
  v_accvgpr_write_b32 a129, v231
  v_accvgpr_read_b32 v229, a130
  v_accvgpr_read_b32 v231, a131
  v_mul_f32 v229, v229, v230
  v_mul_f32 v231, v231, v230
  v_accvgpr_write_b32 a130, v229
  v_accvgpr_write_b32 a131, v231
  v_accvgpr_read_b32 v229, a148
  v_accvgpr_read_b32 v231, a149
  v_mul_f32 v229, v229, v230
  v_mul_f32 v231, v231, v230
  v_accvgpr_write_b32 a148, v229
  v_accvgpr_write_b32 a149, v231
  v_accvgpr_read_b32 v229, a150
  v_accvgpr_read_b32 v231, a151
  v_mul_f32 v229, v229, v230
  v_mul_f32 v231, v231, v230
  v_accvgpr_write_b32 a150, v229
  v_accvgpr_write_b32 a151, v231
  v_accvgpr_read_b32 v229, a168
  v_accvgpr_read_b32 v231, a169
  v_mul_f32 v229, v229, v230
  v_mul_f32 v231, v231, v230
  v_accvgpr_write_b32 a168, v229
  v_accvgpr_write_b32 a169, v231
  v_accvgpr_read_b32 v229, a170
  v_accvgpr_read_b32 v231, a171
  v_mul_f32 v229, v229, v230
  v_mul_f32 v231, v231, v230
  v_accvgpr_write_b32 a170, v229
  v_accvgpr_write_b32 a171, v231
  s_nop 1
  s_branch L_retY2
L_slowY3:
  v_mov_b32 v229, v228
  s_nop 1
  v_permlane32_swap_b32 v228, v229
  v_max_f32 v228, v228, v229
  v_mov_b32 v229, v228
  s_nop 1
  v_permlane16_swap_b32 v228, v229
  v_max_f32 v228, v228, v229
  v_max_f32 v228, s81, v228
  v_max_f32 v230, 0, v228
  v_exp_f32 v230, -v230
  v_sub_f32 v220, v220, v228
  v_sub_f32 v128, v128, v228
  v_sub_f32 v129, v129, v228
  v_sub_f32 v130, v130, v228
  v_sub_f32 v131, v131, v228
  v_sub_f32 v132, v132, v228
  v_sub_f32 v133, v133, v228
  v_sub_f32 v134, v134, v228
  v_sub_f32 v135, v135, v228
  v_mov_b32 v221, v220
  v_mov_b32 v222, v220
  v_mov_b32 v223, v220
  v_accvgpr_read_b32 v229, a12
  v_accvgpr_read_b32 v231, a13
  v_mul_f32 v229, v229, v230
  v_mul_f32 v231, v231, v230
  v_accvgpr_write_b32 a12, v229
  v_accvgpr_write_b32 a13, v231
  v_accvgpr_read_b32 v229, a14
  v_accvgpr_read_b32 v231, a15
  v_mul_f32 v229, v229, v230
  v_mul_f32 v231, v231, v230
  v_accvgpr_write_b32 a14, v229
  v_accvgpr_write_b32 a15, v231
  v_accvgpr_read_b32 v229, a32
  v_accvgpr_read_b32 v231, a33
  v_mul_f32 v229, v229, v230
  v_mul_f32 v231, v231, v230
  v_accvgpr_write_b32 a32, v229
  v_accvgpr_write_b32 a33, v231
  v_accvgpr_read_b32 v229, a34
  v_accvgpr_read_b32 v231, a35
  v_mul_f32 v229, v229, v230
  v_mul_f32 v231, v231, v230
  v_accvgpr_write_b32 a34, v229
  v_accvgpr_write_b32 a35, v231
  v_accvgpr_read_b32 v229, a52
  v_accvgpr_read_b32 v231, a53
  v_mul_f32 v229, v229, v230
  v_mul_f32 v231, v231, v230
  v_accvgpr_write_b32 a52, v229
  v_accvgpr_write_b32 a53, v231
  v_accvgpr_read_b32 v229, a54
  v_accvgpr_read_b32 v231, a55
  v_mul_f32 v229, v229, v230
  v_mul_f32 v231, v231, v230
  v_accvgpr_write_b32 a54, v229
  v_accvgpr_write_b32 a55, v231
  v_accvgpr_read_b32 v229, a72
  v_accvgpr_read_b32 v231, a73
  v_mul_f32 v229, v229, v230
  v_mul_f32 v231, v231, v230
  v_accvgpr_write_b32 a72, v229
  v_accvgpr_write_b32 a73, v231
  v_accvgpr_read_b32 v229, a74
  v_accvgpr_read_b32 v231, a75
  v_mul_f32 v229, v229, v230
  v_mul_f32 v231, v231, v230
  v_accvgpr_write_b32 a74, v229
  v_accvgpr_write_b32 a75, v231
  v_accvgpr_read_b32 v229, a92
  v_accvgpr_read_b32 v231, a93
  v_mul_f32 v229, v229, v230
  v_mul_f32 v231, v231, v230
  v_accvgpr_write_b32 a92, v229
  v_accvgpr_write_b32 a93, v231
  v_accvgpr_read_b32 v229, a94
  v_accvgpr_read_b32 v231, a95
  v_mul_f32 v229, v229, v230
  v_mul_f32 v231, v231, v230
  v_accvgpr_write_b32 a94, v229
  v_accvgpr_write_b32 a95, v231
  v_accvgpr_read_b32 v229, a112
  v_accvgpr_read_b32 v231, a113
  v_mul_f32 v229, v229, v230
  v_mul_f32 v231, v231, v230
  v_accvgpr_write_b32 a112, v229
  v_accvgpr_write_b32 a113, v231
  v_accvgpr_read_b32 v229, a114
  v_accvgpr_read_b32 v231, a115
  v_mul_f32 v229, v229, v230
  v_mul_f32 v231, v231, v230
  v_accvgpr_write_b32 a114, v229
  v_accvgpr_write_b32 a115, v231
  v_accvgpr_read_b32 v229, a132
  v_accvgpr_read_b32 v231, a133
  v_mul_f32 v229, v229, v230
  v_mul_f32 v231, v231, v230
  v_accvgpr_write_b32 a132, v229
  v_accvgpr_write_b32 a133, v231
  v_accvgpr_read_b32 v229, a134
  v_accvgpr_read_b32 v231, a135
  v_mul_f32 v229, v229, v230
  v_mul_f32 v231, v231, v230
  v_accvgpr_write_b32 a134, v229
  v_accvgpr_write_b32 a135, v231
  v_accvgpr_read_b32 v229, a152
  v_accvgpr_read_b32 v231, a153
  v_mul_f32 v229, v229, v230
  v_mul_f32 v231, v231, v230
  v_accvgpr_write_b32 a152, v229
  v_accvgpr_write_b32 a153, v231
  v_accvgpr_read_b32 v229, a154
  v_accvgpr_read_b32 v231, a155
  v_mul_f32 v229, v229, v230
  v_mul_f32 v231, v231, v230
  v_accvgpr_write_b32 a154, v229
  v_accvgpr_write_b32 a155, v231
  v_accvgpr_read_b32 v229, a172
  v_accvgpr_read_b32 v231, a173
  v_mul_f32 v229, v229, v230
  v_mul_f32 v231, v231, v230
  v_accvgpr_write_b32 a172, v229
  v_accvgpr_write_b32 a173, v231
  v_accvgpr_read_b32 v229, a174
  v_accvgpr_read_b32 v231, a175
  v_mul_f32 v229, v229, v230
  v_mul_f32 v231, v231, v230
  v_accvgpr_write_b32 a174, v229
  v_accvgpr_write_b32 a175, v231
  s_nop 1
  s_branch L_retY3
L_slowY4:
  v_mov_b32 v229, v228
  s_nop 1
  v_permlane32_swap_b32 v228, v229
  v_max_f32 v228, v228, v229
  v_mov_b32 v229, v228
  s_nop 1
  v_permlane16_swap_b32 v228, v229
  v_max_f32 v228, v228, v229
  v_max_f32 v228, s81, v228
  v_max_f32 v230, 0, v228
  v_exp_f32 v230, -v230
  v_sub_f32 v224, v224, v228
  v_sub_f32 v120, v120, v228
  v_sub_f32 v121, v121, v228
  v_sub_f32 v122, v122, v228
  v_sub_f32 v123, v123, v228
  v_sub_f32 v124, v124, v228
  v_sub_f32 v125, v125, v228
  v_sub_f32 v126, v126, v228
  v_sub_f32 v127, v127, v228
  v_mov_b32 v225, v224
  v_mov_b32 v226, v224
  v_mov_b32 v227, v224
  v_accvgpr_read_b32 v229, a16
  v_accvgpr_read_b32 v231, a17
  v_mul_f32 v229, v229, v230
  v_mul_f32 v231, v231, v230
  v_accvgpr_write_b32 a16, v229
  v_accvgpr_write_b32 a17, v231
  v_accvgpr_read_b32 v229, a18
  v_accvgpr_read_b32 v231, a19
  v_mul_f32 v229, v229, v230
  v_mul_f32 v231, v231, v230
  v_accvgpr_write_b32 a18, v229
  v_accvgpr_write_b32 a19, v231
  v_accvgpr_read_b32 v229, a36
  v_accvgpr_read_b32 v231, a37
  v_mul_f32 v229, v229, v230
  v_mul_f32 v231, v231, v230
  v_accvgpr_write_b32 a36, v229
  v_accvgpr_write_b32 a37, v231
  v_accvgpr_read_b32 v229, a38
  v_accvgpr_read_b32 v231, a39
  v_mul_f32 v229, v229, v230
  v_mul_f32 v231, v231, v230
  v_accvgpr_write_b32 a38, v229
  v_accvgpr_write_b32 a39, v231
  v_accvgpr_read_b32 v229, a56
  v_accvgpr_read_b32 v231, a57
  v_mul_f32 v229, v229, v230
  v_mul_f32 v231, v231, v230
  v_accvgpr_write_b32 a56, v229
  v_accvgpr_write_b32 a57, v231
  v_accvgpr_read_b32 v229, a58
  v_accvgpr_read_b32 v231, a59
  v_mul_f32 v229, v229, v230
  v_mul_f32 v231, v231, v230
  v_accvgpr_write_b32 a58, v229
  v_accvgpr_write_b32 a59, v231
  v_accvgpr_read_b32 v229, a76
  v_accvgpr_read_b32 v231, a77
  v_mul_f32 v229, v229, v230
  v_mul_f32 v231, v231, v230
  v_accvgpr_write_b32 a76, v229
  v_accvgpr_write_b32 a77, v231
  v_accvgpr_read_b32 v229, a78
  v_accvgpr_read_b32 v231, a79
  v_mul_f32 v229, v229, v230
  v_mul_f32 v231, v231, v230
  v_accvgpr_write_b32 a78, v229
  v_accvgpr_write_b32 a79, v231
  v_accvgpr_read_b32 v229, a96
  v_accvgpr_read_b32 v231, a97
  v_mul_f32 v229, v229, v230
  v_mul_f32 v231, v231, v230
  v_accvgpr_write_b32 a96, v229
  v_accvgpr_write_b32 a97, v231
  v_accvgpr_read_b32 v229, a98
  v_accvgpr_read_b32 v231, a99
  v_mul_f32 v229, v229, v230
  v_mul_f32 v231, v231, v230
  v_accvgpr_write_b32 a98, v229
  v_accvgpr_write_b32 a99, v231
  v_accvgpr_read_b32 v229, a116
  v_accvgpr_read_b32 v231, a117
  v_mul_f32 v229, v229, v230
  v_mul_f32 v231, v231, v230
  v_accvgpr_write_b32 a116, v229
  v_accvgpr_write_b32 a117, v231
  v_accvgpr_read_b32 v229, a118
  v_accvgpr_read_b32 v231, a119
  v_mul_f32 v229, v229, v230
  v_mul_f32 v231, v231, v230
  v_accvgpr_write_b32 a118, v229
  v_accvgpr_write_b32 a119, v231
  v_accvgpr_read_b32 v229, a136
  v_accvgpr_read_b32 v231, a137
  v_mul_f32 v229, v229, v230
  v_mul_f32 v231, v231, v230
  v_accvgpr_write_b32 a136, v229
  v_accvgpr_write_b32 a137, v231
  v_accvgpr_read_b32 v229, a138
  v_accvgpr_read_b32 v231, a139
  v_mul_f32 v229, v229, v230
  v_mul_f32 v231, v231, v230
  v_accvgpr_write_b32 a138, v229
  v_accvgpr_write_b32 a139, v231
  v_accvgpr_read_b32 v229, a156
  v_accvgpr_read_b32 v231, a157
  v_mul_f32 v229, v229, v230
  v_mul_f32 v231, v231, v230
  v_accvgpr_write_b32 a156, v229
  v_accvgpr_write_b32 a157, v231
  v_accvgpr_read_b32 v229, a158
  v_accvgpr_read_b32 v231, a159
  v_mul_f32 v229, v229, v230
  v_mul_f32 v231, v231, v230
  v_accvgpr_write_b32 a158, v229
  v_accvgpr_write_b32 a159, v231
  v_accvgpr_read_b32 v229, a176
  v_accvgpr_read_b32 v231, a177
  v_mul_f32 v229, v229, v230
  v_mul_f32 v231, v231, v230
  v_accvgpr_write_b32 a176, v229
  v_accvgpr_write_b32 a177, v231
  v_accvgpr_read_b32 v229, a178
  v_accvgpr_read_b32 v231, a179
  v_mul_f32 v229, v229, v230
  v_mul_f32 v231, v231, v230
  v_accvgpr_write_b32 a178, v229
  v_accvgpr_write_b32 a179, v231
  s_nop 1
  s_branch L_retY4
L_slowY5:
  v_mov_b32 v229, v228
  s_nop 1
  v_permlane32_swap_b32 v228, v229
  v_max_f32 v228, v228, v229
  v_mov_b32 v229, v228
  s_nop 1
  v_permlane16_swap_b32 v228, v229
  v_max_f32 v228, v228, v229
  v_max_f32 v228, s81, v228
  v_max_f32 v230, 0, v228
  v_exp_f32 v230, -v230
  v_sub_f32 v208, v208, v228
  v_sub_f32 v128, v128, v228
  v_sub_f32 v129, v129, v228
  v_sub_f32 v130, v130, v228
  v_sub_f32 v131, v131, v228
  v_sub_f32 v132, v132, v228
  v_sub_f32 v133, v133, v228
  v_sub_f32 v134, v134, v228
  v_sub_f32 v135, v135, v228
  v_mov_b32 v209, v208
  v_mov_b32 v210, v208
  v_mov_b32 v211, v208
  v_accvgpr_read_b32 v229, a0
  v_accvgpr_read_b32 v231, a1
  v_mul_f32 v229, v229, v230
  v_mul_f32 v231, v231, v230
  v_accvgpr_write_b32 a0, v229
  v_accvgpr_write_b32 a1, v231
  v_accvgpr_read_b32 v229, a2
  v_accvgpr_read_b32 v231, a3
  v_mul_f32 v229, v229, v230
  v_mul_f32 v231, v231, v230
  v_accvgpr_write_b32 a2, v229
  v_accvgpr_write_b32 a3, v231
  v_accvgpr_read_b32 v229, a20
  v_accvgpr_read_b32 v231, a21
  v_mul_f32 v229, v229, v230
  v_mul_f32 v231, v231, v230
  v_accvgpr_write_b32 a20, v229
  v_accvgpr_write_b32 a21, v231
  v_accvgpr_read_b32 v229, a22
  v_accvgpr_read_b32 v231, a23
  v_mul_f32 v229, v229, v230
  v_mul_f32 v231, v231, v230
  v_accvgpr_write_b32 a22, v229
  v_accvgpr_write_b32 a23, v231
  v_accvgpr_read_b32 v229, a40
  v_accvgpr_read_b32 v231, a41
  v_mul_f32 v229, v229, v230
  v_mul_f32 v231, v231, v230
  v_accvgpr_write_b32 a40, v229
  v_accvgpr_write_b32 a41, v231
  v_accvgpr_read_b32 v229, a42
  v_accvgpr_read_b32 v231, a43
  v_mul_f32 v229, v229, v230
  v_mul_f32 v231, v231, v230
  v_accvgpr_write_b32 a42, v229
  v_accvgpr_write_b32 a43, v231
  v_accvgpr_read_b32 v229, a60
  v_accvgpr_read_b32 v231, a61
  v_mul_f32 v229, v229, v230
  v_mul_f32 v231, v231, v230
  v_accvgpr_write_b32 a60, v229
  v_accvgpr_write_b32 a61, v231
  v_accvgpr_read_b32 v229, a62
  v_accvgpr_read_b32 v231, a63
  v_mul_f32 v229, v229, v230
  v_mul_f32 v231, v231, v230
  v_accvgpr_write_b32 a62, v229
  v_accvgpr_write_b32 a63, v231
  v_accvgpr_read_b32 v229, a80
  v_accvgpr_read_b32 v231, a81
  v_mul_f32 v229, v229, v230
  v_mul_f32 v231, v231, v230
  v_accvgpr_write_b32 a80, v229
  v_accvgpr_write_b32 a81, v231
  v_accvgpr_read_b32 v229, a82
  v_accvgpr_read_b32 v231, a83
  v_mul_f32 v229, v229, v230
  v_mul_f32 v231, v231, v230
  v_accvgpr_write_b32 a82, v229
  v_accvgpr_write_b32 a83, v231
  v_accvgpr_read_b32 v229, a100
  v_accvgpr_read_b32 v231, a101
  v_mul_f32 v229, v229, v230
  v_mul_f32 v231, v231, v230
  v_accvgpr_write_b32 a100, v229
  v_accvgpr_write_b32 a101, v231
  v_accvgpr_read_b32 v229, a102
  v_accvgpr_read_b32 v231, a103
  v_mul_f32 v229, v229, v230
  v_mul_f32 v231, v231, v230
  v_accvgpr_write_b32 a102, v229
  v_accvgpr_write_b32 a103, v231
  v_accvgpr_read_b32 v229, a120
  v_accvgpr_read_b32 v231, a121
  v_mul_f32 v229, v229, v230
  v_mul_f32 v231, v231, v230
  v_accvgpr_write_b32 a120, v229
  v_accvgpr_write_b32 a121, v231
  v_accvgpr_read_b32 v229, a122
  v_accvgpr_read_b32 v231, a123
  v_mul_f32 v229, v229, v230
  v_mul_f32 v231, v231, v230
  v_accvgpr_write_b32 a122, v229
  v_accvgpr_write_b32 a123, v231
  v_accvgpr_read_b32 v229, a140
  v_accvgpr_read_b32 v231, a141
  v_mul_f32 v229, v229, v230
  v_mul_f32 v231, v231, v230
  v_accvgpr_write_b32 a140, v229
  v_accvgpr_write_b32 a141, v231
  v_accvgpr_read_b32 v229, a142
  v_accvgpr_read_b32 v231, a143
  v_mul_f32 v229, v229, v230
  v_mul_f32 v231, v231, v230
  v_accvgpr_write_b32 a142, v229
  v_accvgpr_write_b32 a143, v231
  v_accvgpr_read_b32 v229, a160
  v_accvgpr_read_b32 v231, a161
  v_mul_f32 v229, v229, v230
  v_mul_f32 v231, v231, v230
  v_accvgpr_write_b32 a160, v229
  v_accvgpr_write_b32 a161, v231
  v_accvgpr_read_b32 v229, a162
  v_accvgpr_read_b32 v231, a163
  v_mul_f32 v229, v229, v230
  v_mul_f32 v231, v231, v230
  v_accvgpr_write_b32 a162, v229
  v_accvgpr_write_b32 a163, v231
  s_nop 1
  s_branch L_retY5
L_slowY6:
  v_mov_b32 v229, v228
  s_nop 1
  v_permlane32_swap_b32 v228, v229
  v_max_f32 v228, v228, v229
  v_mov_b32 v229, v228
  s_nop 1
  v_permlane16_swap_b32 v228, v229
  v_max_f32 v228, v228, v229
  v_max_f32 v228, s81, v228
  v_max_f32 v230, 0, v228
  v_exp_f32 v230, -v230
  v_sub_f32 v212, v212, v228
  v_sub_f32 v120, v120, v228
  v_sub_f32 v121, v121, v228
  v_sub_f32 v122, v122, v228
  v_sub_f32 v123, v123, v228
  v_sub_f32 v124, v124, v228
  v_sub_f32 v125, v125, v228
  v_sub_f32 v126, v126, v228
  v_sub_f32 v127, v127, v228
  v_mov_b32 v213, v212
  v_mov_b32 v214, v212
  v_mov_b32 v215, v212
  v_accvgpr_read_b32 v229, a4
  v_accvgpr_read_b32 v231, a5
  v_mul_f32 v229, v229, v230
  v_mul_f32 v231, v231, v230
  v_accvgpr_write_b32 a4, v229
  v_accvgpr_write_b32 a5, v231
  v_accvgpr_read_b32 v229, a6
  v_accvgpr_read_b32 v231, a7
  v_mul_f32 v229, v229, v230
  v_mul_f32 v231, v231, v230
  v_accvgpr_write_b32 a6, v229
  v_accvgpr_write_b32 a7, v231
  v_accvgpr_read_b32 v229, a24
  v_accvgpr_read_b32 v231, a25
  v_mul_f32 v229, v229, v230
  v_mul_f32 v231, v231, v230
  v_accvgpr_write_b32 a24, v229
  v_accvgpr_write_b32 a25, v231
  v_accvgpr_read_b32 v229, a26
  v_accvgpr_read_b32 v231, a27
  v_mul_f32 v229, v229, v230
  v_mul_f32 v231, v231, v230
  v_accvgpr_write_b32 a26, v229
  v_accvgpr_write_b32 a27, v231
  v_accvgpr_read_b32 v229, a44
  v_accvgpr_read_b32 v231, a45
  v_mul_f32 v229, v229, v230
  v_mul_f32 v231, v231, v230
  v_accvgpr_write_b32 a44, v229
  v_accvgpr_write_b32 a45, v231
  v_accvgpr_read_b32 v229, a46
  v_accvgpr_read_b32 v231, a47
  v_mul_f32 v229, v229, v230
  v_mul_f32 v231, v231, v230
  v_accvgpr_write_b32 a46, v229
  v_accvgpr_write_b32 a47, v231
  v_accvgpr_read_b32 v229, a64
  v_accvgpr_read_b32 v231, a65
  v_mul_f32 v229, v229, v230
  v_mul_f32 v231, v231, v230
  v_accvgpr_write_b32 a64, v229
  v_accvgpr_write_b32 a65, v231
  v_accvgpr_read_b32 v229, a66
  v_accvgpr_read_b32 v231, a67
  v_mul_f32 v229, v229, v230
  v_mul_f32 v231, v231, v230
  v_accvgpr_write_b32 a66, v229
  v_accvgpr_write_b32 a67, v231
  v_accvgpr_read_b32 v229, a84
  v_accvgpr_read_b32 v231, a85
  v_mul_f32 v229, v229, v230
  v_mul_f32 v231, v231, v230
  v_accvgpr_write_b32 a84, v229
  v_accvgpr_write_b32 a85, v231
  v_accvgpr_read_b32 v229, a86
  v_accvgpr_read_b32 v231, a87
  v_mul_f32 v229, v229, v230
  v_mul_f32 v231, v231, v230
  v_accvgpr_write_b32 a86, v229
  v_accvgpr_write_b32 a87, v231
  v_accvgpr_read_b32 v229, a104
  v_accvgpr_read_b32 v231, a105
  v_mul_f32 v229, v229, v230
  v_mul_f32 v231, v231, v230
  v_accvgpr_write_b32 a104, v229
  v_accvgpr_write_b32 a105, v231
  v_accvgpr_read_b32 v229, a106
  v_accvgpr_read_b32 v231, a107
  v_mul_f32 v229, v229, v230
  v_mul_f32 v231, v231, v230
  v_accvgpr_write_b32 a106, v229
  v_accvgpr_write_b32 a107, v231
  v_accvgpr_read_b32 v229, a124
  v_accvgpr_read_b32 v231, a125
  v_mul_f32 v229, v229, v230
  v_mul_f32 v231, v231, v230
  v_accvgpr_write_b32 a124, v229
  v_accvgpr_write_b32 a125, v231
  v_accvgpr_read_b32 v229, a126
  v_accvgpr_read_b32 v231, a127
  v_mul_f32 v229, v229, v230
  v_mul_f32 v231, v231, v230
  v_accvgpr_write_b32 a126, v229
  v_accvgpr_write_b32 a127, v231
  v_accvgpr_read_b32 v229, a144
  v_accvgpr_read_b32 v231, a145
  v_mul_f32 v229, v229, v230
  v_mul_f32 v231, v231, v230
  v_accvgpr_write_b32 a144, v229
  v_accvgpr_write_b32 a145, v231
  v_accvgpr_read_b32 v229, a146
  v_accvgpr_read_b32 v231, a147
  v_mul_f32 v229, v229, v230
  v_mul_f32 v231, v231, v230
  v_accvgpr_write_b32 a146, v229
  v_accvgpr_write_b32 a147, v231
  v_accvgpr_read_b32 v229, a164
  v_accvgpr_read_b32 v231, a165
  v_mul_f32 v229, v229, v230
  v_mul_f32 v231, v231, v230
  v_accvgpr_write_b32 a164, v229
  v_accvgpr_write_b32 a165, v231
  v_accvgpr_read_b32 v229, a166
  v_accvgpr_read_b32 v231, a167
  v_mul_f32 v229, v229, v230
  v_mul_f32 v231, v231, v230
  v_accvgpr_write_b32 a166, v229
  v_accvgpr_write_b32 a167, v231
  s_nop 1
  s_branch L_retY6
L_slowY7:
  v_mov_b32 v229, v228
  s_nop 1
  v_permlane32_swap_b32 v228, v229
  v_max_f32 v228, v228, v229
  v_mov_b32 v229, v228
  s_nop 1
  v_permlane16_swap_b32 v228, v229
  v_max_f32 v228, v228, v229
  v_max_f32 v228, s81, v228
  v_max_f32 v230, 0, v228
  v_exp_f32 v230, -v230
  v_sub_f32 v216, v216, v228
  v_sub_f32 v128, v128, v228
  v_sub_f32 v129, v129, v228
  v_sub_f32 v130, v130, v228
  v_sub_f32 v131, v131, v228
  v_sub_f32 v132, v132, v228
  v_sub_f32 v133, v133, v228
  v_sub_f32 v134, v134, v228
  v_sub_f32 v135, v135, v228
  v_mov_b32 v217, v216
  v_mov_b32 v218, v216
  v_mov_b32 v219, v216
  v_accvgpr_read_b32 v229, a8
  v_accvgpr_read_b32 v231, a9
  v_mul_f32 v229, v229, v230
  v_mul_f32 v231, v231, v230
  v_accvgpr_write_b32 a8, v229
  v_accvgpr_write_b32 a9, v231
  v_accvgpr_read_b32 v229, a10
  v_accvgpr_read_b32 v231, a11
  v_mul_f32 v229, v229, v230
  v_mul_f32 v231, v231, v230
  v_accvgpr_write_b32 a10, v229
  v_accvgpr_write_b32 a11, v231
  v_accvgpr_read_b32 v229, a28
  v_accvgpr_read_b32 v231, a29
  v_mul_f32 v229, v229, v230
  v_mul_f32 v231, v231, v230
  v_accvgpr_write_b32 a28, v229
  v_accvgpr_write_b32 a29, v231
  v_accvgpr_read_b32 v229, a30
  v_accvgpr_read_b32 v231, a31
  v_mul_f32 v229, v229, v230
  v_mul_f32 v231, v231, v230
  v_accvgpr_write_b32 a30, v229
  v_accvgpr_write_b32 a31, v231
  v_accvgpr_read_b32 v229, a48
  v_accvgpr_read_b32 v231, a49
  v_mul_f32 v229, v229, v230
  v_mul_f32 v231, v231, v230
  v_accvgpr_write_b32 a48, v229
  v_accvgpr_write_b32 a49, v231
  v_accvgpr_read_b32 v229, a50
  v_accvgpr_read_b32 v231, a51
  v_mul_f32 v229, v229, v230
  v_mul_f32 v231, v231, v230
  v_accvgpr_write_b32 a50, v229
  v_accvgpr_write_b32 a51, v231
  v_accvgpr_read_b32 v229, a68
  v_accvgpr_read_b32 v231, a69
  v_mul_f32 v229, v229, v230
  v_mul_f32 v231, v231, v230
  v_accvgpr_write_b32 a68, v229
  v_accvgpr_write_b32 a69, v231
  v_accvgpr_read_b32 v229, a70
  v_accvgpr_read_b32 v231, a71
  v_mul_f32 v229, v229, v230
  v_mul_f32 v231, v231, v230
  v_accvgpr_write_b32 a70, v229
  v_accvgpr_write_b32 a71, v231
  v_accvgpr_read_b32 v229, a88
  v_accvgpr_read_b32 v231, a89
  v_mul_f32 v229, v229, v230
  v_mul_f32 v231, v231, v230
  v_accvgpr_write_b32 a88, v229
  v_accvgpr_write_b32 a89, v231
  v_accvgpr_read_b32 v229, a90
  v_accvgpr_read_b32 v231, a91
  v_mul_f32 v229, v229, v230
  v_mul_f32 v231, v231, v230
  v_accvgpr_write_b32 a90, v229
  v_accvgpr_write_b32 a91, v231
  v_accvgpr_read_b32 v229, a108
  v_accvgpr_read_b32 v231, a109
  v_mul_f32 v229, v229, v230
  v_mul_f32 v231, v231, v230
  v_accvgpr_write_b32 a108, v229
  v_accvgpr_write_b32 a109, v231
  v_accvgpr_read_b32 v229, a110
  v_accvgpr_read_b32 v231, a111
  v_mul_f32 v229, v229, v230
  v_mul_f32 v231, v231, v230
  v_accvgpr_write_b32 a110, v229
  v_accvgpr_write_b32 a111, v231
  v_accvgpr_read_b32 v229, a128
  v_accvgpr_read_b32 v231, a129
  v_mul_f32 v229, v229, v230
  v_mul_f32 v231, v231, v230
  v_accvgpr_write_b32 a128, v229
  v_accvgpr_write_b32 a129, v231
  v_accvgpr_read_b32 v229, a130
  v_accvgpr_read_b32 v231, a131
  v_mul_f32 v229, v229, v230
  v_mul_f32 v231, v231, v230
  v_accvgpr_write_b32 a130, v229
  v_accvgpr_write_b32 a131, v231
  v_accvgpr_read_b32 v229, a148
  v_accvgpr_read_b32 v231, a149
  v_mul_f32 v229, v229, v230
  v_mul_f32 v231, v231, v230
  v_accvgpr_write_b32 a148, v229
  v_accvgpr_write_b32 a149, v231
  v_accvgpr_read_b32 v229, a150
  v_accvgpr_read_b32 v231, a151
  v_mul_f32 v229, v229, v230
  v_mul_f32 v231, v231, v230
  v_accvgpr_write_b32 a150, v229
  v_accvgpr_write_b32 a151, v231
  v_accvgpr_read_b32 v229, a168
  v_accvgpr_read_b32 v231, a169
  v_mul_f32 v229, v229, v230
  v_mul_f32 v231, v231, v230
  v_accvgpr_write_b32 a168, v229
  v_accvgpr_write_b32 a169, v231
  v_accvgpr_read_b32 v229, a170
  v_accvgpr_read_b32 v231, a171
  v_mul_f32 v229, v229, v230
  v_mul_f32 v231, v231, v230
  v_accvgpr_write_b32 a170, v229
  v_accvgpr_write_b32 a171, v231
  s_nop 1
  s_branch L_retY7
L_slowY8:
  v_mov_b32 v229, v228
  s_nop 1
  v_permlane32_swap_b32 v228, v229
  v_max_f32 v228, v228, v229
  v_mov_b32 v229, v228
  s_nop 1
  v_permlane16_swap_b32 v228, v229
  v_max_f32 v228, v228, v229
  v_max_f32 v228, s81, v228
  v_max_f32 v230, 0, v228
  v_exp_f32 v230, -v230
  v_sub_f32 v220, v220, v228
  v_sub_f32 v120, v120, v228
  v_sub_f32 v121, v121, v228
  v_sub_f32 v122, v122, v228
  v_sub_f32 v123, v123, v228
  v_sub_f32 v124, v124, v228
  v_sub_f32 v125, v125, v228
  v_sub_f32 v126, v126, v228
  v_sub_f32 v127, v127, v228
  v_mov_b32 v221, v220
  v_mov_b32 v222, v220
  v_mov_b32 v223, v220
  v_accvgpr_read_b32 v229, a12
  v_accvgpr_read_b32 v231, a13
  v_mul_f32 v229, v229, v230
  v_mul_f32 v231, v231, v230
  v_accvgpr_write_b32 a12, v229
  v_accvgpr_write_b32 a13, v231
  v_accvgpr_read_b32 v229, a14
  v_accvgpr_read_b32 v231, a15
  v_mul_f32 v229, v229, v230
  v_mul_f32 v231, v231, v230
  v_accvgpr_write_b32 a14, v229
  v_accvgpr_write_b32 a15, v231
  v_accvgpr_read_b32 v229, a32
  v_accvgpr_read_b32 v231, a33
  v_mul_f32 v229, v229, v230
  v_mul_f32 v231, v231, v230
  v_accvgpr_write_b32 a32, v229
  v_accvgpr_write_b32 a33, v231
  v_accvgpr_read_b32 v229, a34
  v_accvgpr_read_b32 v231, a35
  v_mul_f32 v229, v229, v230
  v_mul_f32 v231, v231, v230
  v_accvgpr_write_b32 a34, v229
  v_accvgpr_write_b32 a35, v231
  v_accvgpr_read_b32 v229, a52
  v_accvgpr_read_b32 v231, a53
  v_mul_f32 v229, v229, v230
  v_mul_f32 v231, v231, v230
  v_accvgpr_write_b32 a52, v229
  v_accvgpr_write_b32 a53, v231
  v_accvgpr_read_b32 v229, a54
  v_accvgpr_read_b32 v231, a55
  v_mul_f32 v229, v229, v230
  v_mul_f32 v231, v231, v230
  v_accvgpr_write_b32 a54, v229
  v_accvgpr_write_b32 a55, v231
  v_accvgpr_read_b32 v229, a72
  v_accvgpr_read_b32 v231, a73
  v_mul_f32 v229, v229, v230
  v_mul_f32 v231, v231, v230
  v_accvgpr_write_b32 a72, v229
  v_accvgpr_write_b32 a73, v231
  v_accvgpr_read_b32 v229, a74
  v_accvgpr_read_b32 v231, a75
  v_mul_f32 v229, v229, v230
  v_mul_f32 v231, v231, v230
  v_accvgpr_write_b32 a74, v229
  v_accvgpr_write_b32 a75, v231
  v_accvgpr_read_b32 v229, a92
  v_accvgpr_read_b32 v231, a93
  v_mul_f32 v229, v229, v230
  v_mul_f32 v231, v231, v230
  v_accvgpr_write_b32 a92, v229
  v_accvgpr_write_b32 a93, v231
  v_accvgpr_read_b32 v229, a94
  v_accvgpr_read_b32 v231, a95
  v_mul_f32 v229, v229, v230
  v_mul_f32 v231, v231, v230
  v_accvgpr_write_b32 a94, v229
  v_accvgpr_write_b32 a95, v231
  v_accvgpr_read_b32 v229, a112
  v_accvgpr_read_b32 v231, a113
  v_mul_f32 v229, v229, v230
  v_mul_f32 v231, v231, v230
  v_accvgpr_write_b32 a112, v229
  v_accvgpr_write_b32 a113, v231
  v_accvgpr_read_b32 v229, a114
  v_accvgpr_read_b32 v231, a115
  v_mul_f32 v229, v229, v230
  v_mul_f32 v231, v231, v230
  v_accvgpr_write_b32 a114, v229
  v_accvgpr_write_b32 a115, v231
  v_accvgpr_read_b32 v229, a132
  v_accvgpr_read_b32 v231, a133
  v_mul_f32 v229, v229, v230
  v_mul_f32 v231, v231, v230
  v_accvgpr_write_b32 a132, v229
  v_accvgpr_write_b32 a133, v231
  v_accvgpr_read_b32 v229, a134
  v_accvgpr_read_b32 v231, a135
  v_mul_f32 v229, v229, v230
  v_mul_f32 v231, v231, v230
  v_accvgpr_write_b32 a134, v229
  v_accvgpr_write_b32 a135, v231
  v_accvgpr_read_b32 v229, a152
  v_accvgpr_read_b32 v231, a153
  v_mul_f32 v229, v229, v230
  v_mul_f32 v231, v231, v230
  v_accvgpr_write_b32 a152, v229
  v_accvgpr_write_b32 a153, v231
  v_accvgpr_read_b32 v229, a154
  v_accvgpr_read_b32 v231, a155
  v_mul_f32 v229, v229, v230
  v_mul_f32 v231, v231, v230
  v_accvgpr_write_b32 a154, v229
  v_accvgpr_write_b32 a155, v231
  v_accvgpr_read_b32 v229, a172
  v_accvgpr_read_b32 v231, a173
  v_mul_f32 v229, v229, v230
  v_mul_f32 v231, v231, v230
  v_accvgpr_write_b32 a172, v229
  v_accvgpr_write_b32 a173, v231
  v_accvgpr_read_b32 v229, a174
  v_accvgpr_read_b32 v231, a175
  v_mul_f32 v229, v229, v230
  v_mul_f32 v231, v231, v230
  v_accvgpr_write_b32 a174, v229
  v_accvgpr_write_b32 a175, v231
  s_nop 1
  s_branch L_retY8
L_slowY9:
  v_mov_b32 v229, v228
  s_nop 1
  v_permlane32_swap_b32 v228, v229
  v_max_f32 v228, v228, v229
  v_mov_b32 v229, v228
  s_nop 1
  v_permlane16_swap_b32 v228, v229
  v_max_f32 v228, v228, v229
  v_max_f32 v228, s81, v228
  v_max_f32 v230, 0, v228
  v_exp_f32 v230, -v230
  v_sub_f32 v224, v224, v228
  v_sub_f32 v128, v128, v228
  v_sub_f32 v129, v129, v228
  v_sub_f32 v130, v130, v228
  v_sub_f32 v131, v131, v228
  v_sub_f32 v132, v132, v228
  v_sub_f32 v133, v133, v228
  v_sub_f32 v134, v134, v228
  v_sub_f32 v135, v135, v228
  v_mov_b32 v225, v224
  v_mov_b32 v226, v224
  v_mov_b32 v227, v224
  v_accvgpr_read_b32 v229, a16
  v_accvgpr_read_b32 v231, a17
  v_mul_f32 v229, v229, v230
  v_mul_f32 v231, v231, v230
  v_accvgpr_write_b32 a16, v229
  v_accvgpr_write_b32 a17, v231
  v_accvgpr_read_b32 v229, a18
  v_accvgpr_read_b32 v231, a19
  v_mul_f32 v229, v229, v230
  v_mul_f32 v231, v231, v230
  v_accvgpr_write_b32 a18, v229
  v_accvgpr_write_b32 a19, v231
  v_accvgpr_read_b32 v229, a36
  v_accvgpr_read_b32 v231, a37
  v_mul_f32 v229, v229, v230
  v_mul_f32 v231, v231, v230
  v_accvgpr_write_b32 a36, v229
  v_accvgpr_write_b32 a37, v231
  v_accvgpr_read_b32 v229, a38
  v_accvgpr_read_b32 v231, a39
  v_mul_f32 v229, v229, v230
  v_mul_f32 v231, v231, v230
  v_accvgpr_write_b32 a38, v229
  v_accvgpr_write_b32 a39, v231
  v_accvgpr_read_b32 v229, a56
  v_accvgpr_read_b32 v231, a57
  v_mul_f32 v229, v229, v230
  v_mul_f32 v231, v231, v230
  v_accvgpr_write_b32 a56, v229
  v_accvgpr_write_b32 a57, v231
  v_accvgpr_read_b32 v229, a58
  v_accvgpr_read_b32 v231, a59
  v_mul_f32 v229, v229, v230
  v_mul_f32 v231, v231, v230
  v_accvgpr_write_b32 a58, v229
  v_accvgpr_write_b32 a59, v231
  v_accvgpr_read_b32 v229, a76
  v_accvgpr_read_b32 v231, a77
  v_mul_f32 v229, v229, v230
  v_mul_f32 v231, v231, v230
  v_accvgpr_write_b32 a76, v229
  v_accvgpr_write_b32 a77, v231
  v_accvgpr_read_b32 v229, a78
  v_accvgpr_read_b32 v231, a79
  v_mul_f32 v229, v229, v230
  v_mul_f32 v231, v231, v230
  v_accvgpr_write_b32 a78, v229
  v_accvgpr_write_b32 a79, v231
  v_accvgpr_read_b32 v229, a96
  v_accvgpr_read_b32 v231, a97
  v_mul_f32 v229, v229, v230
  v_mul_f32 v231, v231, v230
  v_accvgpr_write_b32 a96, v229
  v_accvgpr_write_b32 a97, v231
  v_accvgpr_read_b32 v229, a98
  v_accvgpr_read_b32 v231, a99
  v_mul_f32 v229, v229, v230
  v_mul_f32 v231, v231, v230
  v_accvgpr_write_b32 a98, v229
  v_accvgpr_write_b32 a99, v231
  v_accvgpr_read_b32 v229, a116
  v_accvgpr_read_b32 v231, a117
  v_mul_f32 v229, v229, v230
  v_mul_f32 v231, v231, v230
  v_accvgpr_write_b32 a116, v229
  v_accvgpr_write_b32 a117, v231
  v_accvgpr_read_b32 v229, a118
  v_accvgpr_read_b32 v231, a119
  v_mul_f32 v229, v229, v230
  v_mul_f32 v231, v231, v230
  v_accvgpr_write_b32 a118, v229
  v_accvgpr_write_b32 a119, v231
  v_accvgpr_read_b32 v229, a136
  v_accvgpr_read_b32 v231, a137
  v_mul_f32 v229, v229, v230
  v_mul_f32 v231, v231, v230
  v_accvgpr_write_b32 a136, v229
  v_accvgpr_write_b32 a137, v231
  v_accvgpr_read_b32 v229, a138
  v_accvgpr_read_b32 v231, a139
  v_mul_f32 v229, v229, v230
  v_mul_f32 v231, v231, v230
  v_accvgpr_write_b32 a138, v229
  v_accvgpr_write_b32 a139, v231
  v_accvgpr_read_b32 v229, a156
  v_accvgpr_read_b32 v231, a157
  v_mul_f32 v229, v229, v230
  v_mul_f32 v231, v231, v230
  v_accvgpr_write_b32 a156, v229
  v_accvgpr_write_b32 a157, v231
  v_accvgpr_read_b32 v229, a158
  v_accvgpr_read_b32 v231, a159
  v_mul_f32 v229, v229, v230
  v_mul_f32 v231, v231, v230
  v_accvgpr_write_b32 a158, v229
  v_accvgpr_write_b32 a159, v231
  v_accvgpr_read_b32 v229, a176
  v_accvgpr_read_b32 v231, a177
  v_mul_f32 v229, v229, v230
  v_mul_f32 v231, v231, v230
  v_accvgpr_write_b32 a176, v229
  v_accvgpr_write_b32 a177, v231
  v_accvgpr_read_b32 v229, a178
  v_accvgpr_read_b32 v231, a179
  v_mul_f32 v229, v229, v230
  v_mul_f32 v231, v231, v230
  v_accvgpr_write_b32 a178, v229
  v_accvgpr_write_b32 a179, v231
  s_nop 1
  s_branch L_retY9
L_epi:
  s_nop 1
  v_mfma_f32_16x16x32_bf16 a[16:19], v[176:179], v[140:143], a[16:19]
  s_waitcnt vmcnt(16)
  ds_read_b64_tr_b16 a[180:181], v28 offset:16384
  ds_read_b64_tr_b16 a[182:183], v28 offset:20480
  ds_read_b64_tr_b16 a[184:185], v29 offset:16384
  ds_read_b64_tr_b16 a[186:187], v29 offset:20480
  ds_read_b64_tr_b16 a[188:189], v30 offset:16384
  v_mfma_f32_16x16x32_bf16 a[36:39], v[180:183], v[140:143], a[36:39]
  ds_read_b64_tr_b16 a[190:191], v30 offset:20480
  ds_read_b64_tr_b16 a[192:193], v31 offset:16384
  ds_read_b64_tr_b16 a[194:195], v31 offset:20480
  ds_read_b64_tr_b16 a[196:197], v32 offset:16384
  ds_read_b64_tr_b16 a[198:199], v32 offset:20480
  v_mfma_f32_16x16x32_bf16 a[56:59], v[184:187], v[140:143], a[56:59]
  ds_read_b64_tr_b16 a[200:201], v33 offset:16384
  ds_read_b64_tr_b16 a[202:203], v33 offset:20480
  ds_read_b64_tr_b16 a[204:205], v34 offset:16384
  ds_read_b64_tr_b16 a[206:207], v34 offset:20480
  ds_read_b64_tr_b16 a[208:209], v35 offset:16384
  v_mfma_f32_16x16x32_bf16 a[76:79], v[188:191], v[140:143], a[76:79]
  ds_read_b64_tr_b16 a[210:211], v35 offset:20480
  ds_read_b64_tr_b16 a[212:213], v28 offset:24576
  ds_read_b64_tr_b16 a[214:215], v28 offset:28672
  ds_read_b64_tr_b16 a[216:217], v29 offset:24576
  ds_read_b64_tr_b16 a[218:219], v29 offset:28672
  ds_read_b64_tr_b16 a[220:221], v30 offset:24576
  v_mfma_f32_16x16x32_bf16 a[96:99], v[192:195], v[140:143], a[96:99]
  ds_read_b64_tr_b16 a[222:223], v30 offset:28672
  ds_read_b64_tr_b16 a[224:225], v31 offset:24576
  ds_read_b64_tr_b16 a[226:227], v31 offset:28672
  ds_read_b64_tr_b16 a[228:229], v32 offset:24576
  ds_read_b64_tr_b16 a[230:231], v32 offset:28672
  v_mfma_f32_16x16x32_bf16 a[116:119], v[196:199], v[140:143], a[116:119]
  ds_read_b64_tr_b16 a[232:233], v33 offset:24576
  ds_read_b64_tr_b16 a[234:235], v33 offset:28672
  ds_read_b64_tr_b16 a[236:237], v34 offset:24576
  ds_read_b64_tr_b16 a[238:239], v34 offset:28672
  ds_read_b64_tr_b16 a[240:241], v35 offset:24576
  v_mfma_f32_16x16x32_bf16 a[136:139], v[200:203], v[140:143], a[136:139]
  ds_read_b64_tr_b16 a[242:243], v35 offset:28672
  v_add_u32 v1, s69, v7
  v_add_u32 v2, s78, v7
  v_lshlrev_b32 v5, 2, v0
  v_add_u32 v3, s69, v5
  v_add_u32 v4, s78, v5
  v_mfma_f32_16x16x32_bf16 a[156:159], v[204:207], v[140:143], a[156:159]
  v_add_u32 v5, 0x10000, v7
  s_sub_u32 s77, s70, s69
  v_add_u32 v8, s77, v28
  v_add_u32 v9, s77, v29
  v_add_u32 v10, s77, v30
  v_mfma_f32_16x16x32_bf16 a[176:179], v[20:23], v[140:143], a[176:179]
  v_add_u32 v11, s77, v31
  v_add_u32 v12, s77, v32
  v_add_u32 v13, s77, v33
  v_add_u32 v14, s77, v34
  v_add_u32 v15, s77, v35
  s_nop 3
  v_accvgpr_read_b32 v120, a160
  v_accvgpr_read_b32 v121, a164
  v_accvgpr_read_b32 v122, a168
  v_accvgpr_read_b32 v123, a172
  v_accvgpr_read_b32 v124, a176
  s_waitcnt vmcnt(8)
  ds_read_b64_tr_b16 a[160:161], v28 offset:0
  ds_read_b64_tr_b16 a[162:163], v28 offset:4096
  ds_read_b64_tr_b16 a[164:165], v29 offset:0
  ds_read_b64_tr_b16 a[166:167], v29 offset:4096
  ds_read_b64_tr_b16 a[168:169], v30 offset:0
  ds_read_b64_tr_b16 a[170:171], v30 offset:4096
  ds_read_b64_tr_b16 a[172:173], v31 offset:0
  ds_read_b64_tr_b16 a[174:175], v31 offset:4096
  ds_read_b64_tr_b16 a[176:177], v32 offset:0
  ds_read_b64_tr_b16 a[178:179], v32 offset:4096
  ds_read_b64_tr_b16 a[244:245], v33 offset:0
  ds_read_b64_tr_b16 a[246:247], v33 offset:4096
  ds_read_b64_tr_b16 a[248:249], v34 offset:0
  ds_read_b64_tr_b16 a[250:251], v34 offset:4096
  ds_read_b64_tr_b16 a[252:253], v35 offset:0
  ds_read_b64_tr_b16 a[254:255], v35 offset:4096
  s_waitcnt lgkmcnt(0)
  ds_write_b128 v1, a[80:83] offset:16384
  ds_write_b128 v1, a[84:87] offset:17408
  ds_write_b128 v1, a[88:91] offset:18432
  ds_write_b128 v1, a[92:95] offset:19456
  ds_write_b128 v1, a[96:99] offset:20480
  ds_write_b128 v1, a[100:103] offset:21504
  ds_write_b128 v1, a[104:107] offset:22528
  ds_write_b128 v1, a[108:111] offset:23552
  ds_write_b128 v1, a[112:115] offset:24576
  ds_write_b128 v1, a[116:119] offset:25600
  ds_write_b128 v1, a[120:123] offset:26624
  ds_write_b128 v1, a[124:127] offset:27648
  ds_write_b128 v1, a[128:131] offset:28672
  ds_write_b128 v1, a[132:135] offset:29696
  ds_write_b128 v1, a[136:139] offset:30720
  ds_write_b128 v1, a[140:143] offset:31744
  ds_write_b128 v1, a[144:147] offset:0
  ds_write_b128 v1, a[148:151] offset:1024
  ds_write_b128 v1, a[152:155] offset:2048
  ds_write_b128 v1, a[156:159] offset:3072
  ds_write_b32 v3, v208 offset:4096
  ds_write_b32 v3, v120 offset:5376
  ds_write_b32 v3, v212 offset:4352
  ds_write_b32 v3, v121 offset:5632
  ds_write_b32 v3, v216 offset:4608
  ds_write_b32 v3, v122 offset:5888
  ds_write_b32 v3, v220 offset:4864
  ds_write_b32 v3, v123 offset:6144
  ds_write_b32 v3, v224 offset:5120
  ds_write_b32 v3, v124 offset:6400
  s_waitcnt lgkmcnt(0)
  s_barrier
  ds_read_b32 v125, v4 offset:4096
  ds_read_b32 v130, v4 offset:5376
  ds_read_b32 v126, v4 offset:4352
  ds_read_b32 v131, v4 offset:5632
  ds_read_b32 v127, v4 offset:4608
  ds_read_b32 v132, v4 offset:5888
  ds_read_b32 v128, v4 offset:4864
  ds_read_b32 v133, v4 offset:6144
  ds_read_b32 v129, v4 offset:5120
  ds_read_b32 v134, v4 offset:6400
  ds_read_b128 v[40:43], v2 offset:16384
  ds_read_b128 v[44:47], v2 offset:17408
  ds_read_b128 v[48:51], v2 offset:18432
  ds_read_b128 v[52:55], v2 offset:19456
  ds_read_b128 v[56:59], v2 offset:20480
  ds_read_b128 v[60:63], v2 offset:21504
  ds_read_b128 v[64:67], v2 offset:22528
  ds_read_b128 v[68:71], v2 offset:23552
  ds_read_b128 v[72:75], v2 offset:24576
  ds_read_b128 v[76:79], v2 offset:25600
  ds_read_b128 v[80:83], v2 offset:26624
  ds_read_b128 v[84:87], v2 offset:27648
  ds_read_b128 v[88:91], v2 offset:28672
  ds_read_b128 v[92:95], v2 offset:29696
  ds_read_b128 v[96:99], v2 offset:30720
  ds_read_b128 v[100:103], v2 offset:31744
  ds_read_b128 v[104:107], v2 offset:0
  ds_read_b128 v[108:111], v2 offset:1024
  ds_read_b128 v[112:115], v2 offset:2048
  ds_read_b128 v[116:119], v2 offset:3072
  v_accvgpr_read_b32 v144, a0
  v_accvgpr_read_b32 v145, a1
  v_accvgpr_read_b32 v146, a2
  v_accvgpr_read_b32 v147, a3
  v_accvgpr_read_b32 v148, a4
  v_accvgpr_read_b32 v149, a5
  v_accvgpr_read_b32 v150, a6
  v_accvgpr_read_b32 v151, a7
  v_accvgpr_read_b32 v152, a8
  v_accvgpr_read_b32 v153, a9
  v_accvgpr_read_b32 v154, a10
  v_accvgpr_read_b32 v155, a11
  v_accvgpr_read_b32 v156, a12
  v_accvgpr_read_b32 v157, a13
  v_accvgpr_read_b32 v158, a14
  v_accvgpr_read_b32 v159, a15
  v_accvgpr_read_b32 v160, a16
  v_accvgpr_read_b32 v161, a17
  v_accvgpr_read_b32 v162, a18
  v_accvgpr_read_b32 v163, a19
  v_accvgpr_read_b32 v164, a20
  v_accvgpr_read_b32 v165, a21
  v_accvgpr_read_b32 v166, a22
  v_accvgpr_read_b32 v167, a23
  v_accvgpr_read_b32 v168, a24
  v_accvgpr_read_b32 v169, a25
  v_accvgpr_read_b32 v170, a26
  v_accvgpr_read_b32 v171, a27
  v_accvgpr_read_b32 v172, a28
  v_accvgpr_read_b32 v173, a29
  v_accvgpr_read_b32 v174, a30
  v_accvgpr_read_b32 v175, a31
  v_accvgpr_read_b32 v176, a32
  v_accvgpr_read_b32 v177, a33
  v_accvgpr_read_b32 v178, a34
  v_accvgpr_read_b32 v179, a35
  v_accvgpr_read_b32 v180, a36
  v_accvgpr_read_b32 v181, a37
  v_accvgpr_read_b32 v182, a38
  v_accvgpr_read_b32 v183, a39
  v_accvgpr_read_b32 v184, a40
  v_accvgpr_read_b32 v185, a41
  v_accvgpr_read_b32 v186, a42
  v_accvgpr_read_b32 v187, a43
  v_accvgpr_read_b32 v188, a44
  v_accvgpr_read_b32 v189, a45
  v_accvgpr_read_b32 v190, a46
  v_accvgpr_read_b32 v191, a47
  v_accvgpr_read_b32 v192, a48
  v_accvgpr_read_b32 v193, a49
  v_accvgpr_read_b32 v194, a50
  v_accvgpr_read_b32 v195, a51
  v_accvgpr_read_b32 v196, a52
  v_accvgpr_read_b32 v197, a53
  v_accvgpr_read_b32 v198, a54
  v_accvgpr_read_b32 v199, a55
  v_accvgpr_read_b32 v200, a56
  v_accvgpr_read_b32 v201, a57
  v_accvgpr_read_b32 v202, a58
  v_accvgpr_read_b32 v203, a59
  v_accvgpr_read_b32 v204, a60
  v_accvgpr_read_b32 v205, a61
  v_accvgpr_read_b32 v206, a62
  v_accvgpr_read_b32 v207, a63
  s_waitcnt lgkmcnt(15)
  v_min_f32 v136, v208, v125
  v_sub_f32 v137, v136, v208
  v_sub_f32 v138, v136, v125
  v_exp_f32 v137, v137
  v_exp_f32 v138, v138
  s_nop 0
  v_mul_f32 v136, v137, v120
  v_fma_f32 v136, v138, v130, v136
  v_rcp_f32 v136, v136
  s_nop 0
  v_mul_f32 v228, v137, v136
  v_mul_f32 v229, v138, v136
  v_min_f32 v136, v212, v126
  v_sub_f32 v137, v136, v212
  v_sub_f32 v138, v136, v126
  v_exp_f32 v137, v137
  v_exp_f32 v138, v138
  s_nop 0
  v_mul_f32 v136, v137, v121
  v_fma_f32 v136, v138, v131, v136
  v_rcp_f32 v136, v136
  s_nop 0
  v_mul_f32 v230, v137, v136
  v_mul_f32 v231, v138, v136
  v_min_f32 v136, v216, v127
  v_sub_f32 v137, v136, v216
  v_sub_f32 v138, v136, v127
  v_exp_f32 v137, v137
  v_exp_f32 v138, v138
  s_nop 0
  v_mul_f32 v136, v137, v122
  v_fma_f32 v136, v138, v132, v136
  v_rcp_f32 v136, v136
  s_nop 0
  v_mul_f32 v232, v137, v136
  v_mul_f32 v233, v138, v136
  v_min_f32 v136, v220, v128
  v_sub_f32 v137, v136, v220
  v_sub_f32 v138, v136, v128
  v_exp_f32 v137, v137
  v_exp_f32 v138, v138
  s_nop 0
  v_mul_f32 v136, v137, v123
  v_fma_f32 v136, v138, v133, v136
  v_rcp_f32 v136, v136
  s_nop 0
  v_mul_f32 v234, v137, v136
  v_mul_f32 v235, v138, v136
  v_min_f32 v136, v224, v129
  v_sub_f32 v137, v136, v224
  v_sub_f32 v138, v136, v129
  v_exp_f32 v137, v137
  v_exp_f32 v138, v138
  s_nop 0
  v_mul_f32 v136, v137, v124
  v_fma_f32 v136, v138, v134, v136
  v_rcp_f32 v136, v136
  s_nop 0
  v_mul_f32 v236, v137, v136
  v_mul_f32 v237, v138, v136
  v_accvgpr_read_b32 v208, a64
  v_accvgpr_read_b32 v209, a65
  v_accvgpr_read_b32 v210, a66
  v_accvgpr_read_b32 v211, a67
  v_accvgpr_read_b32 v212, a68
  v_accvgpr_read_b32 v213, a69
  v_accvgpr_read_b32 v214, a70
  v_accvgpr_read_b32 v215, a71
  v_accvgpr_read_b32 v216, a72
  v_accvgpr_read_b32 v217, a73
  v_accvgpr_read_b32 v218, a74
  v_accvgpr_read_b32 v219, a75
  v_accvgpr_read_b32 v220, a76
  v_accvgpr_read_b32 v221, a77
  v_accvgpr_read_b32 v222, a78
  v_accvgpr_read_b32 v223, a79
  s_waitcnt lgkmcnt(0)
  v_pk_mul_f32 v[40:41], v[40:41], v[228:229] op_sel:[0,1] op_sel_hi:[1,1]
  v_pk_mul_f32 v[42:43], v[42:43], v[228:229] op_sel:[0,1] op_sel_hi:[1,1]
  v_pk_fma_f32 v[40:41], v[144:145], v[228:229], v[40:41] op_sel_hi:[1,0,1]
  v_pk_fma_f32 v[42:43], v[146:147], v[228:229], v[42:43] op_sel_hi:[1,0,1]
  v_cvt_pk_bf16_f32 v40, v40, v41
  v_cvt_pk_bf16_f32 v41, v42, v43
  v_pk_mul_f32 v[60:61], v[60:61], v[228:229] op_sel:[0,1] op_sel_hi:[1,1]
  v_pk_mul_f32 v[62:63], v[62:63], v[228:229] op_sel:[0,1] op_sel_hi:[1,1]
  v_pk_fma_f32 v[60:61], v[164:165], v[228:229], v[60:61] op_sel_hi:[1,0,1]
  v_pk_fma_f32 v[62:63], v[166:167], v[228:229], v[62:63] op_sel_hi:[1,0,1]
  v_cvt_pk_bf16_f32 v42, v60, v61
  v_cvt_pk_bf16_f32 v43, v62, v63
  ds_write_b128 v2, v[40:43] offset:16384
  v_pk_mul_f32 v[44:45], v[44:45], v[230:231] op_sel:[0,1] op_sel_hi:[1,1]
  v_pk_mul_f32 v[46:47], v[46:47], v[230:231] op_sel:[0,1] op_sel_hi:[1,1]
  v_pk_fma_f32 v[44:45], v[148:149], v[230:231], v[44:45] op_sel_hi:[1,0,1]
  v_pk_fma_f32 v[46:47], v[150:151], v[230:231], v[46:47] op_sel_hi:[1,0,1]
  v_cvt_pk_bf16_f32 v44, v44, v45
  v_cvt_pk_bf16_f32 v45, v46, v47
  v_pk_mul_f32 v[64:65], v[64:65], v[230:231] op_sel:[0,1] op_sel_hi:[1,1]
  v_pk_mul_f32 v[66:67], v[66:67], v[230:231] op_sel:[0,1] op_sel_hi:[1,1]
  v_pk_fma_f32 v[64:65], v[168:169], v[230:231], v[64:65] op_sel_hi:[1,0,1]
  v_pk_fma_f32 v[66:67], v[170:171], v[230:231], v[66:67] op_sel_hi:[1,0,1]
  v_cvt_pk_bf16_f32 v46, v64, v65
  v_cvt_pk_bf16_f32 v47, v66, v67
  ds_write_b128 v2, v[44:47] offset:17408
  v_pk_mul_f32 v[48:49], v[48:49], v[232:233] op_sel:[0,1] op_sel_hi:[1,1]
  v_pk_mul_f32 v[50:51], v[50:51], v[232:233] op_sel:[0,1] op_sel_hi:[1,1]
  v_pk_fma_f32 v[48:49], v[152:153], v[232:233], v[48:49] op_sel_hi:[1,0,1]
  v_pk_fma_f32 v[50:51], v[154:155], v[232:233], v[50:51] op_sel_hi:[1,0,1]
  v_cvt_pk_bf16_f32 v48, v48, v49
  v_cvt_pk_bf16_f32 v49, v50, v51
  v_pk_mul_f32 v[68:69], v[68:69], v[232:233] op_sel:[0,1] op_sel_hi:[1,1]
  v_pk_mul_f32 v[70:71], v[70:71], v[232:233] op_sel:[0,1] op_sel_hi:[1,1]
  v_pk_fma_f32 v[68:69], v[172:173], v[232:233], v[68:69] op_sel_hi:[1,0,1]
  v_pk_fma_f32 v[70:71], v[174:175], v[232:233], v[70:71] op_sel_hi:[1,0,1]
  v_cvt_pk_bf16_f32 v50, v68, v69
  v_cvt_pk_bf16_f32 v51, v70, v71
  ds_write_b128 v2, v[48:51] offset:18432
  v_pk_mul_f32 v[52:53], v[52:53], v[234:235] op_sel:[0,1] op_sel_hi:[1,1]
  v_pk_mul_f32 v[54:55], v[54:55], v[234:235] op_sel:[0,1] op_sel_hi:[1,1]
  v_pk_fma_f32 v[52:53], v[156:157], v[234:235], v[52:53] op_sel_hi:[1,0,1]
  v_pk_fma_f32 v[54:55], v[158:159], v[234:235], v[54:55] op_sel_hi:[1,0,1]
  v_cvt_pk_bf16_f32 v52, v52, v53
  v_cvt_pk_bf16_f32 v53, v54, v55
  v_pk_mul_f32 v[72:73], v[72:73], v[234:235] op_sel:[0,1] op_sel_hi:[1,1]
  v_pk_mul_f32 v[74:75], v[74:75], v[234:235] op_sel:[0,1] op_sel_hi:[1,1]
  v_pk_fma_f32 v[72:73], v[176:177], v[234:235], v[72:73] op_sel_hi:[1,0,1]
  v_pk_fma_f32 v[74:75], v[178:179], v[234:235], v[74:75] op_sel_hi:[1,0,1]
  v_cvt_pk_bf16_f32 v54, v72, v73
  v_cvt_pk_bf16_f32 v55, v74, v75
  ds_write_b128 v2, v[52:55] offset:19456
  v_pk_mul_f32 v[56:57], v[56:57], v[236:237] op_sel:[0,1] op_sel_hi:[1,1]
  v_pk_mul_f32 v[58:59], v[58:59], v[236:237] op_sel:[0,1] op_sel_hi:[1,1]
  v_pk_fma_f32 v[56:57], v[160:161], v[236:237], v[56:57] op_sel_hi:[1,0,1]
  v_pk_fma_f32 v[58:59], v[162:163], v[236:237], v[58:59] op_sel_hi:[1,0,1]
  v_cvt_pk_bf16_f32 v56, v56, v57
  v_cvt_pk_bf16_f32 v57, v58, v59
  v_pk_mul_f32 v[76:77], v[76:77], v[236:237] op_sel:[0,1] op_sel_hi:[1,1]
  v_pk_mul_f32 v[78:79], v[78:79], v[236:237] op_sel:[0,1] op_sel_hi:[1,1]
  v_pk_fma_f32 v[76:77], v[180:181], v[236:237], v[76:77] op_sel_hi:[1,0,1]
  v_pk_fma_f32 v[78:79], v[182:183], v[236:237], v[78:79] op_sel_hi:[1,0,1]
  v_cvt_pk_bf16_f32 v58, v76, v77
  v_cvt_pk_bf16_f32 v59, v78, v79
  ds_write_b128 v2, v[56:59] offset:20480
  v_pk_mul_f32 v[80:81], v[80:81], v[228:229] op_sel:[0,1] op_sel_hi:[1,1]
  v_pk_mul_f32 v[82:83], v[82:83], v[228:229] op_sel:[0,1] op_sel_hi:[1,1]
  v_pk_fma_f32 v[80:81], v[184:185], v[228:229], v[80:81] op_sel_hi:[1,0,1]
  v_pk_fma_f32 v[82:83], v[186:187], v[228:229], v[82:83] op_sel_hi:[1,0,1]
  v_cvt_pk_bf16_f32 v60, v80, v81
  v_cvt_pk_bf16_f32 v61, v82, v83
  v_pk_mul_f32 v[100:101], v[100:101], v[228:229] op_sel:[0,1] op_sel_hi:[1,1]
  v_pk_mul_f32 v[102:103], v[102:103], v[228:229] op_sel:[0,1] op_sel_hi:[1,1]
  v_pk_fma_f32 v[100:101], v[204:205], v[228:229], v[100:101] op_sel_hi:[1,0,1]
  v_pk_fma_f32 v[102:103], v[206:207], v[228:229], v[102:103] op_sel_hi:[1,0,1]
  v_cvt_pk_bf16_f32 v62, v100, v101
  v_cvt_pk_bf16_f32 v63, v102, v103
  ds_write_b128 v2, v[60:63] offset:21504
  v_pk_mul_f32 v[84:85], v[84:85], v[230:231] op_sel:[0,1] op_sel_hi:[1,1]
  v_pk_mul_f32 v[86:87], v[86:87], v[230:231] op_sel:[0,1] op_sel_hi:[1,1]
  v_pk_fma_f32 v[84:85], v[188:189], v[230:231], v[84:85] op_sel_hi:[1,0,1]
  v_pk_fma_f32 v[86:87], v[190:191], v[230:231], v[86:87] op_sel_hi:[1,0,1]
  v_cvt_pk_bf16_f32 v64, v84, v85
  v_cvt_pk_bf16_f32 v65, v86, v87
  v_pk_mul_f32 v[104:105], v[104:105], v[230:231] op_sel:[0,1] op_sel_hi:[1,1]
  v_pk_mul_f32 v[106:107], v[106:107], v[230:231] op_sel:[0,1] op_sel_hi:[1,1]
  v_pk_fma_f32 v[104:105], v[208:209], v[230:231], v[104:105] op_sel_hi:[1,0,1]
  v_pk_fma_f32 v[106:107], v[210:211], v[230:231], v[106:107] op_sel_hi:[1,0,1]
  v_cvt_pk_bf16_f32 v66, v104, v105
  v_cvt_pk_bf16_f32 v67, v106, v107
  ds_write_b128 v2, v[64:67] offset:22528
  v_pk_mul_f32 v[88:89], v[88:89], v[232:233] op_sel:[0,1] op_sel_hi:[1,1]
  v_pk_mul_f32 v[90:91], v[90:91], v[232:233] op_sel:[0,1] op_sel_hi:[1,1]
  v_pk_fma_f32 v[88:89], v[192:193], v[232:233], v[88:89] op_sel_hi:[1,0,1]
  v_pk_fma_f32 v[90:91], v[194:195], v[232:233], v[90:91] op_sel_hi:[1,0,1]
  v_cvt_pk_bf16_f32 v68, v88, v89
  v_cvt_pk_bf16_f32 v69, v90, v91
  v_pk_mul_f32 v[108:109], v[108:109], v[232:233] op_sel:[0,1] op_sel_hi:[1,1]
  v_pk_mul_f32 v[110:111], v[110:111], v[232:233] op_sel:[0,1] op_sel_hi:[1,1]
  v_pk_fma_f32 v[108:109], v[212:213], v[232:233], v[108:109] op_sel_hi:[1,0,1]
  v_pk_fma_f32 v[110:111], v[214:215], v[232:233], v[110:111] op_sel_hi:[1,0,1]
  v_cvt_pk_bf16_f32 v70, v108, v109
  v_cvt_pk_bf16_f32 v71, v110, v111
  ds_write_b128 v2, v[68:71] offset:23552
  v_pk_mul_f32 v[92:93], v[92:93], v[234:235] op_sel:[0,1] op_sel_hi:[1,1]
  v_pk_mul_f32 v[94:95], v[94:95], v[234:235] op_sel:[0,1] op_sel_hi:[1,1]
  v_pk_fma_f32 v[92:93], v[196:197], v[234:235], v[92:93] op_sel_hi:[1,0,1]
  v_pk_fma_f32 v[94:95], v[198:199], v[234:235], v[94:95] op_sel_hi:[1,0,1]
  v_cvt_pk_bf16_f32 v72, v92, v93
  v_cvt_pk_bf16_f32 v73, v94, v95
  v_pk_mul_f32 v[112:113], v[112:113], v[234:235] op_sel:[0,1] op_sel_hi:[1,1]
  v_pk_mul_f32 v[114:115], v[114:115], v[234:235] op_sel:[0,1] op_sel_hi:[1,1]
  v_pk_fma_f32 v[112:113], v[216:217], v[234:235], v[112:113] op_sel_hi:[1,0,1]
  v_pk_fma_f32 v[114:115], v[218:219], v[234:235], v[114:115] op_sel_hi:[1,0,1]
  v_cvt_pk_bf16_f32 v74, v112, v113
  v_cvt_pk_bf16_f32 v75, v114, v115
  ds_write_b128 v2, v[72:75] offset:24576
  v_pk_mul_f32 v[96:97], v[96:97], v[236:237] op_sel:[0,1] op_sel_hi:[1,1]
  v_pk_mul_f32 v[98:99], v[98:99], v[236:237] op_sel:[0,1] op_sel_hi:[1,1]
  v_pk_fma_f32 v[96:97], v[200:201], v[236:237], v[96:97] op_sel_hi:[1,0,1]
  v_pk_fma_f32 v[98:99], v[202:203], v[236:237], v[98:99] op_sel_hi:[1,0,1]
  v_cvt_pk_bf16_f32 v76, v96, v97
  v_cvt_pk_bf16_f32 v77, v98, v99
  v_pk_mul_f32 v[116:117], v[116:117], v[236:237] op_sel:[0,1] op_sel_hi:[1,1]
  v_pk_mul_f32 v[118:119], v[118:119], v[236:237] op_sel:[0,1] op_sel_hi:[1,1]
  v_pk_fma_f32 v[116:117], v[220:221], v[236:237], v[116:117] op_sel_hi:[1,0,1]
  v_pk_fma_f32 v[118:119], v[222:223], v[236:237], v[118:119] op_sel_hi:[1,0,1]
  v_cvt_pk_bf16_f32 v78, v116, v117
  v_cvt_pk_bf16_f32 v79, v118, v119
  ds_write_b128 v2, v[76:79] offset:25600
  s_waitcnt lgkmcnt(0)
  s_barrier
  ds_read_b128 a[0:3], v7 offset:49152
  ds_read_b128 a[4:7], v7 offset:50176
  ds_read_b128 a[8:11], v7 offset:51200
  ds_read_b128 a[12:15], v7 offset:52224
  ds_read_b128 a[16:19], v7 offset:53248
  ds_read_b128 a[20:23], v7 offset:54272
  ds_read_b128 a[24:27], v7 offset:55296
  ds_read_b128 a[28:31], v7 offset:56320
  ds_read_b128 a[32:35], v7 offset:57344
  ds_read_b128 a[36:39], v7 offset:58368
  ds_read_b128 a[40:43], v7 offset:16384
  ds_read_b128 a[44:47], v7 offset:17408
  ds_read_b128 a[48:51], v7 offset:18432
  ds_read_b128 a[52:55], v7 offset:19456
  ds_read_b128 a[56:59], v7 offset:20480
  ds_read_b128 a[60:63], v7 offset:21504
  ds_read_b128 a[64:67], v7 offset:22528
  ds_read_b128 a[68:71], v7 offset:23552
  ds_read_b128 a[72:75], v7 offset:24576
  ds_read_b128 a[76:79], v7 offset:25600
  ds_read_b128 a[80:83], v5 offset:49152
  ds_read_b128 a[84:87], v5 offset:50176
  ds_read_b128 a[88:91], v5 offset:51200
  ds_read_b128 a[92:95], v5 offset:52224
  ds_read_b128 a[96:99], v5 offset:53248
  ds_read_b128 a[100:103], v5 offset:54272
  ds_read_b128 a[104:107], v5 offset:55296
  ds_read_b128 a[108:111], v5 offset:56320
  ds_read_b128 a[112:115], v5 offset:57344
  ds_read_b128 a[116:119], v5 offset:58368
  ds_read_b128 a[120:123], v5 offset:16384
  ds_read_b128 a[124:127], v5 offset:17408
  ds_read_b128 a[128:131], v5 offset:18432
  ds_read_b128 a[132:135], v5 offset:19456
  ds_read_b128 a[136:139], v5 offset:20480
  ds_read_b128 a[140:143], v5 offset:21504
  ds_read_b128 a[144:147], v5 offset:22528
  ds_read_b128 a[148:151], v5 offset:23552
  ds_read_b128 a[152:155], v5 offset:24576
  ds_read_b128 a[156:159], v5 offset:25600
  s_xor_b32 s76, s66, 1
  s_lshl_b32 s76, s76, 3
  s_add_u32 s76, s76, s67
  s_lshl_b32 s76, s76, 4
  s_add_u32 s76, s76, s31
  s_mul_i32 s76, s76, 81920
  s_mul_i32 s77, s64, 20480
  s_add_u32 s76, s76, s77
  v_add_u32 v36, 1, v36
  s_waitcnt lgkmcnt(0)
  s_barrier
  v_mfma_f32_16x16x32_bf16 v[40:43], a[180:183], a[0:3], 0
  s_add_u32 m0, s69, 16384
  v_mfma_f32_16x16x32_bf16 v[44:47], a[180:183], a[4:7], 0
  s_add_u32 s77, s101, 163840
  v_mfma_f32_16x16x32_bf16 v[48:51], a[180:183], a[8:11], 0
  buffer_load_dwordx4 v24, s[48:51], s77 offen offset:0 lds
  v_mfma_f32_16x16x32_bf16 v[52:55], a[180:183], a[12:15], 0
  buffer_load_dwordx4 v25, s[48:51], s77 offen offset:1024 lds
  v_mfma_f32_16x16x32_bf16 v[56:59], a[180:183], a[16:19], 0
  buffer_load_dwordx4 v26, s[48:51], s77 offen offset:2048 lds
  v_mfma_f32_16x16x32_bf16 v[60:63], a[184:187], a[0:3], 0
  buffer_load_dwordx4 v27, s[48:51], s77 offen offset:3072 lds
  v_mfma_f32_16x16x32_bf16 v[64:67], a[184:187], a[4:7], 0
  s_add_u32 m0, s69, 20480
  v_mfma_f32_16x16x32_bf16 v[68:71], a[184:187], a[8:11], 0
  s_add_u32 s77, s101, 180224
  v_mfma_f32_16x16x32_bf16 v[72:75], a[184:187], a[12:15], 0
  buffer_load_dwordx4 v24, s[48:51], s77 offen offset:0 lds
  v_mfma_f32_16x16x32_bf16 v[76:79], a[184:187], a[16:19], 0
  v_mfma_f32_16x16x32_bf16 v[80:83], a[188:191], a[0:3], 0
  buffer_load_dwordx4 v25, s[48:51], s77 offen offset:1024 lds
  v_mfma_f32_16x16x32_bf16 v[84:87], a[188:191], a[4:7], 0
  buffer_load_dwordx4 v26, s[48:51], s77 offen offset:2048 lds
  v_mfma_f32_16x16x32_bf16 v[88:91], a[188:191], a[8:11], 0
  buffer_load_dwordx4 v27, s[48:51], s77 offen offset:3072 lds
  v_mfma_f32_16x16x32_bf16 v[92:95], a[188:191], a[12:15], 0
  s_add_u32 m0, s69, 24576
  v_mfma_f32_16x16x32_bf16 v[96:99], a[188:191], a[16:19], 0
  s_add_u32 s77, s101, 196608
  v_mfma_f32_16x16x32_bf16 v[100:103], a[192:195], a[0:3], 0
  buffer_load_dwordx4 v24, s[48:51], s77 offen offset:0 lds
  v_mfma_f32_16x16x32_bf16 v[104:107], a[192:195], a[4:7], 0
  buffer_load_dwordx4 v25, s[48:51], s77 offen offset:1024 lds
  v_mfma_f32_16x16x32_bf16 v[108:111], a[192:195], a[8:11], 0
  buffer_load_dwordx4 v26, s[48:51], s77 offen offset:2048 lds
  v_mfma_f32_16x16x32_bf16 v[112:115], a[192:195], a[12:15], 0
  buffer_load_dwordx4 v27, s[48:51], s77 offen offset:3072 lds
  v_mfma_f32_16x16x32_bf16 v[116:119], a[192:195], a[16:19], 0
  v_mfma_f32_16x16x32_bf16 v[120:123], a[196:199], a[0:3], 0
  s_add_u32 m0, s69, 28672
  v_mfma_f32_16x16x32_bf16 v[124:127], a[196:199], a[4:7], 0
  s_add_u32 s77, s101, 212992
  v_mfma_f32_16x16x32_bf16 v[128:131], a[196:199], a[8:11], 0
  buffer_load_dwordx4 v24, s[48:51], s77 offen offset:0 lds
  v_mfma_f32_16x16x32_bf16 v[132:135], a[196:199], a[12:15], 0
  buffer_load_dwordx4 v25, s[48:51], s77 offen offset:1024 lds
  v_mfma_f32_16x16x32_bf16 v[136:139], a[196:199], a[16:19], 0
  buffer_load_dwordx4 v26, s[48:51], s77 offen offset:2048 lds
  v_mfma_f32_16x16x32_bf16 v[140:143], a[200:203], a[0:3], 0
  buffer_load_dwordx4 v27, s[48:51], s77 offen offset:3072 lds
  v_mfma_f32_16x16x32_bf16 v[144:147], a[200:203], a[4:7], 0
  s_add_u32 m0, s69, 0
  v_mfma_f32_16x16x32_bf16 v[148:151], a[200:203], a[8:11], 0
  s_add_u32 s77, s101, 229376
  v_mfma_f32_16x16x32_bf16 v[152:155], a[200:203], a[12:15], 0
  buffer_load_dwordx4 v24, s[48:51], s77 offen offset:0 lds
  v_mfma_f32_16x16x32_bf16 v[156:159], a[200:203], a[16:19], 0
  v_mfma_f32_16x16x32_bf16 v[160:163], a[204:207], a[0:3], 0
  buffer_load_dwordx4 v25, s[48:51], s77 offen offset:1024 lds
  v_mfma_f32_16x16x32_bf16 v[164:167], a[204:207], a[4:7], 0
  buffer_load_dwordx4 v26, s[48:51], s77 offen offset:2048 lds
  v_mfma_f32_16x16x32_bf16 v[168:171], a[204:207], a[8:11], 0
  buffer_load_dwordx4 v27, s[48:51], s77 offen offset:3072 lds
  v_mfma_f32_16x16x32_bf16 v[172:175], a[204:207], a[12:15], 0
  s_add_u32 m0, s69, 4096
  v_mfma_f32_16x16x32_bf16 v[176:179], a[204:207], a[16:19], 0
  s_add_u32 s77, s101, 245760
  v_mfma_f32_16x16x32_bf16 v[180:183], a[208:211], a[0:3], 0
  buffer_load_dwordx4 v24, s[48:51], s77 offen offset:0 lds
  v_mfma_f32_16x16x32_bf16 v[184:187], a[208:211], a[4:7], 0
  buffer_load_dwordx4 v25, s[48:51], s77 offen offset:1024 lds
  v_mfma_f32_16x16x32_bf16 v[188:191], a[208:211], a[8:11], 0
  buffer_load_dwordx4 v26, s[48:51], s77 offen offset:2048 lds
  v_mfma_f32_16x16x32_bf16 v[192:195], a[208:211], a[12:15], 0
  buffer_load_dwordx4 v27, s[48:51], s77 offen offset:3072 lds
  v_mfma_f32_16x16x32_bf16 v[196:199], a[208:211], a[16:19], 0
  s_waitcnt vmcnt(24)
  v_mfma_f32_16x16x32_bf16 v[40:43], a[212:215], a[20:23], v[40:43]
  ds_read_b64_tr_b16 a[180:181], v28 offset:8192
  v_mfma_f32_16x16x32_bf16 v[44:47], a[212:215], a[24:27], v[44:47]
  ds_read_b64_tr_b16 a[182:183], v28 offset:12288
  v_mfma_f32_16x16x32_bf16 v[48:51], a[212:215], a[28:31], v[48:51]
  v_mfma_f32_16x16x32_bf16 v[52:55], a[212:215], a[32:35], v[52:55]
  ds_read_b64_tr_b16 a[184:185], v29 offset:8192
  v_mfma_f32_16x16x32_bf16 v[56:59], a[212:215], a[36:39], v[56:59]
  ds_read_b64_tr_b16 a[186:187], v29 offset:12288
  v_mfma_f32_16x16x32_bf16 v[60:63], a[216:219], a[20:23], v[60:63]
  v_mfma_f32_16x16x32_bf16 v[64:67], a[216:219], a[24:27], v[64:67]
  ds_read_b64_tr_b16 a[188:189], v30 offset:8192
  v_mfma_f32_16x16x32_bf16 v[68:71], a[216:219], a[28:31], v[68:71]
  ds_read_b64_tr_b16 a[190:191], v30 offset:12288
  v_mfma_f32_16x16x32_bf16 v[72:75], a[216:219], a[32:35], v[72:75]
  v_mfma_f32_16x16x32_bf16 v[76:79], a[216:219], a[36:39], v[76:79]
  ds_read_b64_tr_b16 a[192:193], v31 offset:8192
  v_mfma_f32_16x16x32_bf16 v[80:83], a[220:223], a[20:23], v[80:83]
  ds_read_b64_tr_b16 a[194:195], v31 offset:12288
  v_mfma_f32_16x16x32_bf16 v[84:87], a[220:223], a[24:27], v[84:87]
  v_mfma_f32_16x16x32_bf16 v[88:91], a[220:223], a[28:31], v[88:91]
  ds_read_b64_tr_b16 a[196:197], v32 offset:8192
  v_mfma_f32_16x16x32_bf16 v[92:95], a[220:223], a[32:35], v[92:95]
  ds_read_b64_tr_b16 a[198:199], v32 offset:12288
  v_mfma_f32_16x16x32_bf16 v[96:99], a[220:223], a[36:39], v[96:99]
  v_mfma_f32_16x16x32_bf16 v[100:103], a[224:227], a[20:23], v[100:103]
  ds_read_b64_tr_b16 a[200:201], v33 offset:8192
  v_mfma_f32_16x16x32_bf16 v[104:107], a[224:227], a[24:27], v[104:107]
  ds_read_b64_tr_b16 a[202:203], v33 offset:12288
  v_mfma_f32_16x16x32_bf16 v[108:111], a[224:227], a[28:31], v[108:111]
  v_mfma_f32_16x16x32_bf16 v[112:115], a[224:227], a[32:35], v[112:115]
  ds_read_b64_tr_b16 a[204:205], v34 offset:8192
  v_mfma_f32_16x16x32_bf16 v[116:119], a[224:227], a[36:39], v[116:119]
  ds_read_b64_tr_b16 a[206:207], v34 offset:12288
  v_mfma_f32_16x16x32_bf16 v[120:123], a[228:231], a[20:23], v[120:123]
  v_mfma_f32_16x16x32_bf16 v[124:127], a[228:231], a[24:27], v[124:127]
  ds_read_b64_tr_b16 a[208:209], v35 offset:8192
  v_mfma_f32_16x16x32_bf16 v[128:131], a[228:231], a[28:31], v[128:131]
  ds_read_b64_tr_b16 a[210:211], v35 offset:12288
  v_mfma_f32_16x16x32_bf16 v[132:135], a[228:231], a[32:35], v[132:135]
  v_mfma_f32_16x16x32_bf16 v[136:139], a[228:231], a[36:39], v[136:139]
  v_mfma_f32_16x16x32_bf16 v[140:143], a[232:235], a[20:23], v[140:143]
  v_mfma_f32_16x16x32_bf16 v[144:147], a[232:235], a[24:27], v[144:147]
  v_mfma_f32_16x16x32_bf16 v[148:151], a[232:235], a[28:31], v[148:151]
  v_mfma_f32_16x16x32_bf16 v[152:155], a[232:235], a[32:35], v[152:155]
  v_mfma_f32_16x16x32_bf16 v[156:159], a[232:235], a[36:39], v[156:159]
  v_mfma_f32_16x16x32_bf16 v[160:163], a[236:239], a[20:23], v[160:163]
  v_mfma_f32_16x16x32_bf16 v[164:167], a[236:239], a[24:27], v[164:167]
  v_mfma_f32_16x16x32_bf16 v[168:171], a[236:239], a[28:31], v[168:171]
  v_mfma_f32_16x16x32_bf16 v[172:175], a[236:239], a[32:35], v[172:175]
  v_mfma_f32_16x16x32_bf16 v[176:179], a[236:239], a[36:39], v[176:179]
  v_mfma_f32_16x16x32_bf16 v[180:183], a[240:243], a[20:23], v[180:183]
  v_mfma_f32_16x16x32_bf16 v[184:187], a[240:243], a[24:27], v[184:187]
  v_mfma_f32_16x16x32_bf16 v[188:191], a[240:243], a[28:31], v[188:191]
  v_mfma_f32_16x16x32_bf16 v[192:195], a[240:243], a[32:35], v[192:195]
  v_mfma_f32_16x16x32_bf16 v[196:199], a[240:243], a[36:39], v[196:199]
  v_mfma_f32_16x16x32_bf16 v[40:43], a[160:163], a[40:43], v[40:43]
  v_mfma_f32_16x16x32_bf16 v[44:47], a[160:163], a[44:47], v[44:47]
  v_mfma_f32_16x16x32_bf16 v[48:51], a[160:163], a[48:51], v[48:51]
  v_mfma_f32_16x16x32_bf16 v[52:55], a[160:163], a[52:55], v[52:55]
  v_mfma_f32_16x16x32_bf16 v[56:59], a[160:163], a[56:59], v[56:59]
  v_mfma_f32_16x16x32_bf16 v[60:63], a[164:167], a[40:43], v[60:63]
  v_mfma_f32_16x16x32_bf16 v[64:67], a[164:167], a[44:47], v[64:67]
  v_mfma_f32_16x16x32_bf16 v[68:71], a[164:167], a[48:51], v[68:71]
  v_mfma_f32_16x16x32_bf16 v[72:75], a[164:167], a[52:55], v[72:75]
  v_mfma_f32_16x16x32_bf16 v[76:79], a[164:167], a[56:59], v[76:79]
  v_mfma_f32_16x16x32_bf16 v[80:83], a[168:171], a[40:43], v[80:83]
  v_mfma_f32_16x16x32_bf16 v[84:87], a[168:171], a[44:47], v[84:87]
  v_mfma_f32_16x16x32_bf16 v[88:91], a[168:171], a[48:51], v[88:91]
  v_mfma_f32_16x16x32_bf16 v[92:95], a[168:171], a[52:55], v[92:95]
  v_mfma_f32_16x16x32_bf16 v[96:99], a[168:171], a[56:59], v[96:99]
  v_mfma_f32_16x16x32_bf16 v[100:103], a[172:175], a[40:43], v[100:103]
  v_mfma_f32_16x16x32_bf16 v[104:107], a[172:175], a[44:47], v[104:107]
  v_mfma_f32_16x16x32_bf16 v[108:111], a[172:175], a[48:51], v[108:111]
  v_mfma_f32_16x16x32_bf16 v[112:115], a[172:175], a[52:55], v[112:115]
  v_mfma_f32_16x16x32_bf16 v[116:119], a[172:175], a[56:59], v[116:119]
  v_mfma_f32_16x16x32_bf16 v[120:123], a[176:179], a[40:43], v[120:123]
  v_mfma_f32_16x16x32_bf16 v[124:127], a[176:179], a[44:47], v[124:127]
  v_mfma_f32_16x16x32_bf16 v[128:131], a[176:179], a[48:51], v[128:131]
  v_mfma_f32_16x16x32_bf16 v[132:135], a[176:179], a[52:55], v[132:135]
  v_mfma_f32_16x16x32_bf16 v[136:139], a[176:179], a[56:59], v[136:139]
  v_mfma_f32_16x16x32_bf16 v[140:143], a[244:247], a[40:43], v[140:143]
  v_mfma_f32_16x16x32_bf16 v[144:147], a[244:247], a[44:47], v[144:147]
  v_mfma_f32_16x16x32_bf16 v[148:151], a[244:247], a[48:51], v[148:151]
  v_mfma_f32_16x16x32_bf16 v[152:155], a[244:247], a[52:55], v[152:155]
  v_mfma_f32_16x16x32_bf16 v[156:159], a[244:247], a[56:59], v[156:159]
  v_mfma_f32_16x16x32_bf16 v[160:163], a[248:251], a[40:43], v[160:163]
  v_mfma_f32_16x16x32_bf16 v[164:167], a[248:251], a[44:47], v[164:167]
  v_mfma_f32_16x16x32_bf16 v[168:171], a[248:251], a[48:51], v[168:171]
  v_mfma_f32_16x16x32_bf16 v[172:175], a[248:251], a[52:55], v[172:175]
  v_mfma_f32_16x16x32_bf16 v[176:179], a[248:251], a[56:59], v[176:179]
  v_mfma_f32_16x16x32_bf16 v[180:183], a[252:255], a[40:43], v[180:183]
  v_mfma_f32_16x16x32_bf16 v[184:187], a[252:255], a[44:47], v[184:187]
  v_mfma_f32_16x16x32_bf16 v[188:191], a[252:255], a[48:51], v[188:191]
  v_mfma_f32_16x16x32_bf16 v[192:195], a[252:255], a[52:55], v[192:195]
  v_mfma_f32_16x16x32_bf16 v[196:199], a[252:255], a[56:59], v[196:199]
  s_waitcnt lgkmcnt(0)
  v_mfma_f32_16x16x32_bf16 v[40:43], a[180:183], a[60:63], v[40:43]
  v_mfma_f32_16x16x32_bf16 v[44:47], a[180:183], a[64:67], v[44:47]
  v_mfma_f32_16x16x32_bf16 v[48:51], a[180:183], a[68:71], v[48:51]
  v_mfma_f32_16x16x32_bf16 v[52:55], a[180:183], a[72:75], v[52:55]
  v_mfma_f32_16x16x32_bf16 v[56:59], a[180:183], a[76:79], v[56:59]
  v_mfma_f32_16x16x32_bf16 v[60:63], a[184:187], a[60:63], v[60:63]
  v_mfma_f32_16x16x32_bf16 v[64:67], a[184:187], a[64:67], v[64:67]
  v_mfma_f32_16x16x32_bf16 v[68:71], a[184:187], a[68:71], v[68:71]
  v_mfma_f32_16x16x32_bf16 v[72:75], a[184:187], a[72:75], v[72:75]
  v_mfma_f32_16x16x32_bf16 v[76:79], a[184:187], a[76:79], v[76:79]
  v_mfma_f32_16x16x32_bf16 v[80:83], a[188:191], a[60:63], v[80:83]
  v_mfma_f32_16x16x32_bf16 v[84:87], a[188:191], a[64:67], v[84:87]
  v_mfma_f32_16x16x32_bf16 v[88:91], a[188:191], a[68:71], v[88:91]
  v_mfma_f32_16x16x32_bf16 v[92:95], a[188:191], a[72:75], v[92:95]
  v_mfma_f32_16x16x32_bf16 v[96:99], a[188:191], a[76:79], v[96:99]
  v_mfma_f32_16x16x32_bf16 v[100:103], a[192:195], a[60:63], v[100:103]
  v_mfma_f32_16x16x32_bf16 v[104:107], a[192:195], a[64:67], v[104:107]
  v_mfma_f32_16x16x32_bf16 v[108:111], a[192:195], a[68:71], v[108:111]
  v_mfma_f32_16x16x32_bf16 v[112:115], a[192:195], a[72:75], v[112:115]
  v_mfma_f32_16x16x32_bf16 v[116:119], a[192:195], a[76:79], v[116:119]
  v_mfma_f32_16x16x32_bf16 v[120:123], a[196:199], a[60:63], v[120:123]
  s_waitcnt vmcnt(0)
  v_mfma_f32_16x16x32_bf16 v[124:127], a[196:199], a[64:67], v[124:127]
  ds_read_b64_tr_b16 a[212:213], v8 offset:0
  v_mfma_f32_16x16x32_bf16 v[128:131], a[196:199], a[68:71], v[128:131]
  ds_read_b64_tr_b16 a[214:215], v8 offset:4096
  v_mfma_f32_16x16x32_bf16 v[132:135], a[196:199], a[72:75], v[132:135]
  ds_read_b64_tr_b16 a[216:217], v9 offset:0
  v_mfma_f32_16x16x32_bf16 v[136:139], a[196:199], a[76:79], v[136:139]
  ds_read_b64_tr_b16 a[218:219], v9 offset:4096
  v_mfma_f32_16x16x32_bf16 v[140:143], a[200:203], a[60:63], v[140:143]
  ds_read_b64_tr_b16 a[220:221], v28 offset:16384
  v_mfma_f32_16x16x32_bf16 v[144:147], a[200:203], a[64:67], v[144:147]
  v_mfma_f32_16x16x32_bf16 v[148:151], a[200:203], a[68:71], v[148:151]
  ds_read_b64_tr_b16 a[222:223], v28 offset:20480
  v_mfma_f32_16x16x32_bf16 v[152:155], a[200:203], a[72:75], v[152:155]
  ds_read_b64_tr_b16 a[224:225], v29 offset:16384
  v_mfma_f32_16x16x32_bf16 v[156:159], a[200:203], a[76:79], v[156:159]
  ds_read_b64_tr_b16 a[226:227], v29 offset:20480
  v_mfma_f32_16x16x32_bf16 v[160:163], a[204:207], a[60:63], v[160:163]
  ds_read_b64_tr_b16 a[228:229], v28 offset:24576
  v_mfma_f32_16x16x32_bf16 v[164:167], a[204:207], a[64:67], v[164:167]
  ds_read_b64_tr_b16 a[230:231], v28 offset:28672
  v_mfma_f32_16x16x32_bf16 v[168:171], a[204:207], a[68:71], v[168:171]
  ds_read_b64_tr_b16 a[232:233], v29 offset:24576
  v_mfma_f32_16x16x32_bf16 v[172:175], a[204:207], a[72:75], v[172:175]
  v_mfma_f32_16x16x32_bf16 v[176:179], a[204:207], a[76:79], v[176:179]
  ds_read_b64_tr_b16 a[234:235], v29 offset:28672
  v_mfma_f32_16x16x32_bf16 v[180:183], a[208:211], a[60:63], v[180:183]
  ds_read_b64_tr_b16 a[236:237], v28 offset:0
  v_mfma_f32_16x16x32_bf16 v[184:187], a[208:211], a[64:67], v[184:187]
  ds_read_b64_tr_b16 a[238:239], v28 offset:4096
  v_mfma_f32_16x16x32_bf16 v[188:191], a[208:211], a[68:71], v[188:191]
  ds_read_b64_tr_b16 a[240:241], v29 offset:0
  v_mfma_f32_16x16x32_bf16 v[192:195], a[208:211], a[72:75], v[192:195]
  ds_read_b64_tr_b16 a[242:243], v29 offset:4096
  v_mfma_f32_16x16x32_bf16 v[196:199], a[208:211], a[76:79], v[196:199]
  s_cmp_eq_u32 s66, 0
  s_cbranch_scc1 L_dfr_done
  s_mov_b32 s72, 0
L_dfr:
  buffer_load_dword v228, v247, s[52:55], s18 offen sc1
  s_waitcnt vmcnt(0)
  v_cmp_ne_u32 vcc, v246, v228
  s_cbranch_vccnz L_dfr_done
  s_sleep 2
  s_add_u32 s72, s72, 1
  s_cmp_lt_u32 s72, 400
  s_cbranch_scc1 L_dfr
L_dfr_done:
  s_waitcnt lgkmcnt(0)
  v_mfma_f32_16x16x32_bf16 v[40:43], a[212:215], a[80:83], v[40:43]
  v_mfma_f32_16x16x32_bf16 v[44:47], a[212:215], a[84:87], v[44:47]
  v_mfma_f32_16x16x32_bf16 v[48:51], a[212:215], a[88:91], v[48:51]
  v_mfma_f32_16x16x32_bf16 v[52:55], a[212:215], a[92:95], v[52:55]
  ds_read_b64_tr_b16 a[160:161], v10 offset:0
  v_mfma_f32_16x16x32_bf16 v[56:59], a[212:215], a[96:99], v[56:59]
  v_mfma_f32_16x16x32_bf16 v[60:63], a[216:219], a[80:83], v[60:63]
  ds_read_b64_tr_b16 a[162:163], v10 offset:4096
  v_mfma_f32_16x16x32_bf16 v[64:67], a[216:219], a[84:87], v[64:67]
  v_mfma_f32_16x16x32_bf16 v[68:71], a[216:219], a[88:91], v[68:71]
  ds_read_b64_tr_b16 a[164:165], v11 offset:0
  v_mfma_f32_16x16x32_bf16 v[72:75], a[216:219], a[92:95], v[72:75]
  v_mfma_f32_16x16x32_bf16 v[76:79], a[216:219], a[96:99], v[76:79]
  ds_read_b64_tr_b16 a[166:167], v11 offset:4096
  v_mfma_f32_16x16x32_bf16 v[40:43], a[220:223], a[100:103], v[40:43]
  v_mfma_f32_16x16x32_bf16 v[44:47], a[220:223], a[104:107], v[44:47]
  ds_read_b64_tr_b16 a[168:169], v30 offset:16384
  v_mfma_f32_16x16x32_bf16 v[48:51], a[220:223], a[108:111], v[48:51]
  v_mfma_f32_16x16x32_bf16 v[52:55], a[220:223], a[112:115], v[52:55]
  ds_read_b64_tr_b16 a[170:171], v30 offset:20480
  v_mfma_f32_16x16x32_bf16 v[56:59], a[220:223], a[116:119], v[56:59]
  v_mfma_f32_16x16x32_bf16 v[60:63], a[224:227], a[100:103], v[60:63]
  ds_read_b64_tr_b16 a[172:173], v31 offset:16384
  v_mfma_f32_16x16x32_bf16 v[64:67], a[224:227], a[104:107], v[64:67]
  v_mfma_f32_16x16x32_bf16 v[68:71], a[224:227], a[108:111], v[68:71]
  ds_read_b64_tr_b16 a[174:175], v31 offset:20480
  v_mfma_f32_16x16x32_bf16 v[72:75], a[224:227], a[112:115], v[72:75]
  v_mfma_f32_16x16x32_bf16 v[76:79], a[224:227], a[116:119], v[76:79]
  ds_read_b64_tr_b16 a[176:177], v30 offset:24576
  v_mfma_f32_16x16x32_bf16 v[40:43], a[228:231], a[120:123], v[40:43]
  v_mfma_f32_16x16x32_bf16 v[44:47], a[228:231], a[124:127], v[44:47]
  ds_read_b64_tr_b16 a[178:179], v30 offset:28672
  v_mfma_f32_16x16x32_bf16 v[48:51], a[228:231], a[128:131], v[48:51]
  v_mfma_f32_16x16x32_bf16 v[52:55], a[228:231], a[132:135], v[52:55]
  ds_read_b64_tr_b16 a[244:245], v31 offset:24576
  v_mfma_f32_16x16x32_bf16 v[56:59], a[228:231], a[136:139], v[56:59]
  v_mfma_f32_16x16x32_bf16 v[60:63], a[232:235], a[120:123], v[60:63]
  ds_read_b64_tr_b16 a[246:247], v31 offset:28672
  v_mfma_f32_16x16x32_bf16 v[64:67], a[232:235], a[124:127], v[64:67]
  v_mfma_f32_16x16x32_bf16 v[68:71], a[232:235], a[128:131], v[68:71]
  ds_read_b64_tr_b16 a[248:249], v30 offset:0
  v_mfma_f32_16x16x32_bf16 v[72:75], a[232:235], a[132:135], v[72:75]
  v_mfma_f32_16x16x32_bf16 v[76:79], a[232:235], a[136:139], v[76:79]
  ds_read_b64_tr_b16 a[250:251], v30 offset:4096
  v_mfma_f32_16x16x32_bf16 v[40:43], a[236:239], a[140:143], v[40:43]
  v_mfma_f32_16x16x32_bf16 v[44:47], a[236:239], a[144:147], v[44:47]
  ds_read_b64_tr_b16 a[252:253], v31 offset:0
  v_mfma_f32_16x16x32_bf16 v[48:51], a[236:239], a[148:151], v[48:51]
  v_mfma_f32_16x16x32_bf16 v[52:55], a[236:239], a[152:155], v[52:55]
  ds_read_b64_tr_b16 a[254:255], v31 offset:4096
  v_mfma_f32_16x16x32_bf16 v[56:59], a[236:239], a[156:159], v[56:59]
  v_mfma_f32_16x16x32_bf16 v[60:63], a[240:243], a[140:143], v[60:63]
  v_mfma_f32_16x16x32_bf16 v[64:67], a[240:243], a[144:147], v[64:67]
  v_mfma_f32_16x16x32_bf16 v[68:71], a[240:243], a[148:151], v[68:71]
  v_mfma_f32_16x16x32_bf16 v[72:75], a[240:243], a[152:155], v[72:75]
  v_mfma_f32_16x16x32_bf16 v[76:79], a[240:243], a[156:159], v[76:79]
  s_waitcnt lgkmcnt(0)
  v_mfma_f32_16x16x32_bf16 v[80:83], a[160:163], a[80:83], v[80:83]
  v_mfma_f32_16x16x32_bf16 v[84:87], a[160:163], a[84:87], v[84:87]
  v_mfma_f32_16x16x32_bf16 v[88:91], a[160:163], a[88:91], v[88:91]
  v_mfma_f32_16x16x32_bf16 v[92:95], a[160:163], a[92:95], v[92:95]
  ds_read_b64_tr_b16 a[212:213], v12 offset:0
  ds_read_b64_tr_b16 a[214:215], v12 offset:4096
  v_mfma_f32_16x16x32_bf16 v[96:99], a[160:163], a[96:99], v[96:99]
  ds_read_b64_tr_b16 a[216:217], v13 offset:0
  v_mfma_f32_16x16x32_bf16 v[100:103], a[164:167], a[80:83], v[100:103]
  ds_read_b64_tr_b16 a[218:219], v13 offset:4096
  ds_read_b64_tr_b16 a[220:221], v32 offset:16384
  v_mfma_f32_16x16x32_bf16 v[104:107], a[164:167], a[84:87], v[104:107]
  ds_read_b64_tr_b16 a[222:223], v32 offset:20480
  v_mfma_f32_16x16x32_bf16 v[108:111], a[164:167], a[88:91], v[108:111]
  v_cvt_pk_bf16_f32 v200, v40, v41
  v_mfma_f32_16x16x32_bf16 v[112:115], a[164:167], a[92:95], v[112:115]
  v_cvt_pk_bf16_f32 v201, v42, v43
  v_cvt_pk_bf16_f32 v202, v60, v61
  v_mfma_f32_16x16x32_bf16 v[116:119], a[164:167], a[96:99], v[116:119]
  v_cvt_pk_bf16_f32 v203, v62, v63
  v_mfma_f32_16x16x32_bf16 v[80:83], a[168:171], a[100:103], v[80:83]
  s_add_u32 s77, s76, 0
  buffer_store_dwordx4 v[200:203], v7, s[52:55], s77 offen sc1
  v_mfma_f32_16x16x32_bf16 v[84:87], a[168:171], a[104:107], v[84:87]
  v_cvt_pk_bf16_f32 v204, v44, v45
  v_mfma_f32_16x16x32_bf16 v[88:91], a[168:171], a[108:111], v[88:91]
  v_cvt_pk_bf16_f32 v205, v46, v47
  v_mfma_f32_16x16x32_bf16 v[92:95], a[168:171], a[112:115], v[92:95]
  v_cvt_pk_bf16_f32 v206, v64, v65
  v_cvt_pk_bf16_f32 v207, v66, v67
  v_mfma_f32_16x16x32_bf16 v[96:99], a[168:171], a[116:119], v[96:99]
  s_add_u32 s77, s76, 1024
  v_mfma_f32_16x16x32_bf16 v[100:103], a[172:175], a[100:103], v[100:103]
  buffer_store_dwordx4 v[204:207], v7, s[52:55], s77 offen sc1
  v_cvt_pk_bf16_f32 v200, v48, v49
  v_mfma_f32_16x16x32_bf16 v[104:107], a[172:175], a[104:107], v[104:107]
  v_cvt_pk_bf16_f32 v201, v50, v51
  v_mfma_f32_16x16x32_bf16 v[108:111], a[172:175], a[108:111], v[108:111]
  v_cvt_pk_bf16_f32 v202, v68, v69
  v_mfma_f32_16x16x32_bf16 v[112:115], a[172:175], a[112:115], v[112:115]
  v_cvt_pk_bf16_f32 v203, v70, v71
  s_add_u32 s77, s76, 2048
  v_mfma_f32_16x16x32_bf16 v[116:119], a[172:175], a[116:119], v[116:119]
  buffer_store_dwordx4 v[200:203], v7, s[52:55], s77 offen sc1
  v_mfma_f32_16x16x32_bf16 v[80:83], a[176:179], a[120:123], v[80:83]
  v_cvt_pk_bf16_f32 v204, v52, v53
  v_cvt_pk_bf16_f32 v205, v54, v55
  v_mfma_f32_16x16x32_bf16 v[84:87], a[176:179], a[124:127], v[84:87]
  v_cvt_pk_bf16_f32 v206, v72, v73
  v_mfma_f32_16x16x32_bf16 v[88:91], a[176:179], a[128:131], v[88:91]
  v_cvt_pk_bf16_f32 v207, v74, v75
  v_mfma_f32_16x16x32_bf16 v[92:95], a[176:179], a[132:135], v[92:95]
  s_add_u32 s77, s76, 3072
  buffer_store_dwordx4 v[204:207], v7, s[52:55], s77 offen sc1
  v_mfma_f32_16x16x32_bf16 v[96:99], a[176:179], a[136:139], v[96:99]
  v_cvt_pk_bf16_f32 v200, v56, v57
  v_mfma_f32_16x16x32_bf16 v[100:103], a[244:247], a[120:123], v[100:103]
  v_cvt_pk_bf16_f32 v201, v58, v59
  v_cvt_pk_bf16_f32 v202, v76, v77
  v_mfma_f32_16x16x32_bf16 v[104:107], a[244:247], a[124:127], v[104:107]
  v_cvt_pk_bf16_f32 v203, v78, v79
  v_mfma_f32_16x16x32_bf16 v[108:111], a[244:247], a[128:131], v[108:111]
  s_add_u32 s77, s76, 4096
  v_mfma_f32_16x16x32_bf16 v[112:115], a[244:247], a[132:135], v[112:115]
  buffer_store_dwordx4 v[200:203], v7, s[52:55], s77 offen sc1
  ds_read_b64_tr_b16 a[224:225], v33 offset:16384
  v_mfma_f32_16x16x32_bf16 v[116:119], a[244:247], a[136:139], v[116:119]
  ds_read_b64_tr_b16 a[226:227], v33 offset:20480
  v_mfma_f32_16x16x32_bf16 v[80:83], a[248:251], a[140:143], v[80:83]
  ds_read_b64_tr_b16 a[228:229], v32 offset:24576
  ds_read_b64_tr_b16 a[230:231], v32 offset:28672
  v_mfma_f32_16x16x32_bf16 v[84:87], a[248:251], a[144:147], v[84:87]
  ds_read_b64_tr_b16 a[232:233], v33 offset:24576
  v_mfma_f32_16x16x32_bf16 v[88:91], a[248:251], a[148:151], v[88:91]
  ds_read_b64_tr_b16 a[234:235], v33 offset:28672
  v_mfma_f32_16x16x32_bf16 v[92:95], a[248:251], a[152:155], v[92:95]
  ds_read_b64_tr_b16 a[236:237], v32 offset:0
  ds_read_b64_tr_b16 a[238:239], v32 offset:4096
  v_mfma_f32_16x16x32_bf16 v[96:99], a[248:251], a[156:159], v[96:99]
  ds_read_b64_tr_b16 a[240:241], v33 offset:0
  v_mfma_f32_16x16x32_bf16 v[100:103], a[252:255], a[140:143], v[100:103]
  ds_read_b64_tr_b16 a[242:243], v33 offset:4096
  v_mfma_f32_16x16x32_bf16 v[104:107], a[252:255], a[144:147], v[104:107]
  v_mfma_f32_16x16x32_bf16 v[108:111], a[252:255], a[148:151], v[108:111]
  v_mfma_f32_16x16x32_bf16 v[112:115], a[252:255], a[152:155], v[112:115]
  v_mfma_f32_16x16x32_bf16 v[116:119], a[252:255], a[156:159], v[116:119]
  s_waitcnt lgkmcnt(0)
  v_mfma_f32_16x16x32_bf16 v[120:123], a[212:215], a[80:83], v[120:123]
  v_mfma_f32_16x16x32_bf16 v[124:127], a[212:215], a[84:87], v[124:127]
  v_mfma_f32_16x16x32_bf16 v[128:131], a[212:215], a[88:91], v[128:131]
  v_mfma_f32_16x16x32_bf16 v[132:135], a[212:215], a[92:95], v[132:135]
  ds_read_b64_tr_b16 a[160:161], v14 offset:0
  ds_read_b64_tr_b16 a[162:163], v14 offset:4096
  v_mfma_f32_16x16x32_bf16 v[136:139], a[212:215], a[96:99], v[136:139]
  ds_read_b64_tr_b16 a[164:165], v15 offset:0
  v_mfma_f32_16x16x32_bf16 v[140:143], a[216:219], a[80:83], v[140:143]
  ds_read_b64_tr_b16 a[166:167], v15 offset:4096
  ds_read_b64_tr_b16 a[168:169], v34 offset:16384
  v_mfma_f32_16x16x32_bf16 v[144:147], a[216:219], a[84:87], v[144:147]
  ds_read_b64_tr_b16 a[170:171], v34 offset:20480
  v_mfma_f32_16x16x32_bf16 v[148:151], a[216:219], a[88:91], v[148:151]
  v_cvt_pk_bf16_f32 v200, v80, v81
  v_mfma_f32_16x16x32_bf16 v[152:155], a[216:219], a[92:95], v[152:155]
  v_cvt_pk_bf16_f32 v201, v82, v83
  v_cvt_pk_bf16_f32 v202, v100, v101
  v_mfma_f32_16x16x32_bf16 v[156:159], a[216:219], a[96:99], v[156:159]
  v_cvt_pk_bf16_f32 v203, v102, v103
  v_mfma_f32_16x16x32_bf16 v[120:123], a[220:223], a[100:103], v[120:123]
  s_add_u32 s77, s76, 5120
  buffer_store_dwordx4 v[200:203], v7, s[52:55], s77 offen sc1
  v_mfma_f32_16x16x32_bf16 v[124:127], a[220:223], a[104:107], v[124:127]
  v_cvt_pk_bf16_f32 v204, v84, v85
  v_mfma_f32_16x16x32_bf16 v[128:131], a[220:223], a[108:111], v[128:131]
  v_cvt_pk_bf16_f32 v205, v86, v87
  v_mfma_f32_16x16x32_bf16 v[132:135], a[220:223], a[112:115], v[132:135]
  v_cvt_pk_bf16_f32 v206, v104, v105
  v_cvt_pk_bf16_f32 v207, v106, v107
  v_mfma_f32_16x16x32_bf16 v[136:139], a[220:223], a[116:119], v[136:139]
  s_add_u32 s77, s76, 6144
  v_mfma_f32_16x16x32_bf16 v[140:143], a[224:227], a[100:103], v[140:143]
  buffer_store_dwordx4 v[204:207], v7, s[52:55], s77 offen sc1
  v_cvt_pk_bf16_f32 v200, v88, v89
  v_mfma_f32_16x16x32_bf16 v[144:147], a[224:227], a[104:107], v[144:147]
  v_cvt_pk_bf16_f32 v201, v90, v91
  v_mfma_f32_16x16x32_bf16 v[148:151], a[224:227], a[108:111], v[148:151]
  v_cvt_pk_bf16_f32 v202, v108, v109
  v_mfma_f32_16x16x32_bf16 v[152:155], a[224:227], a[112:115], v[152:155]
  v_cvt_pk_bf16_f32 v203, v110, v111
  s_add_u32 s77, s76, 7168
  v_mfma_f32_16x16x32_bf16 v[156:159], a[224:227], a[116:119], v[156:159]
  buffer_store_dwordx4 v[200:203], v7, s[52:55], s77 offen sc1
  v_mfma_f32_16x16x32_bf16 v[120:123], a[228:231], a[120:123], v[120:123]
  v_cvt_pk_bf16_f32 v204, v92, v93
  v_cvt_pk_bf16_f32 v205, v94, v95
  v_mfma_f32_16x16x32_bf16 v[124:127], a[228:231], a[124:127], v[124:127]
  v_cvt_pk_bf16_f32 v206, v112, v113
  v_mfma_f32_16x16x32_bf16 v[128:131], a[228:231], a[128:131], v[128:131]
  v_cvt_pk_bf16_f32 v207, v114, v115
  v_mfma_f32_16x16x32_bf16 v[132:135], a[228:231], a[132:135], v[132:135]
  s_add_u32 s77, s76, 8192
  buffer_store_dwordx4 v[204:207], v7, s[52:55], s77 offen sc1
  v_mfma_f32_16x16x32_bf16 v[136:139], a[228:231], a[136:139], v[136:139]
  v_cvt_pk_bf16_f32 v200, v96, v97
  v_mfma_f32_16x16x32_bf16 v[140:143], a[232:235], a[120:123], v[140:143]
  v_cvt_pk_bf16_f32 v201, v98, v99
  v_cvt_pk_bf16_f32 v202, v116, v117
  v_mfma_f32_16x16x32_bf16 v[144:147], a[232:235], a[124:127], v[144:147]
  v_cvt_pk_bf16_f32 v203, v118, v119
  v_mfma_f32_16x16x32_bf16 v[148:151], a[232:235], a[128:131], v[148:151]
  s_add_u32 s77, s76, 9216
  v_mfma_f32_16x16x32_bf16 v[152:155], a[232:235], a[132:135], v[152:155]
  buffer_store_dwordx4 v[200:203], v7, s[52:55], s77 offen sc1
  ds_read_b64_tr_b16 a[172:173], v35 offset:16384
  v_mfma_f32_16x16x32_bf16 v[156:159], a[232:235], a[136:139], v[156:159]
  ds_read_b64_tr_b16 a[174:175], v35 offset:20480
  v_mfma_f32_16x16x32_bf16 v[120:123], a[236:239], a[140:143], v[120:123]
  ds_read_b64_tr_b16 a[176:177], v34 offset:24576
  ds_read_b64_tr_b16 a[178:179], v34 offset:28672
  v_mfma_f32_16x16x32_bf16 v[124:127], a[236:239], a[144:147], v[124:127]
  ds_read_b64_tr_b16 a[244:245], v35 offset:24576
  v_mfma_f32_16x16x32_bf16 v[128:131], a[236:239], a[148:151], v[128:131]
  ds_read_b64_tr_b16 a[246:247], v35 offset:28672
  v_mfma_f32_16x16x32_bf16 v[132:135], a[236:239], a[152:155], v[132:135]
  ds_read_b64_tr_b16 a[248:249], v34 offset:0
  ds_read_b64_tr_b16 a[250:251], v34 offset:4096
  v_mfma_f32_16x16x32_bf16 v[136:139], a[236:239], a[156:159], v[136:139]
  ds_read_b64_tr_b16 a[252:253], v35 offset:0
  v_mfma_f32_16x16x32_bf16 v[140:143], a[240:243], a[140:143], v[140:143]
  ds_read_b64_tr_b16 a[254:255], v35 offset:4096
  v_mfma_f32_16x16x32_bf16 v[144:147], a[240:243], a[144:147], v[144:147]
  v_mfma_f32_16x16x32_bf16 v[148:151], a[240:243], a[148:151], v[148:151]
  v_mfma_f32_16x16x32_bf16 v[152:155], a[240:243], a[152:155], v[152:155]
  v_mfma_f32_16x16x32_bf16 v[156:159], a[240:243], a[156:159], v[156:159]
  s_waitcnt vmcnt(5)
  s_mov_b64 exec, 1
  buffer_store_dword v36, v37, s[52:55], s29 offen sc1
  s_mov_b64 exec, -1
  s_waitcnt lgkmcnt(0)
  v_mfma_f32_16x16x32_bf16 v[160:163], a[160:163], a[80:83], v[160:163]
  v_mfma_f32_16x16x32_bf16 v[164:167], a[160:163], a[84:87], v[164:167]
  v_mfma_f32_16x16x32_bf16 v[168:171], a[160:163], a[88:91], v[168:171]
  v_mfma_f32_16x16x32_bf16 v[172:175], a[160:163], a[92:95], v[172:175]
  v_cvt_pk_bf16_f32 v200, v120, v121
  v_mfma_f32_16x16x32_bf16 v[176:179], a[160:163], a[96:99], v[176:179]
  v_cvt_pk_bf16_f32 v201, v122, v123
  v_mfma_f32_16x16x32_bf16 v[180:183], a[164:167], a[80:83], v[180:183]
  v_cvt_pk_bf16_f32 v202, v140, v141
  v_mfma_f32_16x16x32_bf16 v[184:187], a[164:167], a[84:87], v[184:187]
  v_cvt_pk_bf16_f32 v203, v142, v143
  v_mfma_f32_16x16x32_bf16 v[188:191], a[164:167], a[88:91], v[188:191]
  s_add_u32 s77, s76, 10240
  v_mfma_f32_16x16x32_bf16 v[192:195], a[164:167], a[92:95], v[192:195]
  buffer_store_dwordx4 v[200:203], v7, s[52:55], s77 offen sc1
  v_mfma_f32_16x16x32_bf16 v[196:199], a[164:167], a[96:99], v[196:199]
  v_cvt_pk_bf16_f32 v204, v124, v125
  v_mfma_f32_16x16x32_bf16 v[160:163], a[168:171], a[100:103], v[160:163]
  v_cvt_pk_bf16_f32 v205, v126, v127
  v_mfma_f32_16x16x32_bf16 v[164:167], a[168:171], a[104:107], v[164:167]
  v_cvt_pk_bf16_f32 v206, v144, v145
  v_mfma_f32_16x16x32_bf16 v[168:171], a[168:171], a[108:111], v[168:171]
  v_cvt_pk_bf16_f32 v207, v146, v147
  v_mfma_f32_16x16x32_bf16 v[172:175], a[168:171], a[112:115], v[172:175]
  v_mfma_f32_16x16x32_bf16 v[176:179], a[168:171], a[116:119], v[176:179]
  s_add_u32 s77, s76, 11264
  v_mfma_f32_16x16x32_bf16 v[180:183], a[172:175], a[100:103], v[180:183]
  buffer_store_dwordx4 v[204:207], v7, s[52:55], s77 offen sc1
  v_mfma_f32_16x16x32_bf16 v[184:187], a[172:175], a[104:107], v[184:187]
  v_cvt_pk_bf16_f32 v200, v128, v129
  v_mfma_f32_16x16x32_bf16 v[188:191], a[172:175], a[108:111], v[188:191]
  v_cvt_pk_bf16_f32 v201, v130, v131
  v_mfma_f32_16x16x32_bf16 v[192:195], a[172:175], a[112:115], v[192:195]
  v_cvt_pk_bf16_f32 v202, v148, v149
  v_mfma_f32_16x16x32_bf16 v[196:199], a[172:175], a[116:119], v[196:199]
  v_cvt_pk_bf16_f32 v203, v150, v151
  v_mfma_f32_16x16x32_bf16 v[160:163], a[176:179], a[120:123], v[160:163]
  s_add_u32 s77, s76, 12288
  v_mfma_f32_16x16x32_bf16 v[164:167], a[176:179], a[124:127], v[164:167]
  buffer_store_dwordx4 v[200:203], v7, s[52:55], s77 offen sc1
  v_mfma_f32_16x16x32_bf16 v[168:171], a[176:179], a[128:131], v[168:171]
  v_cvt_pk_bf16_f32 v204, v132, v133
  v_mfma_f32_16x16x32_bf16 v[172:175], a[176:179], a[132:135], v[172:175]
  v_cvt_pk_bf16_f32 v205, v134, v135
  v_mfma_f32_16x16x32_bf16 v[176:179], a[176:179], a[136:139], v[176:179]
  v_mfma_f32_16x16x32_bf16 v[180:183], a[244:247], a[120:123], v[180:183]
  v_cvt_pk_bf16_f32 v206, v152, v153
  v_mfma_f32_16x16x32_bf16 v[184:187], a[244:247], a[124:127], v[184:187]
  v_cvt_pk_bf16_f32 v207, v154, v155
  v_mfma_f32_16x16x32_bf16 v[188:191], a[244:247], a[128:131], v[188:191]
  s_add_u32 s77, s76, 13312
  v_mfma_f32_16x16x32_bf16 v[192:195], a[244:247], a[132:135], v[192:195]
  buffer_store_dwordx4 v[204:207], v7, s[52:55], s77 offen sc1
  v_mfma_f32_16x16x32_bf16 v[196:199], a[244:247], a[136:139], v[196:199]
  v_cvt_pk_bf16_f32 v200, v136, v137
  v_mfma_f32_16x16x32_bf16 v[160:163], a[248:251], a[140:143], v[160:163]
  v_cvt_pk_bf16_f32 v201, v138, v139
  v_mfma_f32_16x16x32_bf16 v[164:167], a[248:251], a[144:147], v[164:167]
  v_cvt_pk_bf16_f32 v202, v156, v157
  v_mfma_f32_16x16x32_bf16 v[168:171], a[248:251], a[148:151], v[168:171]
  v_cvt_pk_bf16_f32 v203, v158, v159
  v_mfma_f32_16x16x32_bf16 v[172:175], a[248:251], a[152:155], v[172:175]
  s_add_u32 s77, s76, 14336
  v_mfma_f32_16x16x32_bf16 v[176:179], a[248:251], a[156:159], v[176:179]
  buffer_store_dwordx4 v[200:203], v7, s[52:55], s77 offen sc1
  v_mfma_f32_16x16x32_bf16 v[180:183], a[252:255], a[140:143], v[180:183]
  v_mfma_f32_16x16x32_bf16 v[184:187], a[252:255], a[144:147], v[184:187]
  v_mfma_f32_16x16x32_bf16 v[188:191], a[252:255], a[148:151], v[188:191]
  v_mfma_f32_16x16x32_bf16 v[192:195], a[252:255], a[152:155], v[192:195]
  v_mfma_f32_16x16x32_bf16 v[196:199], a[252:255], a[156:159], v[196:199]
  s_waitcnt vmcnt(6)
  s_mov_b64 exec, 2
  buffer_store_dword v36, v37, s[52:55], s29 offen sc1
  s_mov_b64 exec, -1
  s_nop 7
  v_cvt_pk_bf16_f32 v200, v160, v161
  v_cvt_pk_bf16_f32 v201, v162, v163
  v_cvt_pk_bf16_f32 v202, v180, v181
  v_cvt_pk_bf16_f32 v203, v182, v183
  s_add_u32 s77, s76, 15360
  buffer_store_dwordx4 v[200:203], v7, s[52:55], s77 offen sc1
  v_cvt_pk_bf16_f32 v204, v164, v165
  v_cvt_pk_bf16_f32 v205, v166, v167
  v_cvt_pk_bf16_f32 v206, v184, v185
  v_cvt_pk_bf16_f32 v207, v186, v187
  s_add_u32 s77, s76, 16384
  buffer_store_dwordx4 v[204:207], v7, s[52:55], s77 offen sc1
  v_cvt_pk_bf16_f32 v200, v168, v169
  v_cvt_pk_bf16_f32 v201, v170, v171
  v_cvt_pk_bf16_f32 v202, v188, v189
  v_cvt_pk_bf16_f32 v203, v190, v191
  s_add_u32 s77, s76, 17408
  buffer_store_dwordx4 v[200:203], v7, s[52:55], s77 offen sc1
  v_cvt_pk_bf16_f32 v204, v172, v173
  v_cvt_pk_bf16_f32 v205, v174, v175
  v_cvt_pk_bf16_f32 v206, v192, v193
  v_cvt_pk_bf16_f32 v207, v194, v195
  s_add_u32 s77, s76, 18432
  buffer_store_dwordx4 v[204:207], v7, s[52:55], s77 offen sc1
  v_cvt_pk_bf16_f32 v200, v176, v177
  v_cvt_pk_bf16_f32 v201, v178, v179
  v_cvt_pk_bf16_f32 v202, v196, v197
  v_cvt_pk_bf16_f32 v203, v198, v199
  s_add_u32 s77, s76, 19456
  buffer_store_dwordx4 v[200:203], v7, s[52:55], s77 offen sc1
  s_waitcnt vmcnt(6)
  s_mov_b64 exec, 4
  buffer_store_dword v36, v37, s[52:55], s29 offen sc1
  s_mov_b64 exec, -1
  s_waitcnt vmcnt(1)
  s_mov_b64 exec, 8
  buffer_store_dword v36, v37, s[52:55], s29 offen sc1
  s_mov_b64 exec, -1
  s_barrier
  s_cmp_lg_u32 s64, 0
  s_cbranch_scc1 L_nomark
  v_mov_b32 v229, 1
  v_mov_b32 v230, s2
  s_mov_b64 exec, 1
  buffer_store_byte v229, v230, s[60:63], 0 offen sc1
  s_mov_b64 exec, -1
L_nomark:
  s_cmp_eq_u32 s66, 0
  s_cbranch_scc1 L_fin
  v_lshrrev_b32 v237, 2, v38
  v_and_b32 v238, 1, v237
  v_lshrrev_b32 v237, 1, v237
  v_lshl_add_u32 v237, v238, 4, v237
  s_lshl_b32 s77, s67, 5
  v_add_u32 v237, s77, v237
  s_mov_b32 s72, 0
  s_mov_b32 s4, 0x00003f80
  s_mov_b32 s5, 0x3f800000
  v_and_b32 v233, 15, v0
  v_lshrrev_b32 v234, 4, v0
  v_lshlrev_b32 v234, 3, v234
  v_lshl_add_u32 v233, v233, 11, v234
  s_mul_i32 s6, s67, 163840
  s_lshl_b32 s77, s31, 6
  s_add_u32 s6, s6, s77
  s_mul_i32 s7, s64, 10240
  v_add_u32 v235, s7, v7
  s_lshl_b32 s7, s64, 11
  v_add_u32 v236, s7, v7
L_cons:
  s_lshl_b32 s8, s72, 3
  s_add_u32 s8, s8, s67
  s_lshl_b32 s8, s8, 4
  s_add_u32 s9, s8, s31
  s_lshl_b32 s9, s9, 6
  s_add_u32 s9, s9, 33554432
  s_lshl_b32 s10, s64, 2
  s_add_u32 s10, s10, s8
  s_mul_i32 s10, s10, 81920
  s_mul_i32 s11, s31, 5120
  s_add_u32 s10, s10, s11
  s_xor_b32 s13, s72, 1
  s_lshl_b32 s13, s13, 3
  s_mov_b32 s14, 0
  v_mov_b32 v40, 0
  v_mov_b32 v41, 0
  v_mov_b32 v42, 0
  v_mov_b32 v43, 0
  v_mov_b32 v44, 0
  v_mov_b32 v45, 0
  v_mov_b32 v46, 0
  v_mov_b32 v47, 0
  v_mov_b32 v48, 0
  v_mov_b32 v49, 0
  v_mov_b32 v50, 0
  v_mov_b32 v51, 0
  v_mov_b32 v52, 0
  v_mov_b32 v53, 0
  v_mov_b32 v54, 0
  v_mov_b32 v55, 0
  v_mov_b32 v56, 0
  v_mov_b32 v57, 0
  v_mov_b32 v58, 0
  v_mov_b32 v59, 0
  v_mov_b32 v60, 0
  v_mov_b32 v61, 0
  v_mov_b32 v62, 0
  v_mov_b32 v63, 0
  v_mov_b32 v64, 0
  v_mov_b32 v65, 0
  v_mov_b32 v66, 0
  v_mov_b32 v67, 0
  v_mov_b32 v68, 0
  v_mov_b32 v69, 0
  v_mov_b32 v70, 0
  v_mov_b32 v71, 0
  v_mov_b32 v72, 0
  v_mov_b32 v73, 0
  v_mov_b32 v74, 0
  v_mov_b32 v75, 0
  v_mov_b32 v76, 0
  v_mov_b32 v77, 0
  v_mov_b32 v78, 0
  v_mov_b32 v79, 0
L_poll:
  buffer_load_dword v231, v38, s[52:55], s9 offen sc1
  s_waitcnt vmcnt(0)
  v_cmp_eq_u32 vcc, v244, v231
  s_cbranch_vccz L_go
  s_sleep 1
  s_add_u32 s14, s14, 1
  s_and_b32 s15, s14, 31
  s_cbranch_scc1 L_poll
  buffer_load_ubyte v231, v237, s[60:63], s13 offen sc1
  s_waitcnt vmcnt(0)
  v_cmp_eq_u32 vcc, 0, v231
  s_cbranch_vccnz L_poll
L_go:
  s_add_u32 s11, s10, 0
  buffer_load_dwordx4 v[80:83], v7, s[52:55], s11 offen offset:0 sc1
  buffer_load_dwordx4 v[84:87], v7, s[52:55], s11 offen offset:1024 sc1
  buffer_load_dwordx4 v[88:91], v7, s[52:55], s11 offen offset:2048 sc1
  buffer_load_dwordx4 v[92:95], v7, s[52:55], s11 offen offset:3072 sc1
  s_add_u32 s11, s11, 4096
  buffer_load_dwordx4 v[96:99], v7, s[52:55], s11 offen sc1
  s_add_u32 s11, s10, 81920
  buffer_load_dwordx4 v[100:103], v7, s[52:55], s11 offen offset:0 sc1
  buffer_load_dwordx4 v[104:107], v7, s[52:55], s11 offen offset:1024 sc1
  buffer_load_dwordx4 v[108:111], v7, s[52:55], s11 offen offset:2048 sc1
  buffer_load_dwordx4 v[112:115], v7, s[52:55], s11 offen offset:3072 sc1
  s_add_u32 s11, s11, 4096
  buffer_load_dwordx4 v[116:119], v7, s[52:55], s11 offen sc1
  s_add_u32 s11, s10, 163840
  buffer_load_dwordx4 v[120:123], v7, s[52:55], s11 offen offset:0 sc1
  buffer_load_dwordx4 v[124:127], v7, s[52:55], s11 offen offset:1024 sc1
  buffer_load_dwordx4 v[128:131], v7, s[52:55], s11 offen offset:2048 sc1
  buffer_load_dwordx4 v[132:135], v7, s[52:55], s11 offen offset:3072 sc1
  s_add_u32 s11, s11, 4096
  buffer_load_dwordx4 v[136:139], v7, s[52:55], s11 offen sc1
  s_add_u32 s11, s10, 245760
  buffer_load_dwordx4 v[140:143], v7, s[52:55], s11 offen offset:0 sc1
  buffer_load_dwordx4 v[144:147], v7, s[52:55], s11 offen offset:1024 sc1
  buffer_load_dwordx4 v[148:151], v7, s[52:55], s11 offen offset:2048 sc1
  buffer_load_dwordx4 v[152:155], v7, s[52:55], s11 offen offset:3072 sc1
  s_add_u32 s11, s11, 4096
  buffer_load_dwordx4 v[156:159], v7, s[52:55], s11 offen sc1
  s_waitcnt vmcnt(15)
  v_dot2c_f32_bf16 v40, s4, v80
  v_dot2c_f32_bf16 v41, s5, v80
  v_dot2c_f32_bf16 v42, s4, v81
  v_dot2c_f32_bf16 v43, s5, v81
  v_dot2c_f32_bf16 v44, s4, v82
  v_dot2c_f32_bf16 v45, s5, v82
  v_dot2c_f32_bf16 v46, s4, v83
  v_dot2c_f32_bf16 v47, s5, v83
  v_dot2c_f32_bf16 v48, s4, v84
  v_dot2c_f32_bf16 v49, s5, v84
  v_dot2c_f32_bf16 v50, s4, v85
  v_dot2c_f32_bf16 v51, s5, v85
  v_dot2c_f32_bf16 v52, s4, v86
  v_dot2c_f32_bf16 v53, s5, v86
  v_dot2c_f32_bf16 v54, s4, v87
  v_dot2c_f32_bf16 v55, s5, v87
  v_dot2c_f32_bf16 v56, s4, v88
  v_dot2c_f32_bf16 v57, s5, v88
  v_dot2c_f32_bf16 v58, s4, v89
  v_dot2c_f32_bf16 v59, s5, v89
  v_dot2c_f32_bf16 v60, s4, v90
  v_dot2c_f32_bf16 v61, s5, v90
  v_dot2c_f32_bf16 v62, s4, v91
  v_dot2c_f32_bf16 v63, s5, v91
  v_dot2c_f32_bf16 v64, s4, v92
  v_dot2c_f32_bf16 v65, s5, v92
  v_dot2c_f32_bf16 v66, s4, v93
  v_dot2c_f32_bf16 v67, s5, v93
  v_dot2c_f32_bf16 v68, s4, v94
  v_dot2c_f32_bf16 v69, s5, v94
  v_dot2c_f32_bf16 v70, s4, v95
  v_dot2c_f32_bf16 v71, s5, v95
  v_dot2c_f32_bf16 v72, s4, v96
  v_dot2c_f32_bf16 v73, s5, v96
  v_dot2c_f32_bf16 v74, s4, v97
  v_dot2c_f32_bf16 v75, s5, v97
  v_dot2c_f32_bf16 v76, s4, v98
  v_dot2c_f32_bf16 v77, s5, v98
  v_dot2c_f32_bf16 v78, s4, v99
  v_dot2c_f32_bf16 v79, s5, v99
  s_waitcnt vmcnt(10)
  v_dot2c_f32_bf16 v40, s4, v100
  v_dot2c_f32_bf16 v41, s5, v100
  v_dot2c_f32_bf16 v42, s4, v101
  v_dot2c_f32_bf16 v43, s5, v101
  v_dot2c_f32_bf16 v44, s4, v102
  v_dot2c_f32_bf16 v45, s5, v102
  v_dot2c_f32_bf16 v46, s4, v103
  v_dot2c_f32_bf16 v47, s5, v103
  v_dot2c_f32_bf16 v48, s4, v104
  v_dot2c_f32_bf16 v49, s5, v104
  v_dot2c_f32_bf16 v50, s4, v105
  v_dot2c_f32_bf16 v51, s5, v105
  v_dot2c_f32_bf16 v52, s4, v106
  v_dot2c_f32_bf16 v53, s5, v106
  v_dot2c_f32_bf16 v54, s4, v107
  v_dot2c_f32_bf16 v55, s5, v107
  v_dot2c_f32_bf16 v56, s4, v108
  v_dot2c_f32_bf16 v57, s5, v108
  v_dot2c_f32_bf16 v58, s4, v109
  v_dot2c_f32_bf16 v59, s5, v109
  v_dot2c_f32_bf16 v60, s4, v110
  v_dot2c_f32_bf16 v61, s5, v110
  v_dot2c_f32_bf16 v62, s4, v111
  v_dot2c_f32_bf16 v63, s5, v111
  v_dot2c_f32_bf16 v64, s4, v112
  v_dot2c_f32_bf16 v65, s5, v112
  v_dot2c_f32_bf16 v66, s4, v113
  v_dot2c_f32_bf16 v67, s5, v113
  v_dot2c_f32_bf16 v68, s4, v114
  v_dot2c_f32_bf16 v69, s5, v114
  v_dot2c_f32_bf16 v70, s4, v115
  v_dot2c_f32_bf16 v71, s5, v115
  v_dot2c_f32_bf16 v72, s4, v116
  v_dot2c_f32_bf16 v73, s5, v116
  v_dot2c_f32_bf16 v74, s4, v117
  v_dot2c_f32_bf16 v75, s5, v117
  v_dot2c_f32_bf16 v76, s4, v118
  v_dot2c_f32_bf16 v77, s5, v118
  v_dot2c_f32_bf16 v78, s4, v119
  v_dot2c_f32_bf16 v79, s5, v119
  s_waitcnt vmcnt(5)
  v_dot2c_f32_bf16 v40, s4, v120
  v_dot2c_f32_bf16 v41, s5, v120
  v_dot2c_f32_bf16 v42, s4, v121
  v_dot2c_f32_bf16 v43, s5, v121
  v_dot2c_f32_bf16 v44, s4, v122
  v_dot2c_f32_bf16 v45, s5, v122
  v_dot2c_f32_bf16 v46, s4, v123
  v_dot2c_f32_bf16 v47, s5, v123
  v_dot2c_f32_bf16 v48, s4, v124
  v_dot2c_f32_bf16 v49, s5, v124
  v_dot2c_f32_bf16 v50, s4, v125
  v_dot2c_f32_bf16 v51, s5, v125
  v_dot2c_f32_bf16 v52, s4, v126
  v_dot2c_f32_bf16 v53, s5, v126
  v_dot2c_f32_bf16 v54, s4, v127
  v_dot2c_f32_bf16 v55, s5, v127
  v_dot2c_f32_bf16 v56, s4, v128
  v_dot2c_f32_bf16 v57, s5, v128
  v_dot2c_f32_bf16 v58, s4, v129
  v_dot2c_f32_bf16 v59, s5, v129
  v_dot2c_f32_bf16 v60, s4, v130
  v_dot2c_f32_bf16 v61, s5, v130
  v_dot2c_f32_bf16 v62, s4, v131
  v_dot2c_f32_bf16 v63, s5, v131
  v_dot2c_f32_bf16 v64, s4, v132
  v_dot2c_f32_bf16 v65, s5, v132
  v_dot2c_f32_bf16 v66, s4, v133
  v_dot2c_f32_bf16 v67, s5, v133
  v_dot2c_f32_bf16 v68, s4, v134
  v_dot2c_f32_bf16 v69, s5, v134
  v_dot2c_f32_bf16 v70, s4, v135
  v_dot2c_f32_bf16 v71, s5, v135
  v_dot2c_f32_bf16 v72, s4, v136
  v_dot2c_f32_bf16 v73, s5, v136
  v_dot2c_f32_bf16 v74, s4, v137
  v_dot2c_f32_bf16 v75, s5, v137
  v_dot2c_f32_bf16 v76, s4, v138
  v_dot2c_f32_bf16 v77, s5, v138
  v_dot2c_f32_bf16 v78, s4, v139
  v_dot2c_f32_bf16 v79, s5, v139
  s_waitcnt vmcnt(0)
  v_dot2c_f32_bf16 v40, s4, v140
  v_dot2c_f32_bf16 v41, s5, v140
  v_dot2c_f32_bf16 v42, s4, v141
  v_dot2c_f32_bf16 v43, s5, v141
  v_dot2c_f32_bf16 v44, s4, v142
  v_dot2c_f32_bf16 v45, s5, v142
  v_dot2c_f32_bf16 v46, s4, v143
  v_dot2c_f32_bf16 v47, s5, v143
  v_dot2c_f32_bf16 v48, s4, v144
  v_dot2c_f32_bf16 v49, s5, v144
  v_dot2c_f32_bf16 v50, s4, v145
  v_dot2c_f32_bf16 v51, s5, v145
  v_dot2c_f32_bf16 v52, s4, v146
  v_dot2c_f32_bf16 v53, s5, v146
  v_dot2c_f32_bf16 v54, s4, v147
  v_dot2c_f32_bf16 v55, s5, v147
  v_dot2c_f32_bf16 v56, s4, v148
  v_dot2c_f32_bf16 v57, s5, v148
  v_dot2c_f32_bf16 v58, s4, v149
  v_dot2c_f32_bf16 v59, s5, v149
  v_dot2c_f32_bf16 v60, s4, v150
  v_dot2c_f32_bf16 v61, s5, v150
  v_dot2c_f32_bf16 v62, s4, v151
  v_dot2c_f32_bf16 v63, s5, v151
  v_dot2c_f32_bf16 v64, s4, v152
  v_dot2c_f32_bf16 v65, s5, v152
  v_dot2c_f32_bf16 v66, s4, v153
  v_dot2c_f32_bf16 v67, s5, v153
  v_dot2c_f32_bf16 v68, s4, v154
  v_dot2c_f32_bf16 v69, s5, v154
  v_dot2c_f32_bf16 v70, s4, v155
  v_dot2c_f32_bf16 v71, s5, v155
  v_dot2c_f32_bf16 v72, s4, v156
  v_dot2c_f32_bf16 v73, s5, v156
  v_dot2c_f32_bf16 v74, s4, v157
  v_dot2c_f32_bf16 v75, s5, v157
  v_dot2c_f32_bf16 v76, s4, v158
  v_dot2c_f32_bf16 v77, s5, v158
  v_dot2c_f32_bf16 v78, s4, v159
  v_dot2c_f32_bf16 v79, s5, v159
  s_nop 2
  ds_write_b128 v235, v[40:43] offset:0
  ds_write_b128 v235, v[44:47] offset:1024
  ds_write_b128 v235, v[48:51] offset:2048
  ds_write_b128 v235, v[52:55] offset:3072
  ds_write_b128 v235, v[56:59] offset:4096
  ds_write_b128 v235, v[60:63] offset:5120
  ds_write_b128 v235, v[64:67] offset:6144
  ds_write_b128 v235, v[68:71] offset:7168
  ds_write_b128 v235, v[72:75] offset:8192
  ds_write_b128 v235, v[76:79] offset:9216
  s_lshl_b32 s11, s72, 10
  s_add_u32 s11, s11, s6
  s_lshl_b32 s12, s64, 15
  s_add_u32 s12, s12, s11
  s_waitcnt lgkmcnt(0)
  s_barrier
  ds_read_b128 v[80:83], v236 offset:0
  ds_read_b128 v[84:87], v236 offset:1024
  ds_read_b128 v[88:91], v236 offset:10240
  ds_read_b128 v[92:95], v236 offset:11264
  ds_read_b128 v[96:99], v236 offset:20480
  ds_read_b128 v[100:103], v236 offset:21504
  ds_read_b128 v[104:107], v236 offset:30720
  ds_read_b128 v[108:111], v236 offset:31744
  s_waitcnt lgkmcnt(0)
  v_add_f32 v40, v80, v88
  v_add_f32 v48, v96, v104
  v_add_f32 v41, v81, v89
  v_add_f32 v49, v97, v105
  v_add_f32 v42, v82, v90
  v_add_f32 v50, v98, v106
  v_add_f32 v43, v83, v91
  v_add_f32 v51, v99, v107
  v_add_f32 v44, v84, v92
  v_add_f32 v52, v100, v108
  v_add_f32 v45, v85, v93
  v_add_f32 v53, v101, v109
  v_add_f32 v46, v86, v94
  v_add_f32 v54, v102, v110
  v_add_f32 v47, v87, v95
  v_add_f32 v55, v103, v111
  v_add_f32 v40, v40, v48
  v_add_f32 v41, v41, v49
  v_add_f32 v42, v42, v50
  v_add_f32 v43, v43, v51
  v_add_f32 v44, v44, v52
  v_add_f32 v45, v45, v53
  v_add_f32 v46, v46, v54
  v_add_f32 v47, v47, v55
  v_cvt_pk_bf16_f32 v56, v40, v41
  v_cvt_pk_bf16_f32 v57, v42, v43
  v_cvt_pk_bf16_f32 v58, v44, v45
  v_cvt_pk_bf16_f32 v59, v46, v47
  buffer_store_dwordx2 v[56:57], v233, s[56:59], s12 offen
  buffer_store_dwordx2 v[58:59], v233, s[56:59], s12 offen offset:32
  s_cmp_lg_u32 s64, 0
  s_cbranch_scc1 L_skip4
  s_add_u32 s12, s11, 131072
  ds_read_b128 v[80:83], v236 offset:8192
  ds_read_b128 v[84:87], v236 offset:9216
  ds_read_b128 v[88:91], v236 offset:18432
  ds_read_b128 v[92:95], v236 offset:19456
  ds_read_b128 v[96:99], v236 offset:28672
  ds_read_b128 v[100:103], v236 offset:29696
  ds_read_b128 v[104:107], v236 offset:38912
  ds_read_b128 v[108:111], v236 offset:39936
  s_waitcnt lgkmcnt(0)
  v_add_f32 v40, v80, v88
  v_add_f32 v48, v96, v104
  v_add_f32 v41, v81, v89
  v_add_f32 v49, v97, v105
  v_add_f32 v42, v82, v90
  v_add_f32 v50, v98, v106
  v_add_f32 v43, v83, v91
  v_add_f32 v51, v99, v107
  v_add_f32 v44, v84, v92
  v_add_f32 v52, v100, v108
  v_add_f32 v45, v85, v93
  v_add_f32 v53, v101, v109
  v_add_f32 v46, v86, v94
  v_add_f32 v54, v102, v110
  v_add_f32 v47, v87, v95
  v_add_f32 v55, v103, v111
  v_add_f32 v40, v40, v48
  v_add_f32 v41, v41, v49
  v_add_f32 v42, v42, v50
  v_add_f32 v43, v43, v51
  v_add_f32 v44, v44, v52
  v_add_f32 v45, v45, v53
  v_add_f32 v46, v46, v54
  v_add_f32 v47, v47, v55
  v_cvt_pk_bf16_f32 v56, v40, v41
  v_cvt_pk_bf16_f32 v57, v42, v43
  v_cvt_pk_bf16_f32 v58, v44, v45
  v_cvt_pk_bf16_f32 v59, v46, v47
  buffer_store_dwordx2 v[56:57], v233, s[56:59], s12 offen
  buffer_store_dwordx2 v[58:59], v233, s[56:59], s12 offen offset:32
L_skip4:
  s_barrier
  v_mov_b32 v244, v245
  s_add_u32 s72, s72, 1
  s_cmp_lt_u32 s72, 2
  s_cbranch_scc1 L_cons
L_fin:
L_end:
  s_endpgm
.section .rodata,"a"
.p2align 6
.amdhsa_kernel concat_heads__gqa_block_cached__mha_block_cached__near_ridge_kernel
  .amdhsa_next_free_vgpr 512
  .amdhsa_next_free_sgpr 102
  .amdhsa_accum_offset 256
  .amdhsa_group_segment_fixed_size 0
  .amdhsa_kernarg_size 104
  .amdhsa_user_sgpr_count 2
  .amdhsa_user_sgpr_kernarg_segment_ptr 1
  .amdhsa_system_sgpr_workgroup_id_x 1
  .amdhsa_float_denorm_mode_32 3
.end_amdhsa_kernel
```
